```python
import torch

def _softmax(x, axis=-1):
    return torch.softmax(x, dim=axis)
def _gelu(x):
    return torch.nn.functional.gelu(x, approximate="tanh")
def _silu(x):
    return torch.nn.functional.silu(x)
def _sigmoid(x):
    return torch.sigmoid(x)
def _layernorm(x, axis=-1, eps=1e-5):
    m = x.mean(dim=axis, keepdim=True)
    v = x.var(dim=axis, keepdim=True, unbiased=False)
    return (x - m) / torch.sqrt(v + eps)
def _scatter_add(tgt, idx, src, axis=0):
    return tgt.clone().index_add_(axis, idx, src)
def _segment_sum(src, seg, n):
    out = torch.zeros((n,) + src.shape[1:], dtype=src.dtype)
    return out.index_add_(0, seg, src)
def _pad(x, pw):
    flat = tuple(v for pair in reversed(pw) for v in pair)
    return torch.nn.functional.pad(x, flat)

kernel_name = 'sequential_preLN__ssm_conv_s4__glu_gated_bilinear__prompt'

def setup_inputs():

    _w = (lambda a: (lambda t: t.to(torch.bfloat16) if t.is_floating_point() else t)(torch.as_tensor(a)))
    def _A_setup():
        B, L, D, N = 1, 2048, 640, 128
        A_re = -(lambda _x: torch.exp(torch.as_tensor(_x)))((lambda *s: torch.randn(*s, dtype=torch.bfloat16) * 6.4)(D, N))
        A_im = torch.pi * (lambda *s: torch.randn(*s, dtype=torch.bfloat16) * 0.05)(D, N)
        B_re = (lambda *s: torch.randn(*s, dtype=torch.bfloat16) * 0.05)(D, N)
        B_im = (lambda *s: torch.randn(*s, dtype=torch.bfloat16) * 0.05)(D, N)
        C_re = (lambda *s: torch.randn(*s, dtype=torch.bfloat16) * 0.05)(D, N)
        C_im = (lambda *s: torch.randn(*s, dtype=torch.bfloat16) * 0.05)(D, N)
        log_dt = (lambda *s: torch.randn(*s, dtype=torch.bfloat16) * 0.05)(D) * 0.5 - 4.0
        Dskip = (lambda *s: torch.randn(*s, dtype=torch.bfloat16) * 0.05)(D)
        return {
            "u": _w((lambda *s: torch.randn(*s, dtype=torch.bfloat16) * 0.05)(B, L, D)),
            "A_re": _w(A_re),
            "A_im": _w(A_im),
            "B_re": _w(B_re),
            "B_im": _w(B_im),
            "C_re": _w(C_re),
            "C_im": _w(C_im),
            "log_dt": _w(log_dt),
            "Dskip": _w(Dskip),
        }
    _A_in = _A_setup()

    def _B_setup():
        B, S, D, F = 1, 2048, 640, 1728
        return {
            "x": _w((lambda *s: torch.randn(*s, dtype=torch.bfloat16) * 0.05)(B, S, D)),
            "w_gate": _w((lambda *s: torch.randn(*s, dtype=torch.bfloat16) * 0.4)(D, F) * (D ** -0.5)),
            "w_up": _w((lambda *s: torch.randn(*s, dtype=torch.bfloat16) * 0.4)(D, F) * (D ** -0.5)),
            "w_down": _w((lambda *s: torch.randn(*s, dtype=torch.bfloat16) * 0.4)(F, D) * (F ** -0.5)),
        }
    _B_in = _B_setup()

    return {
        "A_u": _A_in["u"],
        "A_A_re": _A_in["A_re"],
        "A_A_im": _A_in["A_im"],
        "A_B_re": _A_in["B_re"],
        "A_B_im": _A_in["B_im"],
        "A_C_re": _A_in["C_re"],
        "A_C_im": _A_in["C_im"],
        "A_log_dt": _A_in["log_dt"],
        "A_Dskip": _A_in["Dskip"],
        "B_x": _B_in["x"],
        "B_w_gate": _B_in["w_gate"],
        "B_w_up": _B_in["w_up"],
        "B_w_down": _B_in["w_down"],
    }

def reference(A_u, A_A_re, A_A_im, A_B_re, A_B_im, A_C_re, A_C_im, A_log_dt, A_Dskip, B_x, B_w_gate, B_w_up, B_w_down):
    def _A_ref(u, A_re, A_im, B_re, B_im, C_re, C_im, log_dt, Dskip):
        Bsz, L, D = u.shape
        dt = torch.exp(log_dt)[:, None]
        A = A_re + 1j * A_im
        Bc = B_re + 1j * B_im
        Cc = C_re + 1j * C_im
        logdA = dt * A
        dB = dt * Bc
        l = (lambda x, dt: x.to(dt))(torch.arange(L), A_re.dtype)
        P = torch.exp(logdA[:, :, None] * l[None, None, :])
        K = torch.einsum("dn,dnl,dn->dl", Cc, P, dB).real
        L2 = 2 * L
        Kp = _pad(K, ((0, 0), (0, L)))
        up = (lambda x, *d: x.permute(*d))(u, 0, 2, 1)
        up = _pad(up, ((0, 0), (0, 0), (0, L)))
        Kf = (lambda x, axes=(-2,-1): torch.fft.rfft2(x.float(), dim=axes))(Kp[:, None, :], axes=(-2, -1))
        Uf = (lambda x, axes=(-2,-1): torch.fft.rfft2(x.float(), dim=axes))(up[:, :, None, :], axes=(-2, -1))
        Yf = Uf * Kf[None, :, :, :]
        y = (lambda x, s, axes=(-2,-1): torch.fft.irfft2(x, s=s, dim=axes).to(torch.bfloat16))(Yf, (1, L2), axes=(-2, -1))[:, :, 0, :L]
        y = (lambda x, *d: x.permute(*d))(y, 0, 2, 1) + u * Dskip[None, None, :]
        return y

    def _B_ref(x, w_gate, w_up, w_down):
        g = torch.einsum("bsd,df->bsf", x, w_gate)
        u = torch.einsum("bsd,df->bsf", x, w_up)
        h = g * u
        return torch.einsum("bsf,fd->bsd", h, w_down)

    x = A_u
    h = x + _A_ref(_layernorm(x, axis=-1), A_A_re, A_A_im, A_B_re, A_B_im, A_C_re, A_C_im, A_log_dt, A_Dskip)
    h2 = h + _B_ref(_layernorm(h, axis=-1), B_w_gate, B_w_up, B_w_down)
    return h2
```

```asm
; @launch grid=(256,1,1) block=(512,1,1) lds=163840
.amdgcn_target "amdgcn-amd-amdhsa--gfx950"
.text
.globl sequential_preLN__ssm_conv_s4__glu_gated_bilinear__prompt_kernel
.p2align 8
.type sequential_preLN__ssm_conv_s4__glu_gated_bilinear__prompt_kernel,@function
sequential_preLN__ssm_conv_s4__glu_gated_bilinear__prompt_kernel:
    s_cmp_ge_u32 s2, 256
    s_cbranch_scc1 M_END
    s_load_dwordx16 s[52:67], s[0:1], 0
    s_load_dwordx16 s[68:83], s[0:1], 64
    s_mov_b64 exec, -1
    v_readfirstlane_b32 s24, v0
    v_and_b32 v1, 63, v0
    s_and_b32 s20, s2, 7
    s_lshr_b32 s21, s2, 3
    s_lshr_b32 s24, s24, 6
    s_and_b32 s25, s24, 3
    s_mov_b32 s10, 2621440
    s_mov_b32 s11, 0x20000
    s_cmp_ge_u32 s2, 160
    s_cbranch_scc1 E_J
    s_mul_i32 s33, s20, 20
    s_add_u32 s33, s33, s21
    s_lshl_b32 s26, s33, 2
    s_add_u32 s26, s26, s25
    s_lshl_b32 s22, s26, 8
    v_lshl_add_u32 v2, v1, 2, s22
    s_lshr_b32 s23, s26, 1
    s_lshl_b32 s23, s23, 2
    v_mul_u32_u24 v62, 2560, v0
    s_lshl_b32 s27, s33, 3
    s_add_u32 s40, s21, 0
    s_and_b32 s40, s40, 3
    s_mul_i32 s44, s40, 655360
    s_add_u32 s44, s44, s27
    s_add_u32 s41, s21, 1
    s_and_b32 s41, s41, 3
    s_mul_i32 s45, s41, 655360
    s_add_u32 s45, s45, s27
    s_add_u32 s42, s21, 2
    s_and_b32 s42, s42, 3
    s_mul_i32 s46, s42, 655360
    s_add_u32 s46, s46, s27
    s_add_u32 s43, s21, 3
    s_and_b32 s43, s43, 3
    s_mul_i32 s47, s43, 655360
    s_add_u32 s47, s47, s27
    v_mov_b32 v12, 0
    v_lshlrev_b32 v19, 2, v1
    v_add_u32 v19, 20480, v19
    ds_write_b32 v19, v12
    s_waitcnt lgkmcnt(0)
    global_load_dword v200, v2, s[54:55]
    global_load_dword v201, v2, s[56:57]
    global_load_dword v202, v2, s[58:59]
    global_load_dword v203, v2, s[60:61]
    global_load_dword v204, v2, s[62:63]
    global_load_dword v205, v2, s[64:65]
    s_load_dword s28, s[66:67], s23
    s_load_dword s35, s[68:69], s23
    s_mov_b64 s[4:5], s[82:83]
    s_cmp_ge_u32 s24, 4
    s_barrier
    s_cbranch_scc1 M_C
    s_mov_b32 s8, s52
    s_and_b32 s9, s53, 0xffff
    buffer_load_dwordx2 v[128:129], v62, s[8:11], s44 offen offset:0
    buffer_load_dwordx2 v[130:131], v62, s[8:11], s44 offen offset:1280
    buffer_load_dwordx2 v[132:133], v62, s[8:11], s45 offen offset:0
    buffer_load_dwordx2 v[134:135], v62, s[8:11], s45 offen offset:1280
    s_branch M_BODY
E_J:
    s_getpc_b64 s[30:31]
pc_sequential_preLN__ssm_conv_s4__glu_gated_bilinear__prompt_kernel_1:
    v_lshlrev_b32 v3, 7, v0
    v_min_u32 v3, M_END-pc_sequential_preLN__ssm_conv_s4__glu_gated_bilinear__prompt_kernel_1, v3
    global_load_dword v255, v3, s[30:31]
    s_memrealtime s[46:47]
    s_sub_u32 s33, s2, 160
    s_mul_i32 s26, s24, 96
    s_add_u32 s26, s26, s33
    s_mul_i32 s27, s26, 2560
    s_add_u32 s28, s27, 1966080
    v_lshrrev_b32 v7, 5, v1
    v_and_b32 v3, 31, v1
    v_lshlrev_b32 v4, 4, v3
    v_mul_u32_u24 v5, 1280, v7
    v_add_u32 v5, v5, v4
    v_cmp_gt_u32 vcc, 16, v3
    v_add_u32 v8, 1024, v5
    v_mov_b32 v9, 0x7fffffff
    s_waitcnt lgkmcnt(0)
    v_cndmask_b32 v8, v9, v8, vcc
    s_cmp_lg_u32 s26, 0
    s_cbranch_scc1 E_NN
    s_or_b32 s48, s46, 1
    v_mov_b32 v10, s48
    v_mov_b32 v11, 0
    s_mov_b64 exec, 1
    global_store_dword v11, v10, s[80:81] sc0 sc1
    s_mov_b64 exec, -1
E_NN:
    s_mov_b32 s8, s52
    s_and_b32 s9, s53, 0xffff
    buffer_load_dwordx4 v[16:19], v5, s[8:11], s27 offen
    buffer_load_dwordx4 v[20:23], v5, s[8:11], s27 offen offset:512
    buffer_load_dwordx4 v[24:27], v8, s[8:11], s27 offen
    buffer_load_dwordx4 v[28:31], v5, s[8:11], s28 offen
    buffer_load_dwordx4 v[32:35], v5, s[8:11], s28 offen offset:512
    buffer_load_dwordx4 v[36:39], v8, s[8:11], s28 offen
    s_mov_b64 s[4:5], s[82:83]
    s_branch M_J
PAD_RET:
    s_mov_b64 exec, -1
    s_setpc_b64 s[84:85]
    .p2align 12
M_BODY:
    v_lshlrev_b32 v63, 4, v0
    s_lshl_b32 s29, s25, 2
    s_add_u32 s29, s29, 20480
    v_mov_b32 v60, s29
    v_mov_b32 v19, 20480
    s_mov_b32 s36, s80
    s_and_b32 s37, s81, 0xffff
    s_mov_b32 s38, 256
    s_mov_b32 s39, 0x20000
    s_add_u32 s12, s4, 15400960
    s_addc_u32 s13, s5, 0
    s_and_b32 s13, s13, 0xffff
    s_mov_b32 s14, 16384
    s_mov_b32 s15, 0x20000
    s_mul_i32 s29, s25, 8704
    s_add_u32 s29, s29, 117248
    v_lshl_add_u32 v18, v1, 2, s29
    v_and_b32 v3, 31, v1
    v_lshrrev_b32 v4, 5, v1
    v_mul_u32_u24 v5, 272, v3
    v_lshl_add_u32 v5, v4, 4, v5
    v_add_u32 v5, s29, v5
    s_waitcnt lgkmcnt(0)
    s_and_b32 s23, s26, 1
    s_lshl_b32 s23, s23, 4
    s_lshr_b32 s28, s28, s23
    s_lshl_b32 s28, s28, 16
    v_mov_b32 v6, s28
    v_mul_f32 v6, 0x3fb8aa3b, v6
    v_exp_f32 v6, v6
    s_nop 0
    v_cvt_pk_bf16_f32 v6, v6, v6
    v_and_b32 v6, 0xffff0000, v6
    s_waitcnt vmcnt(4)
    v_and_b32 v10, 0xffff0000, v200
    v_and_b32 v11, 0xffff0000, v201
    v_and_b32 v12, 0xffff0000, v202
    v_and_b32 v13, 0xffff0000, v203
    v_and_b32 v14, 0xffff0000, v204
    v_and_b32 v15, 0xffff0000, v205
    v_mul_f32 v10, v6, v10
    v_mul_f32 v11, v6, v11
    v_mul_f32 v10, 0x3fb8aa3b, v10
    v_mul_f32 v11, 0x3e22f983, v11
    v_mul_f32 v16, 0x43800000, v10
    v_mul_f32 v17, 0x43800000, v11
    v_fract_f32 v11, v11
    v_fract_f32 v17, v17
    v_exp_f32 v10, v10
    v_cos_f32 v20, v11
    v_sin_f32 v21, v11
    v_exp_f32 v16, v16
    v_cos_f32 v28, v17
    v_sin_f32 v29, v17
    v_mul_f32 v20, v10, v20
    v_mul_f32 v21, v10, v21
    v_mul_f32 v28, v16, v28
    v_mul_f32 v29, v16, v29
    .p2align 3
    v_pk_mul_f32 v[36:37], v[20:21], v[20:21] op_sel_hi:[0,1]
    v_pk_fma_f32 v[22:23], v[20:21], v[20:21], v[36:37] op_sel:[1,1,0] op_sel_hi:[1,0,1] neg_lo:[0,1,0]
    v_pk_mul_f32 v[36:37], v[22:23], v[22:23] op_sel_hi:[0,1]
    v_pk_fma_f32 v[24:25], v[22:23], v[22:23], v[36:37] op_sel:[1,1,0] op_sel_hi:[1,0,1] neg_lo:[0,1,0]
    v_pk_mul_f32 v[36:37], v[24:25], v[24:25] op_sel_hi:[0,1]
    v_pk_fma_f32 v[26:27], v[24:25], v[24:25], v[36:37] op_sel:[1,1,0] op_sel_hi:[1,0,1] neg_lo:[0,1,0]
    v_mov_b32 v38, 0x3f80
    ds_write_b32 v18, v38
    v_cvt_pk_bf16_f32 v39, v26, -v27
    ds_write_b32 v18, v39 offset:272
    v_pk_mul_f32 v[36:37], v[26:27], v[26:27] op_sel_hi:[0,1]
    v_pk_fma_f32 v[34:35], v[26:27], v[26:27], v[36:37] op_sel:[1,1,0] op_sel_hi:[1,0,1] neg_lo:[0,1,0]
    v_cvt_pk_bf16_f32 v38, v34, -v35
    ds_write_b32 v18, v38 offset:544
    v_pk_mul_f32 v[36:37], v[34:35], v[26:27] op_sel_hi:[0,1]
    v_pk_fma_f32 v[34:35], v[34:35], v[26:27], v[36:37] op_sel:[1,1,0] op_sel_hi:[1,0,1] neg_lo:[0,1,0]
    v_cvt_pk_bf16_f32 v39, v34, -v35
    ds_write_b32 v18, v39 offset:816
    v_pk_mul_f32 v[36:37], v[34:35], v[26:27] op_sel_hi:[0,1]
    v_pk_fma_f32 v[34:35], v[34:35], v[26:27], v[36:37] op_sel:[1,1,0] op_sel_hi:[1,0,1] neg_lo:[0,1,0]
    v_cvt_pk_bf16_f32 v38, v34, -v35
    ds_write_b32 v18, v38 offset:1088
    v_pk_mul_f32 v[36:37], v[34:35], v[26:27] op_sel_hi:[0,1]
    v_pk_fma_f32 v[34:35], v[34:35], v[26:27], v[36:37] op_sel:[1,1,0] op_sel_hi:[1,0,1] neg_lo:[0,1,0]
    v_cvt_pk_bf16_f32 v39, v34, -v35
    ds_write_b32 v18, v39 offset:1360
    v_pk_mul_f32 v[36:37], v[34:35], v[26:27] op_sel_hi:[0,1]
    v_pk_fma_f32 v[34:35], v[34:35], v[26:27], v[36:37] op_sel:[1,1,0] op_sel_hi:[1,0,1] neg_lo:[0,1,0]
    v_cvt_pk_bf16_f32 v38, v34, -v35
    ds_write_b32 v18, v38 offset:1632
    v_pk_mul_f32 v[36:37], v[34:35], v[26:27] op_sel_hi:[0,1]
    v_pk_fma_f32 v[34:35], v[34:35], v[26:27], v[36:37] op_sel:[1,1,0] op_sel_hi:[1,0,1] neg_lo:[0,1,0]
    v_cvt_pk_bf16_f32 v39, v34, -v35
    ds_write_b32 v18, v39 offset:1904
    v_pk_mul_f32 v[36:37], v[34:35], v[26:27] op_sel_hi:[0,1]
    v_pk_fma_f32 v[34:35], v[34:35], v[26:27], v[36:37] op_sel:[1,1,0] op_sel_hi:[1,0,1] neg_lo:[0,1,0]
    v_cvt_pk_bf16_f32 v38, v34, -v35
    ds_write_b32 v18, v38 offset:2176
    v_pk_mul_f32 v[36:37], v[34:35], v[26:27] op_sel_hi:[0,1]
    v_pk_fma_f32 v[34:35], v[34:35], v[26:27], v[36:37] op_sel:[1,1,0] op_sel_hi:[1,0,1] neg_lo:[0,1,0]
    v_cvt_pk_bf16_f32 v39, v34, -v35
    ds_write_b32 v18, v39 offset:2448
    v_pk_mul_f32 v[36:37], v[34:35], v[26:27] op_sel_hi:[0,1]
    v_pk_fma_f32 v[34:35], v[34:35], v[26:27], v[36:37] op_sel:[1,1,0] op_sel_hi:[1,0,1] neg_lo:[0,1,0]
    v_cvt_pk_bf16_f32 v38, v34, -v35
    ds_write_b32 v18, v38 offset:2720
    v_pk_mul_f32 v[36:37], v[34:35], v[26:27] op_sel_hi:[0,1]
    v_pk_fma_f32 v[34:35], v[34:35], v[26:27], v[36:37] op_sel:[1,1,0] op_sel_hi:[1,0,1] neg_lo:[0,1,0]
    v_cvt_pk_bf16_f32 v39, v34, -v35
    ds_write_b32 v18, v39 offset:2992
    v_pk_mul_f32 v[36:37], v[34:35], v[26:27] op_sel_hi:[0,1]
    v_pk_fma_f32 v[34:35], v[34:35], v[26:27], v[36:37] op_sel:[1,1,0] op_sel_hi:[1,0,1] neg_lo:[0,1,0]
    v_cvt_pk_bf16_f32 v38, v34, -v35
    ds_write_b32 v18, v38 offset:3264
    v_pk_mul_f32 v[36:37], v[34:35], v[26:27] op_sel_hi:[0,1]
    v_pk_fma_f32 v[34:35], v[34:35], v[26:27], v[36:37] op_sel:[1,1,0] op_sel_hi:[1,0,1] neg_lo:[0,1,0]
    v_cvt_pk_bf16_f32 v39, v34, -v35
    ds_write_b32 v18, v39 offset:3536
    v_pk_mul_f32 v[36:37], v[34:35], v[26:27] op_sel_hi:[0,1]
    v_pk_fma_f32 v[34:35], v[34:35], v[26:27], v[36:37] op_sel:[1,1,0] op_sel_hi:[1,0,1] neg_lo:[0,1,0]
    v_cvt_pk_bf16_f32 v38, v34, -v35
    ds_write_b32 v18, v38 offset:3808
    buffer_load_dwordx2 v[136:137], v62, s[8:11], s46 offen offset:0
    v_pk_mul_f32 v[36:37], v[34:35], v[26:27] op_sel_hi:[0,1]
    v_pk_fma_f32 v[34:35], v[34:35], v[26:27], v[36:37] op_sel:[1,1,0] op_sel_hi:[1,0,1] neg_lo:[0,1,0]
    v_cvt_pk_bf16_f32 v39, v34, -v35
    ds_write_b32 v18, v39 offset:4080
    v_pk_mul_f32 v[36:37], v[34:35], v[26:27] op_sel_hi:[0,1]
    v_pk_fma_f32 v[34:35], v[34:35], v[26:27], v[36:37] op_sel:[1,1,0] op_sel_hi:[1,0,1] neg_lo:[0,1,0]
    v_cvt_pk_bf16_f32 v38, v34, -v35
    ds_write_b32 v18, v38 offset:4352
    v_pk_mul_f32 v[36:37], v[34:35], v[26:27] op_sel_hi:[0,1]
    v_pk_fma_f32 v[34:35], v[34:35], v[26:27], v[36:37] op_sel:[1,1,0] op_sel_hi:[1,0,1] neg_lo:[0,1,0]
    v_cvt_pk_bf16_f32 v39, v34, -v35
    ds_write_b32 v18, v39 offset:4624
    v_pk_mul_f32 v[36:37], v[34:35], v[26:27] op_sel_hi:[0,1]
    v_pk_fma_f32 v[34:35], v[34:35], v[26:27], v[36:37] op_sel:[1,1,0] op_sel_hi:[1,0,1] neg_lo:[0,1,0]
    v_cvt_pk_bf16_f32 v38, v34, -v35
    ds_write_b32 v18, v38 offset:4896
    v_pk_mul_f32 v[36:37], v[34:35], v[26:27] op_sel_hi:[0,1]
    v_pk_fma_f32 v[34:35], v[34:35], v[26:27], v[36:37] op_sel:[1,1,0] op_sel_hi:[1,0,1] neg_lo:[0,1,0]
    v_cvt_pk_bf16_f32 v39, v34, -v35
    ds_write_b32 v18, v39 offset:5168
    v_pk_mul_f32 v[36:37], v[34:35], v[26:27] op_sel_hi:[0,1]
    v_pk_fma_f32 v[34:35], v[34:35], v[26:27], v[36:37] op_sel:[1,1,0] op_sel_hi:[1,0,1] neg_lo:[0,1,0]
    v_cvt_pk_bf16_f32 v38, v34, -v35
    ds_write_b32 v18, v38 offset:5440
    v_pk_mul_f32 v[36:37], v[34:35], v[26:27] op_sel_hi:[0,1]
    v_pk_fma_f32 v[34:35], v[34:35], v[26:27], v[36:37] op_sel:[1,1,0] op_sel_hi:[1,0,1] neg_lo:[0,1,0]
    v_cvt_pk_bf16_f32 v39, v34, -v35
    ds_write_b32 v18, v39 offset:5712
    v_pk_mul_f32 v[36:37], v[34:35], v[26:27] op_sel_hi:[0,1]
    v_pk_fma_f32 v[34:35], v[34:35], v[26:27], v[36:37] op_sel:[1,1,0] op_sel_hi:[1,0,1] neg_lo:[0,1,0]
    v_cvt_pk_bf16_f32 v38, v34, -v35
    ds_write_b32 v18, v38 offset:5984
    v_pk_mul_f32 v[36:37], v[34:35], v[26:27] op_sel_hi:[0,1]
    v_pk_fma_f32 v[34:35], v[34:35], v[26:27], v[36:37] op_sel:[1,1,0] op_sel_hi:[1,0,1] neg_lo:[0,1,0]
    v_cvt_pk_bf16_f32 v39, v34, -v35
    ds_write_b32 v18, v39 offset:6256
    v_pk_mul_f32 v[36:37], v[34:35], v[26:27] op_sel_hi:[0,1]
    v_pk_fma_f32 v[34:35], v[34:35], v[26:27], v[36:37] op_sel:[1,1,0] op_sel_hi:[1,0,1] neg_lo:[0,1,0]
    v_cvt_pk_bf16_f32 v38, v34, -v35
    ds_write_b32 v18, v38 offset:6528
    v_pk_mul_f32 v[36:37], v[34:35], v[26:27] op_sel_hi:[0,1]
    v_pk_fma_f32 v[34:35], v[34:35], v[26:27], v[36:37] op_sel:[1,1,0] op_sel_hi:[1,0,1] neg_lo:[0,1,0]
    v_cvt_pk_bf16_f32 v39, v34, -v35
    ds_write_b32 v18, v39 offset:6800
    v_pk_mul_f32 v[36:37], v[34:35], v[26:27] op_sel_hi:[0,1]
    v_pk_fma_f32 v[34:35], v[34:35], v[26:27], v[36:37] op_sel:[1,1,0] op_sel_hi:[1,0,1] neg_lo:[0,1,0]
    v_cvt_pk_bf16_f32 v38, v34, -v35
    ds_write_b32 v18, v38 offset:7072
    buffer_load_dwordx2 v[138:139], v62, s[8:11], s46 offen offset:1280
    v_pk_mul_f32 v[36:37], v[34:35], v[26:27] op_sel_hi:[0,1]
    v_pk_fma_f32 v[34:35], v[34:35], v[26:27], v[36:37] op_sel:[1,1,0] op_sel_hi:[1,0,1] neg_lo:[0,1,0]
    v_cvt_pk_bf16_f32 v39, v34, -v35
    ds_write_b32 v18, v39 offset:7344
    v_pk_mul_f32 v[36:37], v[34:35], v[26:27] op_sel_hi:[0,1]
    v_pk_fma_f32 v[34:35], v[34:35], v[26:27], v[36:37] op_sel:[1,1,0] op_sel_hi:[1,0,1] neg_lo:[0,1,0]
    v_cvt_pk_bf16_f32 v38, v34, -v35
    ds_write_b32 v18, v38 offset:7616
    v_pk_mul_f32 v[36:37], v[34:35], v[26:27] op_sel_hi:[0,1]
    v_pk_fma_f32 v[34:35], v[34:35], v[26:27], v[36:37] op_sel:[1,1,0] op_sel_hi:[1,0,1] neg_lo:[0,1,0]
    v_cvt_pk_bf16_f32 v39, v34, -v35
    ds_write_b32 v18, v39 offset:7888
    v_pk_mul_f32 v[36:37], v[34:35], v[26:27] op_sel_hi:[0,1]
    v_pk_fma_f32 v[34:35], v[34:35], v[26:27], v[36:37] op_sel:[1,1,0] op_sel_hi:[1,0,1] neg_lo:[0,1,0]
    v_cvt_pk_bf16_f32 v38, v34, -v35
    ds_write_b32 v18, v38 offset:8160
    v_pk_mul_f32 v[36:37], v[34:35], v[26:27] op_sel_hi:[0,1]
    v_pk_fma_f32 v[34:35], v[34:35], v[26:27], v[36:37] op_sel:[1,1,0] op_sel_hi:[1,0,1] neg_lo:[0,1,0]
    v_cvt_pk_bf16_f32 v39, v34, -v35
    ds_write_b32 v18, v39 offset:8432
    ds_read_b128 v[64:67], v5 offset:0
    ds_read_b128 v[68:71], v5 offset:32
    ds_read_b128 v[72:75], v5 offset:64
    ds_read_b128 v[76:79], v5 offset:96
    ds_read_b128 v[80:83], v5 offset:128
    ds_read_b128 v[84:87], v5 offset:160
    ds_read_b128 v[88:91], v5 offset:192
    ds_read_b128 v[92:95], v5 offset:224
    v_pk_mul_f32 v[36:37], v[14:15], v[12:13] op_sel_hi:[0,1]
    v_pk_fma_f32 v[30:31], v[14:15], v[12:13], v[36:37] op_sel:[1,1,0] op_sel_hi:[1,0,1] neg_lo:[0,1,0]
    v_mul_f32 v30, v6, v30
    v_mul_f32 v31, v6, v31
    v_cvt_pk_bf16_f32 v38, v30, v31
    ds_write_b32 v18, v38 offset:0
    v_pk_mul_f32 v[36:37], v[30:31], v[20:21] op_sel_hi:[0,1]
    v_pk_fma_f32 v[34:35], v[30:31], v[20:21], v[36:37] op_sel:[1,1,0] op_sel_hi:[1,0,1] neg_lo:[0,1,0]
    v_cvt_pk_bf16_f32 v39, v34, v35
    ds_write_b32 v18, v39 offset:272
    v_pk_mul_f32 v[36:37], v[34:35], v[20:21] op_sel_hi:[0,1]
    v_pk_fma_f32 v[34:35], v[34:35], v[20:21], v[36:37] op_sel:[1,1,0] op_sel_hi:[1,0,1] neg_lo:[0,1,0]
    v_cvt_pk_bf16_f32 v38, v34, v35
    ds_write_b32 v18, v38 offset:544
    v_pk_mul_f32 v[36:37], v[34:35], v[20:21] op_sel_hi:[0,1]
    v_pk_fma_f32 v[34:35], v[34:35], v[20:21], v[36:37] op_sel:[1,1,0] op_sel_hi:[1,0,1] neg_lo:[0,1,0]
    v_cvt_pk_bf16_f32 v39, v34, v35
    ds_write_b32 v18, v39 offset:816
    v_pk_mul_f32 v[36:37], v[34:35], v[20:21] op_sel_hi:[0,1]
    v_pk_fma_f32 v[34:35], v[34:35], v[20:21], v[36:37] op_sel:[1,1,0] op_sel_hi:[1,0,1] neg_lo:[0,1,0]
    v_cvt_pk_bf16_f32 v38, v34, v35
    ds_write_b32 v18, v38 offset:1088
    v_pk_mul_f32 v[36:37], v[34:35], v[20:21] op_sel_hi:[0,1]
    v_pk_fma_f32 v[34:35], v[34:35], v[20:21], v[36:37] op_sel:[1,1,0] op_sel_hi:[1,0,1] neg_lo:[0,1,0]
    v_cvt_pk_bf16_f32 v39, v34, v35
    ds_write_b32 v18, v39 offset:1360
    v_pk_mul_f32 v[36:37], v[34:35], v[20:21] op_sel_hi:[0,1]
    v_pk_fma_f32 v[34:35], v[34:35], v[20:21], v[36:37] op_sel:[1,1,0] op_sel_hi:[1,0,1] neg_lo:[0,1,0]
    v_cvt_pk_bf16_f32 v38, v34, v35
    ds_write_b32 v18, v38 offset:1632
    v_pk_mul_f32 v[36:37], v[34:35], v[20:21] op_sel_hi:[0,1]
    v_pk_fma_f32 v[34:35], v[34:35], v[20:21], v[36:37] op_sel:[1,1,0] op_sel_hi:[1,0,1] neg_lo:[0,1,0]
    v_cvt_pk_bf16_f32 v39, v34, v35
    ds_write_b32 v18, v39 offset:1904
    v_pk_mul_f32 v[36:37], v[30:31], v[28:29] op_sel_hi:[0,1]
    v_pk_fma_f32 v[32:33], v[30:31], v[28:29], v[36:37] op_sel:[1,1,0] op_sel_hi:[1,0,1] neg_lo:[0,1,0]
    v_cvt_pk_bf16_f32 v38, v32, v33
    ds_write_b32 v18, v38 offset:2176
    v_pk_mul_f32 v[36:37], v[32:33], v[22:23] op_sel_hi:[0,1]
    v_pk_fma_f32 v[34:35], v[32:33], v[22:23], v[36:37] op_sel:[1,1,0] op_sel_hi:[1,0,1] neg_lo:[0,1,0]
    v_cvt_pk_bf16_f32 v39, v34, v35
    ds_write_b32 v18, v39 offset:2448
    buffer_load_dwordx2 v[140:141], v62, s[8:11], s47 offen offset:0
    v_pk_mul_f32 v[36:37], v[34:35], v[22:23] op_sel_hi:[0,1]
    v_pk_fma_f32 v[34:35], v[34:35], v[22:23], v[36:37] op_sel:[1,1,0] op_sel_hi:[1,0,1] neg_lo:[0,1,0]
    v_cvt_pk_bf16_f32 v38, v34, v35
    ds_write_b32 v18, v38 offset:2720
    ds_write_b32 v18, v38 offset:3264
    v_pk_mul_f32 v[36:37], v[34:35], v[22:23] op_sel_hi:[0,1]
    v_pk_fma_f32 v[34:35], v[34:35], v[22:23], v[36:37] op_sel:[1,1,0] op_sel_hi:[1,0,1] neg_lo:[0,1,0]
    v_cvt_pk_bf16_f32 v39, v34, v35
    ds_write_b32 v18, v39 offset:3536
    v_pk_mul_f32 v[36:37], v[34:35], v[22:23] op_sel_hi:[0,1]
    v_pk_fma_f32 v[34:35], v[34:35], v[22:23], v[36:37] op_sel:[1,1,0] op_sel_hi:[1,0,1] neg_lo:[0,1,0]
    v_cvt_pk_bf16_f32 v38, v34, v35
    ds_write_b32 v18, v38 offset:3808
    v_pk_mul_f32 v[36:37], v[32:33], v[28:29] op_sel_hi:[0,1]
    v_pk_fma_f32 v[32:33], v[32:33], v[28:29], v[36:37] op_sel:[1,1,0] op_sel_hi:[1,0,1] neg_lo:[0,1,0]
    v_cvt_pk_bf16_f32 v39, v32, v33
    ds_write_b32 v18, v39 offset:4352
    v_pk_mul_f32 v[36:37], v[32:33], v[24:25] op_sel_hi:[0,1]
    v_pk_fma_f32 v[34:35], v[32:33], v[24:25], v[36:37] op_sel:[1,1,0] op_sel_hi:[1,0,1] neg_lo:[0,1,0]
    v_cvt_pk_bf16_f32 v38, v34, v35
    ds_write_b32 v18, v38 offset:4624
    v_pk_mul_f32 v[36:37], v[32:33], v[28:29] op_sel_hi:[0,1]
    v_pk_fma_f32 v[32:33], v[32:33], v[28:29], v[36:37] op_sel:[1,1,0] op_sel_hi:[1,0,1] neg_lo:[0,1,0]
    v_cvt_pk_bf16_f32 v39, v32, v33
    ds_write_b32 v18, v39 offset:5440
    v_pk_mul_f32 v[36:37], v[32:33], v[24:25] op_sel_hi:[0,1]
    v_pk_fma_f32 v[34:35], v[32:33], v[24:25], v[36:37] op_sel:[1,1,0] op_sel_hi:[1,0,1] neg_lo:[0,1,0]
    v_cvt_pk_bf16_f32 v38, v34, v35
    ds_write_b32 v18, v38 offset:5712
    v_pk_mul_f32 v[36:37], v[34:35], v[24:25] op_sel_hi:[0,1]
    v_pk_fma_f32 v[34:35], v[34:35], v[24:25], v[36:37] op_sel:[1,1,0] op_sel_hi:[1,0,1] neg_lo:[0,1,0]
    v_cvt_pk_bf16_f32 v39, v34, v35
    ds_write_b32 v18, v39 offset:5984
    v_pk_mul_f32 v[36:37], v[32:33], v[28:29] op_sel_hi:[0,1]
    v_pk_fma_f32 v[32:33], v[32:33], v[28:29], v[36:37] op_sel:[1,1,0] op_sel_hi:[1,0,1] neg_lo:[0,1,0]
    v_cvt_pk_bf16_f32 v38, v32, v33
    ds_write_b32 v18, v38 offset:6528
    v_pk_mul_f32 v[36:37], v[32:33], v[28:29] op_sel_hi:[0,1]
    v_pk_fma_f32 v[32:33], v[32:33], v[28:29], v[36:37] op_sel:[1,1,0] op_sel_hi:[1,0,1] neg_lo:[0,1,0]
    v_cvt_pk_bf16_f32 v39, v32, v33
    ds_write_b32 v18, v39 offset:6800
    v_pk_mul_f32 v[36:37], v[32:33], v[28:29] op_sel_hi:[0,1]
    v_pk_fma_f32 v[32:33], v[32:33], v[28:29], v[36:37] op_sel:[1,1,0] op_sel_hi:[1,0,1] neg_lo:[0,1,0]
    v_cvt_pk_bf16_f32 v38, v32, v33
    ds_write_b32 v18, v38 offset:7616
    v_pk_mul_f32 v[36:37], v[32:33], v[28:29] op_sel_hi:[0,1]
    v_pk_fma_f32 v[32:33], v[32:33], v[28:29], v[36:37] op_sel:[1,1,0] op_sel_hi:[1,0,1] neg_lo:[0,1,0]
    v_cvt_pk_bf16_f32 v39, v32, v33
    ds_write_b32 v18, v39 offset:7888
    v_pk_mul_f32 v[36:37], v[32:33], v[28:29] op_sel_hi:[0,1]
    v_pk_fma_f32 v[32:33], v[32:33], v[28:29], v[36:37] op_sel:[1,1,0] op_sel_hi:[1,0,1] neg_lo:[0,1,0]
    v_cvt_pk_bf16_f32 v38, v32, v33
    ds_write_b32 v18, v38 offset:8160
    ds_read_b128 v[96:99], v5 offset:0
    ds_read_b128 v[100:103], v5 offset:32
    ds_read_b128 v[104:107], v5 offset:64
    ds_read_b128 v[108:111], v5 offset:96
    ds_read_b128 v[112:115], v5 offset:128
    ds_read_b128 v[116:119], v5 offset:160
    ds_read_b128 v[120:123], v5 offset:192
    ds_read_b128 v[124:127], v5 offset:224
    buffer_load_dwordx2 v[142:143], v62, s[8:11], s47 offen offset:1280
    s_waitcnt lgkmcnt(7)
    v_mfma_f32_32x32x16_bf16 v[44:59], v[96:99], v[64:67], 0
    s_waitcnt lgkmcnt(6)
    v_mfma_f32_32x32x16_bf16 v[44:59], v[100:103], v[68:71], v[44:59]
    s_waitcnt lgkmcnt(5)
    v_mfma_f32_32x32x16_bf16 v[44:59], v[104:107], v[72:75], v[44:59]
    s_waitcnt lgkmcnt(4)
    v_mfma_f32_32x32x16_bf16 v[44:59], v[108:111], v[76:79], v[44:59]
    s_waitcnt lgkmcnt(3)
    v_mfma_f32_32x32x16_bf16 v[44:59], v[112:115], v[80:83], v[44:59]
    s_waitcnt lgkmcnt(2)
    v_mfma_f32_32x32x16_bf16 v[44:59], v[116:119], v[84:87], v[44:59]
    s_waitcnt lgkmcnt(1)
    v_mfma_f32_32x32x16_bf16 v[44:59], v[120:123], v[88:91], v[44:59]
    s_waitcnt lgkmcnt(0)
    v_mfma_f32_32x32x16_bf16 v[44:59], v[124:127], v[92:95], v[44:59]
    v_lshlrev_b32 v7, 4, v1
    v_add_u32 v7, s29, v7
    v_mov_b32 v8, 1
    s_mov_b32 s50, 0x0c0c0400
    s_mov_b32 s51, 0x04000c0c
    s_nop 7
    s_nop 1
    ds_write_b128 v7, v[44:47] offset:0
    ds_write_b128 v7, v[48:51] offset:1024
    ds_write_b128 v7, v[52:55] offset:2048
    ds_write_b128 v7, v[56:59] offset:3072
    ds_write_b32 v60, v8
    buffer_load_dwordx3 v[40:42], off, s[36:39], 0 sc1
    s_lshl_b32 s27, s40, 12
    s_nop 0
    buffer_load_dwordx4 v[144:147], v63, s[12:15], s27 offen sc1
    s_lshl_b32 s27, s41, 12
    s_nop 0
    buffer_load_dwordx4 v[148:151], v63, s[12:15], s27 offen sc1
    s_lshl_b32 s27, s42, 12
    s_nop 0
    buffer_load_dwordx4 v[152:155], v63, s[12:15], s27 offen sc1
    s_lshl_b32 s27, s43, 12
    s_nop 0
    buffer_load_dwordx4 v[156:159], v63, s[12:15], s27 offen sc1
    v_lshlrev_b32 v7, 3, v0
    v_add_u32 v7, 84480, v7
    s_lshl_b32 s27, s40, 11
    v_add_u32 v24, s27, v7
    s_lshl_b32 s27, s41, 11
    v_add_u32 v25, s27, v7
    s_lshl_b32 s27, s42, 11
    v_add_u32 v26, s27, v7
    s_lshl_b32 s27, s43, 11
    v_add_u32 v27, s27, v7
    s_waitcnt vmcnt(5)
    v_lshlrev_b32 v160, 16, v128
    v_and_b32 v162, 0xffff0000, v128
    v_lshlrev_b32 v164, 16, v129
    v_and_b32 v166, 0xffff0000, v129
    v_lshlrev_b32 v161, 16, v130
    v_and_b32 v163, 0xffff0000, v130
    v_lshlrev_b32 v165, 16, v131
    v_and_b32 v167, 0xffff0000, v131
    v_lshlrev_b32 v168, 16, v132
    v_and_b32 v170, 0xffff0000, v132
    v_lshlrev_b32 v172, 16, v133
    v_and_b32 v174, 0xffff0000, v133
    v_lshlrev_b32 v169, 16, v134
    v_and_b32 v171, 0xffff0000, v134
    v_lshlrev_b32 v173, 16, v135
    v_and_b32 v175, 0xffff0000, v135
    v_lshlrev_b32 v176, 16, v136
    v_and_b32 v178, 0xffff0000, v136
    v_lshlrev_b32 v180, 16, v137
    v_and_b32 v182, 0xffff0000, v137
    v_lshlrev_b32 v177, 16, v138
    v_and_b32 v179, 0xffff0000, v138
    v_lshlrev_b32 v181, 16, v139
    v_and_b32 v183, 0xffff0000, v139
    v_lshlrev_b32 v184, 16, v140
    v_and_b32 v186, 0xffff0000, v140
    v_lshlrev_b32 v188, 16, v141
    v_and_b32 v190, 0xffff0000, v141
    v_lshlrev_b32 v185, 16, v142
    v_and_b32 v187, 0xffff0000, v142
    v_lshlrev_b32 v189, 16, v143
    v_and_b32 v191, 0xffff0000, v143
    ds_write_b64 v24, v[160:161] offset:0
    ds_write_b64 v24, v[162:163] offset:8192
    ds_write_b64 v24, v[164:165] offset:16384
    ds_write_b64 v24, v[166:167] offset:24576
    ds_write_b64 v25, v[168:169] offset:0
    ds_write_b64 v25, v[170:171] offset:8192
    ds_write_b64 v25, v[172:173] offset:16384
    ds_write_b64 v25, v[174:175] offset:24576
    ds_write_b64 v26, v[176:177] offset:0
    ds_write_b64 v26, v[178:179] offset:8192
    ds_write_b64 v26, v[180:181] offset:16384
    ds_write_b64 v26, v[182:183] offset:24576
    ds_write_b64 v27, v[184:185] offset:0
    ds_write_b64 v27, v[186:187] offset:8192
    ds_write_b64 v27, v[188:189] offset:16384
    ds_write_b64 v27, v[190:191] offset:24576
    s_mov_b64 exec, 1
    ds_add_u32 v19, v8 offset:16
    s_mov_b64 exec, -1
    v_lshlrev_b32 v7, 2, v0
    v_add_u32 v7, 544, v7
    s_lshl_b32 s27, s40, 10
    v_add_u32 v20, s27, v7
    s_lshl_b32 s27, s41, 10
    v_add_u32 v21, s27, v7
    s_lshl_b32 s27, s42, 10
    v_add_u32 v22, s27, v7
    s_lshl_b32 s27, s43, 10
    v_add_u32 v23, s27, v7
    s_mov_b32 s48, 0
    s_waitcnt vmcnt(0)
S_GP:
    v_perm_b32 v10, v145, v144, s50
    v_perm_b32 v11, v147, v146, s51
    v_or_b32 v10, v10, v11
    v_xor_b32 v12, v10, v40
    v_perm_b32 v10, v149, v148, s50
    v_perm_b32 v11, v151, v150, s51
    v_or_b32 v10, v10, v11
    v_xor_b32 v13, v10, v40
    v_or_b32 v12, v12, v13
    v_perm_b32 v10, v153, v152, s50
    v_perm_b32 v11, v155, v154, s51
    v_or_b32 v10, v10, v11
    v_xor_b32 v13, v10, v40
    v_or_b32 v12, v12, v13
    v_perm_b32 v10, v157, v156, s50
    v_perm_b32 v11, v159, v158, s51
    v_or_b32 v10, v10, v11
    v_xor_b32 v13, v10, v40
    v_or_b32 v12, v12, v13
    v_not_b32 v13, v40
    v_and_or_b32 v12, v13, 1, v12
    v_cmp_ne_u32 vcc, 0, v12
    s_add_u32 s48, s48, 1
    s_cbranch_vccz S_GOK
    buffer_load_dwordx3 v[40:42], off, s[36:39], 0 sc1
    s_lshl_b32 s27, s40, 12
    s_nop 0
    buffer_load_dwordx4 v[144:147], v63, s[12:15], s27 offen sc1
    s_lshl_b32 s27, s41, 12
    s_nop 0
    buffer_load_dwordx4 v[148:151], v63, s[12:15], s27 offen sc1
    s_lshl_b32 s27, s42, 12
    s_nop 0
    buffer_load_dwordx4 v[152:155], v63, s[12:15], s27 offen sc1
    s_lshl_b32 s27, s43, 12
    s_nop 0
    buffer_load_dwordx4 v[156:159], v63, s[12:15], s27 offen sc1
    s_cmp_lt_u32 s48, 262144
    s_waitcnt vmcnt(0)
    s_cbranch_scc1 S_GP
S_GOK:
    v_and_b32 v144, 0xffffff00, v144
    v_and_b32 v145, 0xffffff00, v145
    v_and_b32 v146, 0xffffff00, v146
    v_and_b32 v147, 0xffffff00, v147
    v_pk_fma_f32 v[64:65], v[160:161], v[144:145], v[146:147]
    v_cvt_pk_bf16_f32 v96, v64, v65
    ds_write_b32 v20, v96 offset:0
    v_pk_fma_f32 v[66:67], v[162:163], v[144:145], v[146:147]
    v_cvt_pk_bf16_f32 v100, v66, v67
    ds_write_b32 v20, v100 offset:4640
    v_pk_fma_f32 v[68:69], v[164:165], v[144:145], v[146:147]
    v_cvt_pk_bf16_f32 v104, v68, v69
    ds_write_b32 v20, v104 offset:9280
    v_pk_fma_f32 v[70:71], v[166:167], v[144:145], v[146:147]
    v_cvt_pk_bf16_f32 v108, v70, v71
    ds_write_b32 v20, v108 offset:13920
    v_and_b32 v148, 0xffffff00, v148
    v_and_b32 v149, 0xffffff00, v149
    v_and_b32 v150, 0xffffff00, v150
    v_and_b32 v151, 0xffffff00, v151
    v_pk_fma_f32 v[72:73], v[168:169], v[148:149], v[150:151]
    v_cvt_pk_bf16_f32 v97, v72, v73
    ds_write_b32 v21, v97 offset:0
    v_pk_fma_f32 v[74:75], v[170:171], v[148:149], v[150:151]
    v_cvt_pk_bf16_f32 v101, v74, v75
    ds_write_b32 v21, v101 offset:4640
    v_pk_fma_f32 v[76:77], v[172:173], v[148:149], v[150:151]
    v_cvt_pk_bf16_f32 v105, v76, v77
    ds_write_b32 v21, v105 offset:9280
    v_pk_fma_f32 v[78:79], v[174:175], v[148:149], v[150:151]
    v_cvt_pk_bf16_f32 v109, v78, v79
    ds_write_b32 v21, v109 offset:13920
    v_and_b32 v152, 0xffffff00, v152
    v_and_b32 v153, 0xffffff00, v153
    v_and_b32 v154, 0xffffff00, v154
    v_and_b32 v155, 0xffffff00, v155
    v_pk_fma_f32 v[80:81], v[176:177], v[152:153], v[154:155]
    v_cvt_pk_bf16_f32 v98, v80, v81
    ds_write_b32 v22, v98 offset:0
    v_pk_fma_f32 v[82:83], v[178:179], v[152:153], v[154:155]
    v_cvt_pk_bf16_f32 v102, v82, v83
    ds_write_b32 v22, v102 offset:4640
    v_pk_fma_f32 v[84:85], v[180:181], v[152:153], v[154:155]
    v_cvt_pk_bf16_f32 v106, v84, v85
    ds_write_b32 v22, v106 offset:9280
    v_pk_fma_f32 v[86:87], v[182:183], v[152:153], v[154:155]
    v_cvt_pk_bf16_f32 v110, v86, v87
    ds_write_b32 v22, v110 offset:13920
    v_and_b32 v156, 0xffffff00, v156
    v_and_b32 v157, 0xffffff00, v157
    v_and_b32 v158, 0xffffff00, v158
    v_and_b32 v159, 0xffffff00, v159
    v_pk_fma_f32 v[88:89], v[184:185], v[156:157], v[158:159]
    v_cvt_pk_bf16_f32 v99, v88, v89
    ds_write_b32 v23, v99 offset:0
    v_pk_fma_f32 v[90:91], v[186:187], v[156:157], v[158:159]
    v_cvt_pk_bf16_f32 v103, v90, v91
    ds_write_b32 v23, v103 offset:4640
    v_pk_fma_f32 v[92:93], v[188:189], v[156:157], v[158:159]
    v_cvt_pk_bf16_f32 v107, v92, v93
    ds_write_b32 v23, v107 offset:9280
    v_pk_fma_f32 v[94:95], v[190:191], v[156:157], v[158:159]
    v_cvt_pk_bf16_f32 v111, v94, v95
    ds_write_b32 v23, v111 offset:13920
    s_waitcnt lgkmcnt(0)
    s_barrier
    v_readfirstlane_b32 s49, v42
    s_cmp_lg_u32 s49, 0
    s_cbranch_scc1 M_FFN_L
    s_mov_b32 s48, 0
S_ZC:
    buffer_load_dword v9, off, s[36:39], 0 offset:8 sc1
    s_add_u32 s48, s48, 1
    s_waitcnt vmcnt(0)
    v_readfirstlane_b32 s49, v9
    s_cmp_lg_u32 s49, 0
    s_cbranch_scc1 S_ZC_OK
    s_sleep 2
    s_cmp_lt_u32 s48, 262144
    s_cbranch_scc1 S_ZC
S_ZC_OK:
    s_branch M_FFN_L
M_C:
    s_mul_i32 s27, s25, 8704
    s_add_u32 s27, s27, 24576
    s_mov_b32 m0, s27
    s_mov_b32 s36, s80
    s_and_b32 s37, s81, 0xffff
    s_mov_b32 s38, 256
    s_mov_b32 s39, 0x20000
    v_and_b32 v3, 31, v1
    v_lshrrev_b32 v4, 5, v1
    v_mul_u32_u24 v5, 272, v3
    v_lshl_add_u32 v5, v4, 4, v5
    v_add_u32 v5, s27, v5
    s_mul_i32 s30, s25, 6272
    s_add_u32 s30, s30, 59392
    s_mul_i32 s31, s25, 4640
    s_add_u32 s31, s31, 0
    v_lshlrev_b32 v7, 4, v1
    v_min_u32 v8, 528, v7
    v_add_u32 v8, s31, v8
    v_mov_b32 v44, 0
    v_mov_b32 v45, 0
    v_mov_b32 v46, 0
    v_mov_b32 v47, 0
    ds_write_b128 v8, v[44:47]
    v_add_u32 v8, s30, v7
    ds_write_b128 v8, v[44:47] offset:0
    ds_write_b128 v8, v[44:47] offset:1024
    ds_write_b128 v8, v[44:47] offset:2048
    ds_write_b128 v8, v[44:47] offset:3072
    ds_write_b128 v8, v[44:47] offset:4096
    ds_write_b128 v8, v[44:47] offset:5120
    ds_write_b128 v8, v[44:47] offset:5248
    s_add_u32 s16, s4, 12582912
    s_addc_u32 s17, s5, 0
    s_and_b32 s17, s17, 0xffff
    s_mov_b32 s18, 2621440
    s_mov_b32 s19, 0x20000
    v_lshlrev_b32 v9, 4, v3
    v_lshl_add_u32 v10, v4, 3, v9
    s_add_u32 s27, s30, 568
    v_sub_u32 v210, s27, v10
    v_lshlrev_b32 v10, 2, v1
    s_add_u32 s27, s30, 5756
    v_sub_u32 v211, s27, v10
    v_lshrrev_b32 v10, 1, v3
    v_lshlrev_b32 v10, 2, v10
    v_lshl_add_u32 v10, v4, 7, v10
    v_and_b32 v11, 1, v3
    v_lshlrev_b32 v11, 1, v11
    v_sub_u32 v10, v11, v10
    s_add_u32 s27, s30, 6140
    v_add_u32 v212, s27, v10
    s_lshl_b32 s27, s25, 2
PADA0:
    s_cbranch_execz PADA1
    s_nop 0
    s_add_u32 s27, s27, 20480
    v_mov_b32 v60, s27
    s_mul_i32 s27, s25, 8704
    s_add_u32 s27, s27, 117248
    v_add_u32 v61, s27, v7
    v_mov_b32 v213, s30
    v_and_b32 v13, 15, v1
    v_lshrrev_b32 v9, 4, v1
    v_lshlrev_b32 v14, 4, v9
    v_sub_u32 v10, 3, v13
    v_and_b32 v10, 3, v10
    v_mul_u32_u24 v10, 1344, v10
    v_lshrrev_b32 v11, 2, v13
    v_lshlrev_b32 v11, 3, v11
    v_sub_u32 v10, v10, v11
    v_sub_u32 v10, v10, v14
    s_add_u32 s27, s30, 72
    v_add_u32 v224, s27, v10
    v_lshlrev_b32 v10, 5, v13
    v_sub_u32 v11, v10, v14
    s_add_u32 s27, s31, 112
    v_add_u32 v225, s27, v11
    v_add3_u32 v227, v10, v14, s31
    v_lshl_add_u32 v11, v13, 4, v14
    s_add_u32 s27, s31, 256
    v_add_u32 v226, s27, v11
    v_lshlrev_b32 v10, 3, v13
    v_sub_u32 v10, v14, v10
    s_add_u32 s27, s30, 5496
    v_add_u32 v231, s27, v10
    v_lshlrev_b32 v10, 2, v13
    v_sub_u32 v10, v14, v10
    s_add_u32 s27, s30, 5948
    v_add_u32 v248, s27, v10
    v_lshlrev_b32 v10, 6, v13
    v_add_u32 v10, v10, v14
    s_lshl_b32 s27, s25, 13
    s_add_u32 s27, s27, 84480
    v_add_u32 v229, s27, v10
    v_mov_b32 v230, 20480
    s_waitcnt lgkmcnt(0)
    s_and_b32 s23, s26, 1
    s_lshl_b32 s23, s23, 4
    s_lshr_b32 s28, s28, s23
    s_lshl_b32 s28, s28, 16
    v_mov_b32 v6, s28
    v_mul_f32 v6, 0x3fb8aa3b, v6
    v_exp_f32 v6, v6
    s_nop 0
    v_cvt_pk_bf16_f32 v6, v6, v6
    v_and_b32 v6, 0xffff0000, v6
    s_lshr_b32 s35, s35, s23
    s_lshl_b32 s35, s35, 16
    v_mov_b32 v249, 0
    v_writelane_b32 v249, s35, 0
    s_cmp_lg_u32 s24, 4
    s_cbranch_scc1 S_C_NH
    s_mov_b64 exec, 0
    s_call_b64 s[84:85], PADA0
S_C_NH:
    s_waitcnt vmcnt(0)
    v_lshlrev_b32 v10, 16, v200
    v_lshlrev_b32 v11, 16, v201
    v_lshlrev_b32 v12, 16, v202
    v_lshlrev_b32 v13, 16, v203
    v_lshlrev_b32 v14, 16, v204
    v_lshlrev_b32 v15, 16, v205
    v_mul_f32 v10, v6, v10
    v_mul_f32 v11, v6, v11
    v_mul_f32 v10, 0x3fb8aa3b, v10
    v_mul_f32 v11, 0x3e22f983, v11
    v_mul_f32 v16, 0x43800000, v10
    v_mul_f32 v17, 0x43800000, v11
    v_fract_f32 v11, v11
    v_fract_f32 v17, v17
    v_exp_f32 v10, v10
    v_cos_f32 v20, v11
    v_sin_f32 v21, v11
    v_exp_f32 v16, v16
    v_cos_f32 v28, v17
    v_sin_f32 v29, v17
    v_mul_f32 v20, v10, v20
    v_mul_f32 v21, v10, v21
    v_mul_f32 v28, v16, v28
    v_mul_f32 v29, v16, v29
    .p2align 3
    v_pk_mul_f32 v[36:37], v[20:21], v[20:21] op_sel_hi:[0,1]
    v_pk_fma_f32 v[22:23], v[20:21], v[20:21], v[36:37] op_sel:[1,1,0] op_sel_hi:[1,0,1] neg_lo:[0,1,0]
    v_pk_mul_f32 v[36:37], v[22:23], v[22:23] op_sel_hi:[0,1]
    v_pk_fma_f32 v[24:25], v[22:23], v[22:23], v[36:37] op_sel:[1,1,0] op_sel_hi:[1,0,1] neg_lo:[0,1,0]
    v_pk_mul_f32 v[36:37], v[24:25], v[24:25] op_sel_hi:[0,1]
    v_pk_fma_f32 v[26:27], v[24:25], v[24:25], v[36:37] op_sel:[1,1,0] op_sel_hi:[1,0,1] neg_lo:[0,1,0]
    v_mov_b32 v38, 0x3f80
    ds_write_addtid_b32 v38
    v_cvt_pk_bf16_f32 v39, v26, -v27
    ds_write_addtid_b32 v39 offset:272
    v_pk_mul_f32 v[36:37], v[26:27], v[26:27] op_sel_hi:[0,1]
    v_pk_fma_f32 v[34:35], v[26:27], v[26:27], v[36:37] op_sel:[1,1,0] op_sel_hi:[1,0,1] neg_lo:[0,1,0]
    v_cvt_pk_bf16_f32 v38, v34, -v35
    ds_write_addtid_b32 v38 offset:544
    v_pk_mul_f32 v[36:37], v[34:35], v[26:27] op_sel_hi:[0,1]
    v_pk_fma_f32 v[34:35], v[34:35], v[26:27], v[36:37] op_sel:[1,1,0] op_sel_hi:[1,0,1] neg_lo:[0,1,0]
    v_cvt_pk_bf16_f32 v39, v34, -v35
    ds_write_addtid_b32 v39 offset:816
    v_pk_mul_f32 v[36:37], v[34:35], v[26:27] op_sel_hi:[0,1]
    v_pk_fma_f32 v[34:35], v[34:35], v[26:27], v[36:37] op_sel:[1,1,0] op_sel_hi:[1,0,1] neg_lo:[0,1,0]
    v_cvt_pk_bf16_f32 v38, v34, -v35
    ds_write_addtid_b32 v38 offset:1088
    v_pk_mul_f32 v[36:37], v[34:35], v[26:27] op_sel_hi:[0,1]
    v_pk_fma_f32 v[34:35], v[34:35], v[26:27], v[36:37] op_sel:[1,1,0] op_sel_hi:[1,0,1] neg_lo:[0,1,0]
    v_cvt_pk_bf16_f32 v39, v34, -v35
    ds_write_addtid_b32 v39 offset:1360
    v_pk_mul_f32 v[36:37], v[34:35], v[26:27] op_sel_hi:[0,1]
    v_pk_fma_f32 v[34:35], v[34:35], v[26:27], v[36:37] op_sel:[1,1,0] op_sel_hi:[1,0,1] neg_lo:[0,1,0]
    v_cvt_pk_bf16_f32 v38, v34, -v35
    ds_write_addtid_b32 v38 offset:1632
    v_pk_mul_f32 v[36:37], v[34:35], v[26:27] op_sel_hi:[0,1]
    v_pk_fma_f32 v[34:35], v[34:35], v[26:27], v[36:37] op_sel:[1,1,0] op_sel_hi:[1,0,1] neg_lo:[0,1,0]
    v_cvt_pk_bf16_f32 v39, v34, -v35
    ds_write_addtid_b32 v39 offset:1904
    v_pk_mul_f32 v[36:37], v[34:35], v[26:27] op_sel_hi:[0,1]
    v_pk_fma_f32 v[34:35], v[34:35], v[26:27], v[36:37] op_sel:[1,1,0] op_sel_hi:[1,0,1] neg_lo:[0,1,0]
    v_cvt_pk_bf16_f32 v38, v34, -v35
    ds_write_addtid_b32 v38 offset:2176
    v_pk_mul_f32 v[36:37], v[34:35], v[26:27] op_sel_hi:[0,1]
    v_pk_fma_f32 v[34:35], v[34:35], v[26:27], v[36:37] op_sel:[1,1,0] op_sel_hi:[1,0,1] neg_lo:[0,1,0]
    v_cvt_pk_bf16_f32 v39, v34, -v35
    ds_write_addtid_b32 v39 offset:2448
    v_pk_mul_f32 v[36:37], v[34:35], v[26:27] op_sel_hi:[0,1]
    v_pk_fma_f32 v[34:35], v[34:35], v[26:27], v[36:37] op_sel:[1,1,0] op_sel_hi:[1,0,1] neg_lo:[0,1,0]
    v_cvt_pk_bf16_f32 v38, v34, -v35
    ds_write_addtid_b32 v38 offset:2720
    v_pk_mul_f32 v[36:37], v[34:35], v[26:27] op_sel_hi:[0,1]
    v_pk_fma_f32 v[34:35], v[34:35], v[26:27], v[36:37] op_sel:[1,1,0] op_sel_hi:[1,0,1] neg_lo:[0,1,0]
    v_cvt_pk_bf16_f32 v39, v34, -v35
    ds_write_addtid_b32 v39 offset:2992
    v_pk_mul_f32 v[36:37], v[34:35], v[26:27] op_sel_hi:[0,1]
    v_pk_fma_f32 v[34:35], v[34:35], v[26:27], v[36:37] op_sel:[1,1,0] op_sel_hi:[1,0,1] neg_lo:[0,1,0]
    v_cvt_pk_bf16_f32 v38, v34, -v35
    ds_write_addtid_b32 v38 offset:3264
    v_pk_mul_f32 v[36:37], v[34:35], v[26:27] op_sel_hi:[0,1]
    v_pk_fma_f32 v[34:35], v[34:35], v[26:27], v[36:37] op_sel:[1,1,0] op_sel_hi:[1,0,1] neg_lo:[0,1,0]
    v_cvt_pk_bf16_f32 v39, v34, -v35
    ds_write_addtid_b32 v39 offset:3536
    v_pk_mul_f32 v[36:37], v[34:35], v[26:27] op_sel_hi:[0,1]
    v_pk_fma_f32 v[34:35], v[34:35], v[26:27], v[36:37] op_sel:[1,1,0] op_sel_hi:[1,0,1] neg_lo:[0,1,0]
    v_cvt_pk_bf16_f32 v38, v34, -v35
    ds_write_addtid_b32 v38 offset:3808
    v_pk_mul_f32 v[36:37], v[34:35], v[26:27] op_sel_hi:[0,1]
    v_pk_fma_f32 v[34:35], v[34:35], v[26:27], v[36:37] op_sel:[1,1,0] op_sel_hi:[1,0,1] neg_lo:[0,1,0]
    v_cvt_pk_bf16_f32 v39, v34, -v35
    ds_write_addtid_b32 v39 offset:4080
    v_pk_mul_f32 v[36:37], v[34:35], v[26:27] op_sel_hi:[0,1]
    v_pk_fma_f32 v[34:35], v[34:35], v[26:27], v[36:37] op_sel:[1,1,0] op_sel_hi:[1,0,1] neg_lo:[0,1,0]
    v_cvt_pk_bf16_f32 v38, v34, -v35
    ds_write_addtid_b32 v38 offset:4352
    v_pk_mul_f32 v[36:37], v[34:35], v[26:27] op_sel_hi:[0,1]
    v_pk_fma_f32 v[34:35], v[34:35], v[26:27], v[36:37] op_sel:[1,1,0] op_sel_hi:[1,0,1] neg_lo:[0,1,0]
    v_cvt_pk_bf16_f32 v39, v34, -v35
    ds_write_addtid_b32 v39 offset:4624
    v_pk_mul_f32 v[36:37], v[34:35], v[26:27] op_sel_hi:[0,1]
    v_pk_fma_f32 v[34:35], v[34:35], v[26:27], v[36:37] op_sel:[1,1,0] op_sel_hi:[1,0,1] neg_lo:[0,1,0]
    v_cvt_pk_bf16_f32 v38, v34, -v35
    ds_write_addtid_b32 v38 offset:4896
    v_pk_mul_f32 v[36:37], v[34:35], v[26:27] op_sel_hi:[0,1]
    v_pk_fma_f32 v[34:35], v[34:35], v[26:27], v[36:37] op_sel:[1,1,0] op_sel_hi:[1,0,1] neg_lo:[0,1,0]
    v_cvt_pk_bf16_f32 v39, v34, -v35
    ds_write_addtid_b32 v39 offset:5168
    v_pk_mul_f32 v[36:37], v[34:35], v[26:27] op_sel_hi:[0,1]
    v_pk_fma_f32 v[34:35], v[34:35], v[26:27], v[36:37] op_sel:[1,1,0] op_sel_hi:[1,0,1] neg_lo:[0,1,0]
    v_cvt_pk_bf16_f32 v38, v34, -v35
    ds_write_addtid_b32 v38 offset:5440
    v_pk_mul_f32 v[36:37], v[34:35], v[26:27] op_sel_hi:[0,1]
    v_pk_fma_f32 v[34:35], v[34:35], v[26:27], v[36:37] op_sel:[1,1,0] op_sel_hi:[1,0,1] neg_lo:[0,1,0]
    v_cvt_pk_bf16_f32 v39, v34, -v35
    ds_write_addtid_b32 v39 offset:5712
    v_pk_mul_f32 v[36:37], v[34:35], v[26:27] op_sel_hi:[0,1]
    v_pk_fma_f32 v[34:35], v[34:35], v[26:27], v[36:37] op_sel:[1,1,0] op_sel_hi:[1,0,1] neg_lo:[0,1,0]
    v_cvt_pk_bf16_f32 v38, v34, -v35
    ds_write_addtid_b32 v38 offset:5984
    v_pk_mul_f32 v[36:37], v[34:35], v[26:27] op_sel_hi:[0,1]
    v_pk_fma_f32 v[34:35], v[34:35], v[26:27], v[36:37] op_sel:[1,1,0] op_sel_hi:[1,0,1] neg_lo:[0,1,0]
    v_cvt_pk_bf16_f32 v39, v34, -v35
    ds_write_addtid_b32 v39 offset:6256
    v_pk_mul_f32 v[36:37], v[34:35], v[26:27] op_sel_hi:[0,1]
    v_pk_fma_f32 v[34:35], v[34:35], v[26:27], v[36:37] op_sel:[1,1,0] op_sel_hi:[1,0,1] neg_lo:[0,1,0]
    v_cvt_pk_bf16_f32 v38, v34, -v35
    ds_write_addtid_b32 v38 offset:6528
    v_pk_mul_f32 v[36:37], v[34:35], v[26:27] op_sel_hi:[0,1]
    v_pk_fma_f32 v[34:35], v[34:35], v[26:27], v[36:37] op_sel:[1,1,0] op_sel_hi:[1,0,1] neg_lo:[0,1,0]
    v_cvt_pk_bf16_f32 v39, v34, -v35
    ds_write_addtid_b32 v39 offset:6800
    v_pk_mul_f32 v[36:37], v[34:35], v[26:27] op_sel_hi:[0,1]
    v_pk_fma_f32 v[34:35], v[34:35], v[26:27], v[36:37] op_sel:[1,1,0] op_sel_hi:[1,0,1] neg_lo:[0,1,0]
    v_cvt_pk_bf16_f32 v38, v34, -v35
    ds_write_addtid_b32 v38 offset:7072
    v_pk_mul_f32 v[36:37], v[34:35], v[26:27] op_sel_hi:[0,1]
    v_pk_fma_f32 v[34:35], v[34:35], v[26:27], v[36:37] op_sel:[1,1,0] op_sel_hi:[1,0,1] neg_lo:[0,1,0]
    v_cvt_pk_bf16_f32 v39, v34, -v35
    ds_write_addtid_b32 v39 offset:7344
    v_pk_mul_f32 v[36:37], v[34:35], v[26:27] op_sel_hi:[0,1]
    v_pk_fma_f32 v[34:35], v[34:35], v[26:27], v[36:37] op_sel:[1,1,0] op_sel_hi:[1,0,1] neg_lo:[0,1,0]
    v_cvt_pk_bf16_f32 v38, v34, -v35
    ds_write_addtid_b32 v38 offset:7616
    v_pk_mul_f32 v[36:37], v[34:35], v[26:27] op_sel_hi:[0,1]
    v_pk_fma_f32 v[34:35], v[34:35], v[26:27], v[36:37] op_sel:[1,1,0] op_sel_hi:[1,0,1] neg_lo:[0,1,0]
    v_cvt_pk_bf16_f32 v39, v34, -v35
    ds_write_addtid_b32 v39 offset:7888
    v_pk_mul_f32 v[36:37], v[34:35], v[26:27] op_sel_hi:[0,1]
    v_pk_fma_f32 v[34:35], v[34:35], v[26:27], v[36:37] op_sel:[1,1,0] op_sel_hi:[1,0,1] neg_lo:[0,1,0]
    v_cvt_pk_bf16_f32 v38, v34, -v35
    ds_write_addtid_b32 v38 offset:8160
    v_pk_mul_f32 v[36:37], v[34:35], v[26:27] op_sel_hi:[0,1]
    v_pk_fma_f32 v[34:35], v[34:35], v[26:27], v[36:37] op_sel:[1,1,0] op_sel_hi:[1,0,1] neg_lo:[0,1,0]
    v_cvt_pk_bf16_f32 v39, v34, -v35
    ds_write_addtid_b32 v39 offset:8432
    ds_read_b128 v[64:67], v5 offset:0
    ds_read_b128 v[68:71], v5 offset:32
    ds_read_b128 v[72:75], v5 offset:64
    ds_read_b128 v[76:79], v5 offset:96
    ds_read_b128 v[80:83], v5 offset:128
    ds_read_b128 v[84:87], v5 offset:160
    ds_read_b128 v[88:91], v5 offset:192
    ds_read_b128 v[92:95], v5 offset:224
    v_pk_mul_f32 v[36:37], v[14:15], v[12:13] op_sel_hi:[0,1]
    v_pk_fma_f32 v[30:31], v[14:15], v[12:13], v[36:37] op_sel:[1,1,0] op_sel_hi:[1,0,1] neg_lo:[0,1,0]
    v_mul_f32 v30, v6, v30
    v_mul_f32 v31, v6, v31
    v_cvt_pk_bf16_f32 v38, v30, v31
    ds_write_addtid_b32 v38 offset:0
    v_pk_mul_f32 v[36:37], v[30:31], v[20:21] op_sel_hi:[0,1]
    v_pk_fma_f32 v[34:35], v[30:31], v[20:21], v[36:37] op_sel:[1,1,0] op_sel_hi:[1,0,1] neg_lo:[0,1,0]
    v_cvt_pk_bf16_f32 v39, v34, v35
    ds_write_addtid_b32 v39 offset:272
    v_pk_mul_f32 v[36:37], v[34:35], v[20:21] op_sel_hi:[0,1]
    v_pk_fma_f32 v[34:35], v[34:35], v[20:21], v[36:37] op_sel:[1,1,0] op_sel_hi:[1,0,1] neg_lo:[0,1,0]
    v_cvt_pk_bf16_f32 v38, v34, v35
    ds_write_addtid_b32 v38 offset:544
    v_pk_mul_f32 v[36:37], v[34:35], v[20:21] op_sel_hi:[0,1]
    v_pk_fma_f32 v[34:35], v[34:35], v[20:21], v[36:37] op_sel:[1,1,0] op_sel_hi:[1,0,1] neg_lo:[0,1,0]
    v_cvt_pk_bf16_f32 v39, v34, v35
    ds_write_addtid_b32 v39 offset:816
    v_pk_mul_f32 v[36:37], v[34:35], v[20:21] op_sel_hi:[0,1]
    v_pk_fma_f32 v[34:35], v[34:35], v[20:21], v[36:37] op_sel:[1,1,0] op_sel_hi:[1,0,1] neg_lo:[0,1,0]
    v_cvt_pk_bf16_f32 v38, v34, v35
    ds_write_addtid_b32 v38 offset:1088
    v_pk_mul_f32 v[36:37], v[34:35], v[20:21] op_sel_hi:[0,1]
    v_pk_fma_f32 v[34:35], v[34:35], v[20:21], v[36:37] op_sel:[1,1,0] op_sel_hi:[1,0,1] neg_lo:[0,1,0]
    v_cvt_pk_bf16_f32 v39, v34, v35
    ds_write_addtid_b32 v39 offset:1360
    v_pk_mul_f32 v[36:37], v[34:35], v[20:21] op_sel_hi:[0,1]
    v_pk_fma_f32 v[34:35], v[34:35], v[20:21], v[36:37] op_sel:[1,1,0] op_sel_hi:[1,0,1] neg_lo:[0,1,0]
    v_cvt_pk_bf16_f32 v38, v34, v35
    ds_write_addtid_b32 v38 offset:1632
    v_pk_mul_f32 v[36:37], v[34:35], v[20:21] op_sel_hi:[0,1]
    v_pk_fma_f32 v[34:35], v[34:35], v[20:21], v[36:37] op_sel:[1,1,0] op_sel_hi:[1,0,1] neg_lo:[0,1,0]
    v_cvt_pk_bf16_f32 v39, v34, v35
    ds_write_addtid_b32 v39 offset:1904
    v_pk_mul_f32 v[36:37], v[30:31], v[28:29] op_sel_hi:[0,1]
    v_pk_fma_f32 v[32:33], v[30:31], v[28:29], v[36:37] op_sel:[1,1,0] op_sel_hi:[1,0,1] neg_lo:[0,1,0]
    v_cvt_pk_bf16_f32 v38, v32, v33
    ds_write_addtid_b32 v38 offset:2176
    v_pk_mul_f32 v[36:37], v[32:33], v[22:23] op_sel_hi:[0,1]
    v_pk_fma_f32 v[34:35], v[32:33], v[22:23], v[36:37] op_sel:[1,1,0] op_sel_hi:[1,0,1] neg_lo:[0,1,0]
    v_cvt_pk_bf16_f32 v39, v34, v35
    ds_write_addtid_b32 v39 offset:2448
    v_pk_mul_f32 v[36:37], v[34:35], v[22:23] op_sel_hi:[0,1]
    v_pk_fma_f32 v[34:35], v[34:35], v[22:23], v[36:37] op_sel:[1,1,0] op_sel_hi:[1,0,1] neg_lo:[0,1,0]
    v_cvt_pk_bf16_f32 v38, v34, v35
    ds_write_addtid_b32 v38 offset:2720
    ds_write_addtid_b32 v38 offset:3264
    v_pk_mul_f32 v[36:37], v[34:35], v[22:23] op_sel_hi:[0,1]
    v_pk_fma_f32 v[34:35], v[34:35], v[22:23], v[36:37] op_sel:[1,1,0] op_sel_hi:[1,0,1] neg_lo:[0,1,0]
    v_cvt_pk_bf16_f32 v39, v34, v35
    ds_write_addtid_b32 v39 offset:3536
    v_pk_mul_f32 v[36:37], v[34:35], v[22:23] op_sel_hi:[0,1]
    v_pk_fma_f32 v[34:35], v[34:35], v[22:23], v[36:37] op_sel:[1,1,0] op_sel_hi:[1,0,1] neg_lo:[0,1,0]
    v_cvt_pk_bf16_f32 v38, v34, v35
    ds_write_addtid_b32 v38 offset:3808
    v_pk_mul_f32 v[36:37], v[32:33], v[28:29] op_sel_hi:[0,1]
    v_pk_fma_f32 v[32:33], v[32:33], v[28:29], v[36:37] op_sel:[1,1,0] op_sel_hi:[1,0,1] neg_lo:[0,1,0]
    v_cvt_pk_bf16_f32 v39, v32, v33
    ds_write_addtid_b32 v39 offset:4352
    v_pk_mul_f32 v[36:37], v[32:33], v[24:25] op_sel_hi:[0,1]
    v_pk_fma_f32 v[34:35], v[32:33], v[24:25], v[36:37] op_sel:[1,1,0] op_sel_hi:[1,0,1] neg_lo:[0,1,0]
    v_cvt_pk_bf16_f32 v38, v34, v35
    ds_write_addtid_b32 v38 offset:4624
    v_pk_mul_f32 v[36:37], v[32:33], v[28:29] op_sel_hi:[0,1]
    v_pk_fma_f32 v[32:33], v[32:33], v[28:29], v[36:37] op_sel:[1,1,0] op_sel_hi:[1,0,1] neg_lo:[0,1,0]
    v_cvt_pk_bf16_f32 v39, v32, v33
    ds_write_addtid_b32 v39 offset:5440
    v_pk_mul_f32 v[36:37], v[32:33], v[24:25] op_sel_hi:[0,1]
    v_pk_fma_f32 v[34:35], v[32:33], v[24:25], v[36:37] op_sel:[1,1,0] op_sel_hi:[1,0,1] neg_lo:[0,1,0]
    v_cvt_pk_bf16_f32 v38, v34, v35
    ds_write_addtid_b32 v38 offset:5712
    v_pk_mul_f32 v[36:37], v[34:35], v[24:25] op_sel_hi:[0,1]
    v_pk_fma_f32 v[34:35], v[34:35], v[24:25], v[36:37] op_sel:[1,1,0] op_sel_hi:[1,0,1] neg_lo:[0,1,0]
    v_cvt_pk_bf16_f32 v39, v34, v35
    ds_write_addtid_b32 v39 offset:5984
    v_pk_mul_f32 v[36:37], v[32:33], v[28:29] op_sel_hi:[0,1]
    v_pk_fma_f32 v[32:33], v[32:33], v[28:29], v[36:37] op_sel:[1,1,0] op_sel_hi:[1,0,1] neg_lo:[0,1,0]
    v_cvt_pk_bf16_f32 v38, v32, v33
    ds_write_addtid_b32 v38 offset:6528
    v_pk_mul_f32 v[36:37], v[32:33], v[28:29] op_sel_hi:[0,1]
    v_pk_fma_f32 v[32:33], v[32:33], v[28:29], v[36:37] op_sel:[1,1,0] op_sel_hi:[1,0,1] neg_lo:[0,1,0]
    v_cvt_pk_bf16_f32 v39, v32, v33
    ds_write_addtid_b32 v39 offset:6800
    v_pk_mul_f32 v[36:37], v[32:33], v[28:29] op_sel_hi:[0,1]
    v_pk_fma_f32 v[32:33], v[32:33], v[28:29], v[36:37] op_sel:[1,1,0] op_sel_hi:[1,0,1] neg_lo:[0,1,0]
    v_cvt_pk_bf16_f32 v38, v32, v33
    ds_write_addtid_b32 v38 offset:7616
    v_pk_mul_f32 v[36:37], v[32:33], v[28:29] op_sel_hi:[0,1]
    v_pk_fma_f32 v[32:33], v[32:33], v[28:29], v[36:37] op_sel:[1,1,0] op_sel_hi:[1,0,1] neg_lo:[0,1,0]
    v_cvt_pk_bf16_f32 v39, v32, v33
    ds_write_addtid_b32 v39 offset:7888
    v_pk_mul_f32 v[36:37], v[32:33], v[28:29] op_sel_hi:[0,1]
    v_pk_fma_f32 v[32:33], v[32:33], v[28:29], v[36:37] op_sel:[1,1,0] op_sel_hi:[1,0,1] neg_lo:[0,1,0]
    v_cvt_pk_bf16_f32 v38, v32, v33
    ds_write_addtid_b32 v38 offset:8160
    ds_read_b128 v[96:99], v5 offset:0
    ds_read_b128 v[100:103], v5 offset:32
    ds_read_b128 v[104:107], v5 offset:64
    ds_read_b128 v[108:111], v5 offset:96
    ds_read_b128 v[112:115], v5 offset:128
    ds_read_b128 v[116:119], v5 offset:160
    ds_read_b128 v[120:123], v5 offset:192
    ds_read_b128 v[124:127], v5 offset:224
    s_waitcnt lgkmcnt(7)
    v_mfma_f32_32x32x16_bf16 v[44:59], v[96:99], v[64:67], 0
    s_waitcnt lgkmcnt(6)
    v_mfma_f32_32x32x16_bf16 v[44:59], v[100:103], v[68:71], v[44:59]
    s_waitcnt lgkmcnt(5)
    v_mfma_f32_32x32x16_bf16 v[44:59], v[104:107], v[72:75], v[44:59]
    s_waitcnt lgkmcnt(4)
    v_mfma_f32_32x32x16_bf16 v[44:59], v[108:111], v[76:79], v[44:59]
    s_waitcnt lgkmcnt(3)
    v_mfma_f32_32x32x16_bf16 v[44:59], v[112:115], v[80:83], v[44:59]
    s_waitcnt lgkmcnt(2)
    v_mfma_f32_32x32x16_bf16 v[44:59], v[116:119], v[84:87], v[44:59]
    s_waitcnt lgkmcnt(1)
    v_mfma_f32_32x32x16_bf16 v[44:59], v[120:123], v[88:91], v[44:59]
    s_waitcnt lgkmcnt(0)
    v_mfma_f32_32x32x16_bf16 v[44:59], v[124:127], v[92:95], v[44:59]
    v_cmp_eq_u32 vcc, 63, v1
    s_nop 3
S_C_PW:
    ds_read_b32 v62, v60
    s_waitcnt lgkmcnt(0)
    v_readfirstlane_b32 s27, v62
    s_cmp_lg_u32 s27, 0
    s_cbranch_scc1 S_C_PG
    s_sleep 1
    s_branch S_C_PW
S_C_PG:
    ds_read_b128 v[64:67], v61 offset:0
    ds_read_b128 v[68:71], v61 offset:1024
    ds_read_b128 v[72:75], v61 offset:2048
    ds_read_b128 v[76:79], v61 offset:3072
    s_waitcnt lgkmcnt(2)
    v_pk_add_f32 v[44:45], v[44:45], v[64:65]
    v_pk_add_f32 v[46:47], v[46:47], v[66:67]
    v_pk_add_f32 v[48:49], v[48:49], v[68:69]
    v_pk_add_f32 v[50:51], v[50:51], v[70:71]
    v_add_f32 v44, v44, v249
    v_cndmask_b32 v26, 0, v50, vcc
    v_cvt_pk_bf16_f32 v34, v47, v46
    v_cvt_pk_bf16_f32 v35, v45, v44
    ds_write_b64 v210, v[34:35] offset:512
    v_sub_f32 v49, v49, v26
    v_sub_f32 v50, v50, v26
    v_cvt_pk_bf16_f32 v32, v50, v49
    v_cvt_pk_bf16_f32 v33, v48, v48
    ds_write_b64 v210, v[32:33]
    ds_read_b128 v[80:83], v8 offset:64
    ds_read_b64 v[84:85], v8 offset:80
    v_cvt_pk_bf16_f32 v30, v49, v48
    s_waitcnt lgkmcnt(4)
    v_pk_add_f32 v[52:53], v[52:53], v[72:73]
    v_pk_add_f32 v[54:55], v[54:55], v[74:75]
    v_pk_add_f32 v[56:57], v[56:57], v[76:77]
    v_pk_add_f32 v[58:59], v[58:59], v[78:79]
    v_cndmask_b32 v26, 0, v54, vcc
    v_cvt_pk_bf16_f32 v20, v56, v57
    v_sub_f32 v53, v53, v26
    v_cvt_pk_bf16_f32 v21, v58, v58
    v_cvt_pk_bf16_f32 v22, v52, v53
    ds_write_b16 v212, v20 offset:64
    ds_write_b16_d16_hi v212, v20
    ds_write_b32 v211, v22
    s_mov_b64 exec, vcc
    ds_write_b16 v213, v30 offset:2750
    ds_write_b32 v213, v30 offset:4092
    s_mov_b32 exec_lo, 0
    s_mov_b32 exec_hi, 1
    ds_write_b16 v213, v21 offset:5948
    s_mov_b64 exec, -1
    v_readlane_b32 s34, v20, 0
    s_nop 0
    s_pack_ll_b32_b16 s34, s34, s34
    s_waitcnt lgkmcnt(6)
    v_alignbit_b32 v88, v81, v80, 16
    v_alignbit_b32 v89, v82, v81, 16
    v_alignbit_b32 v90, v83, v82, 16
    v_alignbit_b32 v91, v84, v83, 16
    ds_write_b128 v8, v[88:91] offset:1408
    v_mov_b32 v92, v81
    v_mov_b32 v93, v82
    v_mov_b32 v94, v83
    v_mov_b32 v95, v84
    ds_write_b128 v8, v[92:95] offset:2752
    v_alignbit_b32 v96, v82, v81, 16
    v_alignbit_b32 v97, v83, v82, 16
    v_alignbit_b32 v98, v84, v83, 16
    v_alignbit_b32 v99, v85, v84, 16
    ds_write_b128 v8, v[96:99] offset:4096
    s_waitcnt lgkmcnt(0)
    ds_read_b64 v[48:49], v224 offset:1024
    ds_read_b64 v[50:51], v224 offset:1032
    ds_read_b64 v[80:81], v224 offset:512
    ds_read_b64 v[82:83], v224 offset:520
    ds_read_b64 v[112:113], v224 offset:0
    ds_read_b64 v[114:115], v224 offset:8
    ds_read_b64 v[52:53], v224 offset:960
    ds_read_b64 v[54:55], v224 offset:968
    ds_read_b64 v[84:85], v224 offset:448
    ds_read_b64 v[86:87], v224 offset:456
    ds_read_b64 v[56:57], v224 offset:896
    ds_read_b64 v[58:59], v224 offset:904
    ds_read_b64 v[88:89], v224 offset:384
    ds_read_b64 v[90:91], v224 offset:392
    ds_read_b64 v[60:61], v224 offset:832
    ds_read_b64 v[62:63], v224 offset:840
    ds_read_b64 v[92:93], v224 offset:320
    ds_read_b64 v[94:95], v224 offset:328
    ds_read_b64 v[64:65], v224 offset:768
    ds_read_b64 v[66:67], v224 offset:776
    ds_read_b64 v[96:97], v224 offset:256
    ds_read_b64 v[98:99], v224 offset:264
    ds_read_b64 v[68:69], v224 offset:704
    ds_read_b64 v[70:71], v224 offset:712
    ds_read_b64 v[100:101], v224 offset:192
    ds_read_b64 v[102:103], v224 offset:200
    ds_read_b64 v[72:73], v224 offset:640
    ds_read_b64 v[74:75], v224 offset:648
    ds_read_b64 v[104:105], v224 offset:128
    ds_read_b64 v[106:107], v224 offset:136
    ds_read_b64 v[76:77], v224 offset:576
    ds_read_b64 v[78:79], v224 offset:584
    ds_read_b64 v[108:109], v224 offset:64
    ds_read_b64 v[110:111], v224 offset:72
    ds_read2_b64 v[180:183], v231 offset0:40 offset1:41
    ds_read2_b64 v[184:187], v231 offset0:32 offset1:33
    ds_read2_b64 v[188:191], v231 offset0:24 offset1:25
    ds_read2_b64 v[192:195], v231 offset0:16 offset1:17
    ds_read2_b64 v[196:199], v231 offset0:8 offset1:9
    ds_read2_b64 v[200:203], v231 offset0:0 offset1:1
    ds_read2_b32 v[204:205], v248 offset0:64 offset1:65
    ds_read2_b32 v[206:207], v248 offset0:66 offset1:67
    ds_read2_b32 v[208:209], v248 offset0:48 offset1:49
    ds_read2_b32 v[210:211], v248 offset0:50 offset1:51
    ds_read2_b32 v[212:213], v248 offset0:32 offset1:33
    ds_read2_b32 v[214:215], v248 offset0:34 offset1:35
    ds_read2_b32 v[216:217], v248 offset0:16 offset1:17
    ds_read2_b32 v[218:219], v248 offset0:18 offset1:19
    ds_read2_b32 v[220:221], v248 offset0:0 offset1:1
    ds_read2_b32 v[222:223], v248 offset0:2 offset1:3
S_XW:
    ds_read_b32 v14, v230 offset:16
    s_waitcnt lgkmcnt(0)
    v_readfirstlane_b32 s27, v14
    s_cmp_ge_u32 s27, 4
    s_cbranch_scc1 S_XG
    s_sleep 1
    s_branch S_XW
S_XG:
    ds_read_b128 v[16:19], v229 offset:0
    ds_read_b128 v[20:23], v229 offset:1024
    ds_read_b128 v[24:27], v229 offset:2048
    ds_read_b128 v[28:31], v229 offset:3072
    ds_read_b128 v[32:35], v229 offset:4096
    ds_read_b128 v[36:39], v229 offset:5120
    ds_read_b128 v[40:43], v229 offset:6144
    ds_read_b128 v[44:47], v229 offset:7168
    s_waitcnt lgkmcnt(0)
    s_setprio 3
    s_barrier
    ds_read_b128 v[116:119], v225 offset:448
    ds_read_b128 v[120:123], v225 offset:960
    ds_read_b128 v[124:127], v225 offset:1472
    ds_read_b128 v[128:131], v225 offset:1984
    ds_read_b128 v[132:135], v225 offset:2496
    ds_read_b128 v[136:139], v225 offset:3008
    ds_read_b128 v[140:143], v225 offset:3520
    ds_read_b128 v[144:147], v225 offset:4032
    .p2align 3
    s_waitcnt lgkmcnt(7)
    s_nop 0
    v_mfma_f32_16x16x32_bf16 v[16:19], v[48:51], v[116:119], v[16:19]
    ds_read_b128 v[148:151], v225 offset:384
    s_waitcnt lgkmcnt(7)
    s_nop 0
    v_mfma_f32_16x16x32_bf16 v[20:23], v[48:51], v[120:123], v[20:23]
    ds_read_b128 v[152:155], v225 offset:896
    s_waitcnt lgkmcnt(7)
    s_nop 0
    v_mfma_f32_16x16x32_bf16 v[24:27], v[48:51], v[124:127], v[24:27]
    ds_read_b128 v[156:159], v225 offset:1408
    s_waitcnt lgkmcnt(7)
    s_nop 0
    v_mfma_f32_16x16x32_bf16 v[28:31], v[48:51], v[128:131], v[28:31]
    ds_read_b128 v[160:163], v225 offset:1920
    s_waitcnt lgkmcnt(7)
    s_nop 0
    v_mfma_f32_16x16x32_bf16 v[32:35], v[48:51], v[132:135], v[32:35]
    ds_read_b128 v[164:167], v225 offset:2432
    s_waitcnt lgkmcnt(7)
    s_nop 0
    v_mfma_f32_16x16x32_bf16 v[36:39], v[48:51], v[136:139], v[36:39]
    ds_read_b128 v[168:171], v225 offset:2944
    s_waitcnt lgkmcnt(6)
    s_nop 0
    v_mfma_f32_16x16x32_bf16 v[40:43], v[48:51], v[140:143], v[40:43]
    ds_read_b128 v[172:175], v225 offset:3456
    v_and_b32_e64 v13, 15, v1
    .p2align 3
    v_mfma_f32_16x16x32_bf16 v[44:47], v[48:51], v[144:147], v[44:47]
    ds_read_b128 v[176:179], v225 offset:3968
    v_lshrrev_b32_e64 v9, 4, v1
    .p2align 3
    v_mfma_f32_16x16x32_bf16 v[20:23], v[80:83], v[116:119], v[20:23]
    v_lshlrev_b32_e64 v14, 4, v9
    v_lshrrev_b32_e64 v12, 3, v13
    .p2align 3
    v_mfma_f32_16x16x32_bf16 v[24:27], v[80:83], v[120:123], v[24:27]
    v_mul_u32_u24 v12, 0x28000, v12
    v_and_b32_e64 v11, 7, v13
    .p2align 3
    v_mfma_f32_16x16x32_bf16 v[28:31], v[80:83], v[124:127], v[28:31]
    v_lshl_add_u32 v12, v11, 5, v12
    v_lshrrev_b32_e64 v11, 1, v9
    .p2align 3
    v_mfma_f32_16x16x32_bf16 v[32:35], v[80:83], v[128:131], v[32:35]
    v_lshl_add_u32 v12, v11, 4, v12
    v_and_b32_e64 v11, 1, v9
    .p2align 3
    v_mfma_f32_16x16x32_bf16 v[36:39], v[80:83], v[132:135], v[36:39]
    v_mul_u32_u24 v11, 0x50000, v11
    v_add_u32_e64 v228, v12, v11
    .p2align 3
    v_mfma_f32_16x16x32_bf16 v[40:43], v[80:83], v[136:139], v[40:43]
    s_lshl_b32 s29, s26, 8
    v_lshlrev_b32_e64 v9, 3, v9
    .p2align 3
    v_mfma_f32_16x16x32_bf16 v[44:47], v[80:83], v[140:143], v[44:47]
    s_mov_b32 s27, 0x3f800000
    v_mov_b32 v10, 0x7c0
    .p2align 3
    v_mfma_f32_16x16x32_bf16 v[24:27], v[112:115], v[116:119], v[24:27]
    v_lshlrev_b32_e64 v10, v13, v10
    v_lshrrev_b32_e64 v10, v9, v10
    .p2align 3
    v_mfma_f32_16x16x32_bf16 v[28:31], v[112:115], v[120:123], v[28:31]
    v_bfe_i32 v11, v10, 0, 1
    v_bfe_i32 v12, v10, 1, 1
    .p2align 3
    v_mfma_f32_16x16x32_bf16 v[32:35], v[112:115], v[124:127], v[32:35]
    v_and_b32 v11, 0x3f80, v11
    v_and_or_b32 v232, v12, s27, v11
    .p2align 3
    v_mfma_f32_16x16x32_bf16 v[36:39], v[112:115], v[128:131], v[36:39]
    v_bfe_i32 v11, v10, 2, 1
    v_bfe_i32 v12, v10, 3, 1
    .p2align 3
    v_mfma_f32_16x16x32_bf16 v[40:43], v[112:115], v[132:135], v[40:43]
    v_and_b32 v11, 0x3f80, v11
    v_and_or_b32 v233, v12, s27, v11
    .p2align 3
    v_mfma_f32_16x16x32_bf16 v[44:47], v[112:115], v[136:139], v[44:47]
    v_bfe_i32 v11, v10, 4, 1
    v_bfe_i32 v12, v10, 5, 1
    .p2align 3
    s_waitcnt lgkmcnt(0)
    s_nop 0
    v_mfma_f32_16x16x32_bf16 v[16:19], v[52:55], v[148:151], v[16:19]
    ds_read_b128 v[116:119], v225 offset:320
    v_and_b32 v11, 0x3f80, v11
    .p2align 3
    v_mfma_f32_16x16x32_bf16 v[20:23], v[52:55], v[152:155], v[20:23]
    ds_read_b128 v[120:123], v225 offset:832
    v_and_or_b32 v234, v12, s27, v11
    .p2align 3
    v_mfma_f32_16x16x32_bf16 v[24:27], v[52:55], v[156:159], v[24:27]
    ds_read_b128 v[124:127], v225 offset:1344
    v_bfe_i32 v11, v10, 6, 1
    .p2align 3
    v_mfma_f32_16x16x32_bf16 v[28:31], v[52:55], v[160:163], v[28:31]
    ds_read_b128 v[128:131], v225 offset:1856
    v_bfe_i32 v12, v10, 7, 1
    .p2align 3
    v_mfma_f32_16x16x32_bf16 v[32:35], v[52:55], v[164:167], v[32:35]
PADA1:
    s_cbranch_execz PADA2
    s_nop 0
    ds_read_b128 v[132:135], v225 offset:2368
    v_and_b32 v11, 0x3f80, v11
    .p2align 3
    v_mfma_f32_16x16x32_bf16 v[36:39], v[52:55], v[168:171], v[36:39]
    ds_read_b128 v[136:139], v225 offset:2880
    v_and_or_b32 v235, v12, s27, v11
    .p2align 3
    v_mfma_f32_16x16x32_bf16 v[40:43], v[52:55], v[172:175], v[40:43]
    ds_read_b128 v[140:143], v225 offset:3392
    v_mov_b32 v10, 0x38
    .p2align 3
    v_mfma_f32_16x16x32_bf16 v[44:47], v[52:55], v[176:179], v[44:47]
    ds_read_b128 v[144:147], v225 offset:3904
    v_lshlrev_b32_e64 v10, v13, v10
    .p2align 3
    v_mfma_f32_16x16x32_bf16 v[20:23], v[84:87], v[148:151], v[20:23]
    v_lshrrev_b32_e64 v10, v9, v10
    v_bfe_i32 v11, v10, 0, 1
    .p2align 3
    v_mfma_f32_16x16x32_bf16 v[24:27], v[84:87], v[152:155], v[24:27]
    v_bfe_i32 v12, v10, 1, 1
    v_and_b32 v11, 0x3f80, v11
    .p2align 3
    v_mfma_f32_16x16x32_bf16 v[28:31], v[84:87], v[156:159], v[28:31]
    v_and_or_b32 v236, v12, s27, v11
    v_bfe_i32 v11, v10, 2, 1
    .p2align 3
    v_mfma_f32_16x16x32_bf16 v[32:35], v[84:87], v[160:163], v[32:35]
    v_bfe_i32 v12, v10, 3, 1
    v_and_b32 v11, 0x3f80, v11
    .p2align 3
    v_mfma_f32_16x16x32_bf16 v[36:39], v[84:87], v[164:167], v[36:39]
    v_and_or_b32 v237, v12, s27, v11
    v_bfe_i32 v11, v10, 4, 1
    .p2align 3
    v_mfma_f32_16x16x32_bf16 v[40:43], v[84:87], v[168:171], v[40:43]
    v_bfe_i32 v12, v10, 5, 1
    v_and_b32 v11, 0x3f80, v11
    .p2align 3
    v_mfma_f32_16x16x32_bf16 v[44:47], v[84:87], v[172:175], v[44:47]
    v_and_or_b32 v238, v12, s27, v11
    v_bfe_i32 v11, v10, 6, 1
    .p2align 3
    s_waitcnt lgkmcnt(0)
    s_nop 0
    v_mfma_f32_16x16x32_bf16 v[16:19], v[56:59], v[116:119], v[16:19]
    ds_read_b128 v[148:151], v225 offset:256
    v_bfe_i32 v12, v10, 7, 1
    .p2align 3
    v_mfma_f32_16x16x32_bf16 v[20:23], v[56:59], v[120:123], v[20:23]
    ds_read_b128 v[152:155], v225 offset:768
    v_and_b32 v11, 0x3f80, v11
    .p2align 3
    v_mfma_f32_16x16x32_bf16 v[24:27], v[56:59], v[124:127], v[24:27]
    ds_read_b128 v[156:159], v225 offset:1280
    v_and_or_b32 v239, v12, s27, v11
    .p2align 3
    v_mfma_f32_16x16x32_bf16 v[28:31], v[56:59], v[128:131], v[28:31]
    ds_read_b128 v[160:163], v225 offset:1792
    v_mov_b32 v10, 0x1ff0
    .p2align 3
    v_mfma_f32_16x16x32_bf16 v[32:35], v[56:59], v[132:135], v[32:35]
    ds_read_b128 v[164:167], v225 offset:2304
    v_lshlrev_b32_e64 v10, v13, v10
    .p2align 3
    v_mfma_f32_16x16x32_bf16 v[36:39], v[56:59], v[136:139], v[36:39]
    ds_read_b128 v[168:171], v225 offset:2816
    v_lshrrev_b32_e64 v10, v9, v10
    .p2align 3
    v_mfma_f32_16x16x32_bf16 v[40:43], v[56:59], v[140:143], v[40:43]
    ds_read_b128 v[172:175], v225 offset:3328
    v_bfe_i32 v11, v10, 0, 1
    .p2align 3
    v_mfma_f32_16x16x32_bf16 v[44:47], v[56:59], v[144:147], v[44:47]
    ds_read_b128 v[176:179], v225 offset:3840
    v_bfe_i32 v12, v10, 1, 1
    .p2align 3
    v_mfma_f32_16x16x32_bf16 v[20:23], v[88:91], v[116:119], v[20:23]
    v_and_b32 v11, 0x3f80, v11
    v_and_or_b32 v240, v12, s27, v11
    .p2align 3
    v_mfma_f32_16x16x32_bf16 v[24:27], v[88:91], v[120:123], v[24:27]
    v_bfe_i32 v11, v10, 2, 1
    v_bfe_i32 v12, v10, 3, 1
    .p2align 3
    v_mfma_f32_16x16x32_bf16 v[28:31], v[88:91], v[124:127], v[28:31]
    v_and_b32 v11, 0x3f80, v11
    v_and_or_b32 v241, v12, s27, v11
    .p2align 3
    v_mfma_f32_16x16x32_bf16 v[32:35], v[88:91], v[128:131], v[32:35]
    v_bfe_i32 v11, v10, 4, 1
    v_bfe_i32 v12, v10, 5, 1
    .p2align 3
    v_mfma_f32_16x16x32_bf16 v[36:39], v[88:91], v[132:135], v[36:39]
    v_and_b32 v11, 0x3f80, v11
    v_and_or_b32 v242, v12, s27, v11
    .p2align 3
    v_mfma_f32_16x16x32_bf16 v[40:43], v[88:91], v[136:139], v[40:43]
    v_bfe_i32 v11, v10, 6, 1
    v_bfe_i32 v12, v10, 7, 1
    .p2align 3
    v_mfma_f32_16x16x32_bf16 v[44:47], v[88:91], v[140:143], v[44:47]
    v_and_b32 v11, 0x3f80, v11
    v_and_or_b32 v243, v12, s27, v11
    .p2align 3
    s_waitcnt lgkmcnt(0)
    s_nop 0
    v_mfma_f32_16x16x32_bf16 v[16:19], v[60:63], v[148:151], v[16:19]
    ds_read_b128 v[116:119], v225 offset:192
    v_mov_b32 v10, 0xfe0
    .p2align 3
    v_mfma_f32_16x16x32_bf16 v[20:23], v[60:63], v[152:155], v[20:23]
    ds_read_b128 v[120:123], v225 offset:704
    v_lshlrev_b32_e64 v10, v13, v10
    .p2align 3
    v_mfma_f32_16x16x32_bf16 v[24:27], v[60:63], v[156:159], v[24:27]
    ds_read_b128 v[124:127], v225 offset:1216
    v_lshrrev_b32_e64 v10, v9, v10
    .p2align 3
    v_mfma_f32_16x16x32_bf16 v[28:31], v[60:63], v[160:163], v[28:31]
    ds_read_b128 v[128:131], v225 offset:1728
    v_bfe_i32 v11, v10, 0, 1
    .p2align 3
    v_mfma_f32_16x16x32_bf16 v[32:35], v[60:63], v[164:167], v[32:35]
    ds_read_b128 v[132:135], v225 offset:2240
    v_bfe_i32 v12, v10, 1, 1
    .p2align 3
    v_mfma_f32_16x16x32_bf16 v[36:39], v[60:63], v[168:171], v[36:39]
    ds_read_b128 v[136:139], v225 offset:2752
    v_and_b32 v11, 0x3f80, v11
    .p2align 3
    v_mfma_f32_16x16x32_bf16 v[40:43], v[60:63], v[172:175], v[40:43]
    ds_read_b128 v[140:143], v225 offset:3264
    v_and_or_b32 v244, v12, s27, v11
    .p2align 3
    v_mfma_f32_16x16x32_bf16 v[44:47], v[60:63], v[176:179], v[44:47]
    ds_read_b128 v[144:147], v225 offset:3776
    v_bfe_i32 v11, v10, 2, 1
    .p2align 3
    v_mfma_f32_16x16x32_bf16 v[20:23], v[92:95], v[148:151], v[20:23]
    v_bfe_i32 v12, v10, 3, 1
    v_and_b32 v11, 0x3f80, v11
    .p2align 3
    v_mfma_f32_16x16x32_bf16 v[24:27], v[92:95], v[152:155], v[24:27]
    v_and_or_b32 v245, v12, s27, v11
    v_bfe_i32 v11, v10, 4, 1
    .p2align 3
    v_mfma_f32_16x16x32_bf16 v[28:31], v[92:95], v[156:159], v[28:31]
    v_bfe_i32 v12, v10, 5, 1
    v_and_b32 v11, 0x3f80, v11
    .p2align 3
    v_mfma_f32_16x16x32_bf16 v[32:35], v[92:95], v[160:163], v[32:35]
    v_and_or_b32 v246, v12, s27, v11
    v_bfe_i32 v11, v10, 6, 1
    .p2align 3
    v_mfma_f32_16x16x32_bf16 v[36:39], v[92:95], v[164:167], v[36:39]
    v_bfe_i32 v12, v10, 7, 1
    v_and_b32 v11, 0x3f80, v11
    .p2align 3
    v_mfma_f32_16x16x32_bf16 v[40:43], v[92:95], v[168:171], v[40:43]
    v_and_or_b32 v247, v12, s27, v11
    v_mov_b32 v10, 0x2000
    .p2align 3
    v_mfma_f32_16x16x32_bf16 v[44:47], v[92:95], v[172:175], v[44:47]
    v_lshlrev_b32_e64 v10, v13, v10
    v_lshrrev_b32_e64 v10, v9, v10
    .p2align 3
    s_waitcnt lgkmcnt(0)
    s_nop 0
    v_mfma_f32_16x16x32_bf16 v[16:19], v[64:67], v[116:119], v[16:19]
    ds_read_b128 v[148:151], v225 offset:128
    s_mov_b32 s27, 0xffff0000
    .p2align 3
    v_mfma_f32_16x16x32_bf16 v[20:23], v[64:67], v[120:123], v[20:23]
    ds_read_b128 v[152:155], v225 offset:640
    v_bfe_i32 v11, v10, 0, 1
    .p2align 3
    v_mfma_f32_16x16x32_bf16 v[24:27], v[64:67], v[124:127], v[24:27]
    ds_read_b128 v[156:159], v225 offset:1152
    v_bfe_i32 v12, v10, 1, 1
    .p2align 3
    v_mfma_f32_16x16x32_bf16 v[28:31], v[64:67], v[128:131], v[28:31]
    ds_read_b128 v[160:163], v225 offset:1664
    v_and_b32 v11, 0xffff, v11
    .p2align 3
    v_mfma_f32_16x16x32_bf16 v[32:35], v[64:67], v[132:135], v[32:35]
    ds_read_b128 v[164:167], v225 offset:2176
    v_and_or_b32 v250, v12, s27, v11
    .p2align 3
    v_mfma_f32_16x16x32_bf16 v[36:39], v[64:67], v[136:139], v[36:39]
    ds_read_b128 v[168:171], v225 offset:2688
    v_bfe_i32 v11, v10, 2, 1
    .p2align 3
    v_mfma_f32_16x16x32_bf16 v[40:43], v[64:67], v[140:143], v[40:43]
    ds_read_b128 v[172:175], v225 offset:3200
    v_bfe_i32 v12, v10, 3, 1
    .p2align 3
    v_mfma_f32_16x16x32_bf16 v[44:47], v[64:67], v[144:147], v[44:47]
    ds_read_b128 v[176:179], v225 offset:3712
    v_and_b32 v11, 0xffff, v11
    .p2align 3
    v_mfma_f32_16x16x32_bf16 v[20:23], v[96:99], v[116:119], v[20:23]
    v_and_or_b32 v251, v12, s27, v11
    v_bfe_i32 v11, v10, 4, 1
    .p2align 3
    v_mfma_f32_16x16x32_bf16 v[24:27], v[96:99], v[120:123], v[24:27]
    v_bfe_i32 v12, v10, 5, 1
    v_and_b32 v11, 0xffff, v11
    .p2align 3
    v_mfma_f32_16x16x32_bf16 v[28:31], v[96:99], v[124:127], v[28:31]
    v_and_or_b32 v252, v12, s27, v11
    v_bfe_i32 v11, v10, 6, 1
    .p2align 3
    v_mfma_f32_16x16x32_bf16 v[32:35], v[96:99], v[128:131], v[32:35]
    v_bfe_i32 v12, v10, 7, 1
    v_and_b32 v11, 0xffff, v11
    .p2align 3
    v_mfma_f32_16x16x32_bf16 v[36:39], v[96:99], v[132:135], v[36:39]
    v_and_or_b32 v253, v12, s27, v11
    v_and_b32_e64 v250, s34, v250
    .p2align 3
    v_mfma_f32_16x16x32_bf16 v[40:43], v[96:99], v[136:139], v[40:43]
    v_and_b32_e64 v251, s34, v251
    v_and_b32_e64 v252, s34, v252
    .p2align 3
    v_mfma_f32_16x16x32_bf16 v[44:47], v[96:99], v[140:143], v[44:47]
    v_and_b32_e64 v253, s34, v253
    buffer_load_dword v249, off, s[36:39], 0 offset:8 sc1
    .p2align 3
    s_waitcnt lgkmcnt(0)
    s_nop 0
    v_mfma_f32_16x16x32_bf16 v[16:19], v[68:71], v[148:151], v[16:19]
    ds_read_b128 v[116:119], v225 offset:64
    v_mfma_f32_16x16x32_bf16 v[20:23], v[68:71], v[152:155], v[20:23]
    ds_read_b128 v[120:123], v225 offset:576
    v_mfma_f32_16x16x32_bf16 v[24:27], v[68:71], v[156:159], v[24:27]
    ds_read_b128 v[124:127], v225 offset:1088
    v_mfma_f32_16x16x32_bf16 v[28:31], v[68:71], v[160:163], v[28:31]
    ds_read_b128 v[128:131], v225 offset:1600
    v_mfma_f32_16x16x32_bf16 v[32:35], v[68:71], v[164:167], v[32:35]
    ds_read_b128 v[132:135], v225 offset:2112
    v_mfma_f32_16x16x32_bf16 v[36:39], v[68:71], v[168:171], v[36:39]
    ds_read_b128 v[136:139], v225 offset:2624
    v_mfma_f32_16x16x32_bf16 v[40:43], v[68:71], v[172:175], v[40:43]
    ds_read_b128 v[140:143], v225 offset:3136
    v_mfma_f32_16x16x32_bf16 v[44:47], v[68:71], v[176:179], v[44:47]
    ds_read_b128 v[144:147], v225 offset:3648
    v_mfma_f32_16x16x32_bf16 v[20:23], v[100:103], v[148:151], v[20:23]
    v_mfma_f32_16x16x32_bf16 v[24:27], v[100:103], v[152:155], v[24:27]
    v_mfma_f32_16x16x32_bf16 v[28:31], v[100:103], v[156:159], v[28:31]
    v_mfma_f32_16x16x32_bf16 v[32:35], v[100:103], v[160:163], v[32:35]
    v_mfma_f32_16x16x32_bf16 v[36:39], v[100:103], v[164:167], v[36:39]
    v_mfma_f32_16x16x32_bf16 v[40:43], v[100:103], v[168:171], v[40:43]
    v_mfma_f32_16x16x32_bf16 v[44:47], v[100:103], v[172:175], v[44:47]
    s_waitcnt lgkmcnt(0)
    s_nop 0
    v_mfma_f32_16x16x32_bf16 v[16:19], v[72:75], v[116:119], v[16:19]
    ds_read_b128 v[148:151], v225 offset:0
    v_mfma_f32_16x16x32_bf16 v[20:23], v[72:75], v[120:123], v[20:23]
    ds_read_b128 v[152:155], v225 offset:512
    v_mfma_f32_16x16x32_bf16 v[24:27], v[72:75], v[124:127], v[24:27]
    ds_read_b128 v[156:159], v225 offset:1024
    v_mfma_f32_16x16x32_bf16 v[28:31], v[72:75], v[128:131], v[28:31]
    ds_read_b128 v[160:163], v225 offset:1536
    v_mfma_f32_16x16x32_bf16 v[32:35], v[72:75], v[132:135], v[32:35]
    ds_read_b128 v[164:167], v225 offset:2048
    v_mfma_f32_16x16x32_bf16 v[36:39], v[72:75], v[136:139], v[36:39]
    ds_read_b128 v[168:171], v225 offset:2560
    v_mfma_f32_16x16x32_bf16 v[40:43], v[72:75], v[140:143], v[40:43]
    ds_read_b128 v[172:175], v225 offset:3072
    v_mfma_f32_16x16x32_bf16 v[44:47], v[72:75], v[144:147], v[44:47]
    ds_read_b128 v[176:179], v225 offset:3584
    v_mfma_f32_16x16x32_bf16 v[20:23], v[104:107], v[116:119], v[20:23]
    v_mfma_f32_16x16x32_bf16 v[24:27], v[104:107], v[120:123], v[24:27]
    v_mfma_f32_16x16x32_bf16 v[28:31], v[104:107], v[124:127], v[28:31]
    v_mfma_f32_16x16x32_bf16 v[32:35], v[104:107], v[128:131], v[32:35]
    v_mfma_f32_16x16x32_bf16 v[36:39], v[104:107], v[132:135], v[36:39]
    v_mfma_f32_16x16x32_bf16 v[40:43], v[104:107], v[136:139], v[40:43]
    v_mfma_f32_16x16x32_bf16 v[44:47], v[104:107], v[140:143], v[44:47]
    s_waitcnt lgkmcnt(0)
    s_nop 0
    v_mfma_f32_16x16x32_bf16 v[16:19], v[76:79], v[148:151], v[16:19]
    ds_read_b128 v[116:119], v227 offset:16
    v_mfma_f32_16x16x32_bf16 v[20:23], v[76:79], v[152:155], v[20:23]
    ds_read_b128 v[120:123], v227 offset:0
    v_mfma_f32_16x16x32_bf16 v[24:27], v[76:79], v[156:159], v[24:27]
    ds_read_b128 v[124:127], v227 offset:528
    v_mfma_f32_16x16x32_bf16 v[28:31], v[76:79], v[160:163], v[28:31]
    ds_read_b128 v[128:131], v227 offset:512
    v_mfma_f32_16x16x32_bf16 v[32:35], v[76:79], v[164:167], v[32:35]
    ds_read_b128 v[132:135], v227 offset:1040
    v_mfma_f32_16x16x32_bf16 v[36:39], v[76:79], v[168:171], v[36:39]
    ds_read_b128 v[136:139], v227 offset:1024
    v_mfma_f32_16x16x32_bf16 v[40:43], v[76:79], v[172:175], v[40:43]
    ds_read_b128 v[140:143], v227 offset:1552
    v_mfma_f32_16x16x32_bf16 v[44:47], v[76:79], v[176:179], v[44:47]
    ds_read_b128 v[144:147], v227 offset:1536
    v_mfma_f32_16x16x32_bf16 v[20:23], v[108:111], v[148:151], v[20:23]
    v_mfma_f32_16x16x32_bf16 v[24:27], v[108:111], v[152:155], v[24:27]
    v_mfma_f32_16x16x32_bf16 v[28:31], v[108:111], v[156:159], v[28:31]
    v_mfma_f32_16x16x32_bf16 v[32:35], v[108:111], v[160:163], v[32:35]
    v_mfma_f32_16x16x32_bf16 v[36:39], v[108:111], v[164:167], v[36:39]
    v_mfma_f32_16x16x32_bf16 v[40:43], v[108:111], v[168:171], v[40:43]
    v_mfma_f32_16x16x32_bf16 v[44:47], v[108:111], v[172:175], v[44:47]
    s_waitcnt lgkmcnt(0)
    s_nop 0
    v_mfma_f32_16x16x32_bf16 v[48:51], v[116:119], v[240:243], 0
    v_mfma_f32_16x16x32_bf16 v[28:31], v[250:253], v[116:119], v[28:31]
    ds_read_b128 v[116:119], v227 offset:2064
    v_mfma_f32_16x16x32_bf16 v[52:55], v[120:123], v[244:247], 0
    ds_read_b128 v[120:123], v227 offset:2048
    v_mfma_f32_16x16x32_bf16 v[56:59], v[124:127], v[240:243], 0
    v_mfma_f32_16x16x32_bf16 v[32:35], v[250:253], v[124:127], v[32:35]
    ds_read_b128 v[124:127], v226 offset:0
    v_mfma_f32_16x16x32_bf16 v[60:63], v[128:131], v[244:247], 0
    ds_read_b128 v[128:131], v226 offset:256
    v_mfma_f32_16x16x32_bf16 v[64:67], v[132:135], v[240:243], 0
    v_mfma_f32_16x16x32_bf16 v[36:39], v[250:253], v[132:135], v[36:39]
    ds_read_b128 v[132:135], v226 offset:512
    v_cvt_pk_bf16_f32 v72, v48, v52
    v_mfma_f32_16x16x32_bf16 v[68:71], v[136:139], v[244:247], 0
    ds_read_b128 v[136:139], v226 offset:768
    v_cvt_pk_bf16_f32 v73, v49, v53
    v_cvt_pk_bf16_f32 v74, v50, v54
    v_cvt_pk_bf16_f32 v75, v51, v55
    s_nop 0
    s_nop 0
    v_mfma_f32_16x16x32_bf16 v[28:31], v[72:75], v[204:207], v[28:31]
    v_cvt_pk_bf16_f32 v76, v56, v60
    v_cvt_pk_bf16_f32 v77, v57, v61
    v_mfma_f32_16x16x32_bf16 v[32:35], v[72:75], v[208:211], v[32:35]
    v_cvt_pk_bf16_f32 v78, v58, v62
    v_cvt_pk_bf16_f32 v79, v59, v63
    v_mfma_f32_16x16x32_bf16 v[36:39], v[72:75], v[212:215], v[36:39]
    v_mfma_f32_16x16x32_bf16 v[40:43], v[72:75], v[216:219], v[40:43]
    v_mfma_f32_16x16x32_bf16 v[44:47], v[72:75], v[220:223], v[44:47]
    v_cvt_pk_bf16_f32 v80, v64, v68
    v_cvt_pk_bf16_f32 v81, v65, v69
    v_mfma_f32_16x16x32_bf16 v[48:51], v[140:143], v[240:243], 0
    v_mfma_f32_16x16x32_bf16 v[40:43], v[250:253], v[140:143], v[40:43]
    ds_read_b128 v[140:143], v226 offset:1024
    v_cvt_pk_bf16_f32 v82, v66, v70
    v_mfma_f32_16x16x32_bf16 v[52:55], v[144:147], v[244:247], 0
    ds_read_b128 v[144:147], v226 offset:1280
    v_cvt_pk_bf16_f32 v83, v67, v71
    v_mfma_f32_16x16x32_bf16 v[32:35], v[76:79], v[204:207], v[32:35]
    v_mfma_f32_16x16x32_bf16 v[36:39], v[76:79], v[208:211], v[36:39]
    v_mfma_f32_16x16x32_bf16 v[40:43], v[76:79], v[212:215], v[40:43]
    v_mfma_f32_16x16x32_bf16 v[44:47], v[76:79], v[216:219], v[44:47]
    s_waitcnt lgkmcnt(2)
    s_nop 0
    v_mfma_f32_16x16x32_bf16 v[56:59], v[116:119], v[240:243], 0
    v_mfma_f32_16x16x32_bf16 v[44:47], v[250:253], v[116:119], v[44:47]
    ds_read_b128 v[116:119], v226 offset:1536
    v_cvt_pk_bf16_f32 v72, v48, v52
    v_mfma_f32_16x16x32_bf16 v[60:63], v[120:123], v[244:247], 0
    ds_read_b128 v[120:123], v226 offset:1792
    v_cvt_pk_bf16_f32 v73, v49, v53
    v_mfma_f32_16x16x32_bf16 v[36:39], v[80:83], v[204:207], v[36:39]
    v_cvt_pk_bf16_f32 v74, v50, v54
    v_cvt_pk_bf16_f32 v75, v51, v55
    v_mfma_f32_16x16x32_bf16 v[40:43], v[80:83], v[208:211], v[40:43]
    v_mfma_f32_16x16x32_bf16 v[44:47], v[80:83], v[212:215], v[44:47]
    v_mfma_f32_16x16x32_bf16 v[64:67], v[124:127], v[232:235], 0
    v_cvt_pk_bf16_f32 v76, v56, v60
    v_cvt_pk_bf16_f32 v77, v57, v61
    v_mfma_f32_16x16x32_bf16 v[68:71], v[124:127], v[236:239], 0
    ds_read_b128 v[124:127], v226 offset:2048
    v_cvt_pk_bf16_f32 v78, v58, v62
    v_mfma_f32_16x16x32_bf16 v[40:43], v[72:75], v[204:207], v[40:43]
    v_cvt_pk_bf16_f32 v79, v59, v63
    v_mfma_f32_16x16x32_bf16 v[44:47], v[72:75], v[208:211], v[44:47]
    v_mfma_f32_16x16x32_bf16 v[48:51], v[128:131], v[232:235], 0
    v_mfma_f32_16x16x32_bf16 v[52:55], v[128:131], v[236:239], 0
    ds_read_b128 v[128:131], v226 offset:2304
    v_cvt_pk_bf16_f32 v80, v64, v68
    v_mfma_f32_16x16x32_bf16 v[44:47], v[76:79], v[204:207], v[44:47]
    v_cvt_pk_bf16_f32 v81, v65, v69
    v_cvt_pk_bf16_f32 v82, v66, v70
    v_mfma_f32_16x16x32_bf16 v[56:59], v[132:135], v[232:235], 0
    v_cvt_pk_bf16_f32 v83, v67, v71
    v_mfma_f32_16x16x32_bf16 v[60:63], v[132:135], v[236:239], 0
    ds_read_b128 v[132:135], v226 offset:2560
    v_cvt_pk_bf16_f32 v72, v48, v52
    v_mfma_f32_16x16x32_bf16 v[20:23], v[80:83], v[180:183], v[20:23]
    v_cvt_pk_bf16_f32 v73, v49, v53
    v_cvt_pk_bf16_f32 v74, v50, v54
    v_mfma_f32_16x16x32_bf16 v[24:27], v[80:83], v[188:191], v[24:27]
    v_cvt_pk_bf16_f32 v75, v51, v55
    v_mfma_f32_16x16x32_bf16 v[28:31], v[80:83], v[196:199], v[28:31]
    v_cvt_pk_bf16_f32 v76, v56, v60
    v_cvt_pk_bf16_f32 v77, v57, v61
    v_mfma_f32_16x16x32_bf16 v[64:67], v[136:139], v[232:235], 0
    v_cvt_pk_bf16_f32 v78, v58, v62
    v_cvt_pk_bf16_f32 v79, v59, v63
    v_mfma_f32_16x16x32_bf16 v[68:71], v[136:139], v[236:239], 0
    ds_read_b128 v[136:139], v226 offset:2816
    v_cvt_pk_bf16_f32 v84, v16, v17
    v_mfma_f32_16x16x32_bf16 v[24:27], v[72:75], v[184:187], v[24:27]
    v_cvt_pk_bf16_f32 v86, v20, v21
    v_cvt_pk_bf16_f32 v85, v18, v19
    v_mfma_f32_16x16x32_bf16 v[28:31], v[72:75], v[192:195], v[28:31]
    v_cvt_pk_bf16_f32 v87, v22, v23
    v_permlane16_swap_b32_e64 v84, v86
    v_mfma_f32_16x16x32_bf16 v[32:35], v[72:75], v[200:203], v[32:35]
    v_cvt_pk_bf16_f32 v80, v64, v68
    v_cvt_pk_bf16_f32 v81, v65, v69
    s_waitcnt lgkmcnt(1)
    s_nop 0
    v_mfma_f32_16x16x32_bf16 v[48:51], v[140:143], v[232:235], 0
    v_cvt_pk_bf16_f32 v82, v66, v70
    v_cvt_pk_bf16_f32 v83, v67, v71
    v_mfma_f32_16x16x32_bf16 v[52:55], v[140:143], v[236:239], 0
    ds_read_b128 v[140:143], v226 offset:3072
    v_permlane16_swap_b32_e64 v85, v87
    v_mfma_f32_16x16x32_bf16 v[24:27], v[76:79], v[180:183], v[24:27]
    buffer_store_dwordx4 v[84:87], v228, s[16:19], s29 offen sc1
    s_add_u32 s29, s29, 0xa0000
    v_mfma_f32_16x16x32_bf16 v[28:31], v[76:79], v[188:191], v[28:31]
    v_mfma_f32_16x16x32_bf16 v[32:35], v[76:79], v[196:199], v[32:35]
    v_mfma_f32_16x16x32_bf16 v[56:59], v[144:147], v[232:235], 0
    v_cvt_pk_bf16_f32 v72, v48, v52
    v_cvt_pk_bf16_f32 v73, v49, v53
    v_mfma_f32_16x16x32_bf16 v[60:63], v[144:147], v[236:239], 0
    v_cvt_pk_bf16_f32 v74, v50, v54
    v_cvt_pk_bf16_f32 v75, v51, v55
    v_mfma_f32_16x16x32_bf16 v[28:31], v[80:83], v[184:187], v[28:31]
    v_mfma_f32_16x16x32_bf16 v[32:35], v[80:83], v[192:195], v[32:35]
    v_mfma_f32_16x16x32_bf16 v[36:39], v[80:83], v[200:203], v[36:39]
    v_mfma_f32_16x16x32_bf16 v[64:67], v[116:119], v[232:235], 0
    v_mfma_f32_16x16x32_bf16 v[68:71], v[116:119], v[236:239], 0
    v_mfma_f32_16x16x32_bf16 v[28:31], v[72:75], v[180:183], v[28:31]
    v_cvt_pk_bf16_f32 v76, v56, v60
    v_cvt_pk_bf16_f32 v77, v57, v61
    v_mfma_f32_16x16x32_bf16 v[32:35], v[72:75], v[188:191], v[32:35]
    v_cvt_pk_bf16_f32 v78, v58, v62
    v_cvt_pk_bf16_f32 v79, v59, v63
    v_mfma_f32_16x16x32_bf16 v[36:39], v[72:75], v[196:199], v[36:39]
    v_mfma_f32_16x16x32_bf16 v[48:51], v[120:123], v[232:235], 0
    v_cvt_pk_bf16_f32 v80, v64, v68
    v_cvt_pk_bf16_f32 v81, v65, v69
    v_mfma_f32_16x16x32_bf16 v[52:55], v[120:123], v[236:239], 0
    v_cvt_pk_bf16_f32 v82, v66, v70
    v_cvt_pk_bf16_f32 v83, v67, v71
    v_mfma_f32_16x16x32_bf16 v[32:35], v[76:79], v[184:187], v[32:35]
    v_cvt_pk_bf16_f32 v88, v24, v25
    v_cvt_pk_bf16_f32 v90, v28, v29
    v_mfma_f32_16x16x32_bf16 v[36:39], v[76:79], v[192:195], v[36:39]
    v_cvt_pk_bf16_f32 v89, v26, v27
    v_cvt_pk_bf16_f32 v91, v30, v31
    v_mfma_f32_16x16x32_bf16 v[40:43], v[76:79], v[200:203], v[40:43]
    v_cvt_pk_bf16_f32 v72, v48, v52
    v_cvt_pk_bf16_f32 v73, v49, v53
    v_mfma_f32_16x16x32_bf16 v[56:59], v[124:127], v[232:235], 0
    v_cvt_pk_bf16_f32 v74, v50, v54
    v_cvt_pk_bf16_f32 v75, v51, v55
    v_mfma_f32_16x16x32_bf16 v[60:63], v[124:127], v[236:239], 0
    v_permlane16_swap_b32_e64 v88, v90
    v_permlane16_swap_b32_e64 v89, v91
    v_mfma_f32_16x16x32_bf16 v[32:35], v[80:83], v[180:183], v[32:35]
    buffer_store_dwordx4 v[88:91], v228, s[16:19], s29 offen sc1
    s_add_u32 s29, s29, 0xa0000
    v_mfma_f32_16x16x32_bf16 v[36:39], v[80:83], v[188:191], v[36:39]
    v_mfma_f32_16x16x32_bf16 v[40:43], v[80:83], v[196:199], v[40:43]
    v_mfma_f32_16x16x32_bf16 v[64:67], v[128:131], v[232:235], 0
    v_cvt_pk_bf16_f32 v76, v56, v60
    v_cvt_pk_bf16_f32 v77, v57, v61
    v_mfma_f32_16x16x32_bf16 v[68:71], v[128:131], v[236:239], 0
    v_cvt_pk_bf16_f32 v78, v58, v62
    v_cvt_pk_bf16_f32 v79, v59, v63
    v_mfma_f32_16x16x32_bf16 v[36:39], v[72:75], v[184:187], v[36:39]
    v_mfma_f32_16x16x32_bf16 v[40:43], v[72:75], v[192:195], v[40:43]
    v_mfma_f32_16x16x32_bf16 v[44:47], v[72:75], v[200:203], v[44:47]
    v_mfma_f32_16x16x32_bf16 v[48:51], v[132:135], v[232:235], 0
    v_mfma_f32_16x16x32_bf16 v[52:55], v[132:135], v[236:239], 0
    v_mfma_f32_16x16x32_bf16 v[36:39], v[76:79], v[180:183], v[36:39]
    v_cvt_pk_bf16_f32 v80, v64, v68
    v_cvt_pk_bf16_f32 v81, v65, v69
    v_mfma_f32_16x16x32_bf16 v[40:43], v[76:79], v[188:191], v[40:43]
    v_cvt_pk_bf16_f32 v82, v66, v70
    v_cvt_pk_bf16_f32 v83, v67, v71
    v_mfma_f32_16x16x32_bf16 v[44:47], v[76:79], v[196:199], v[44:47]
    s_waitcnt lgkmcnt(0)
    s_nop 0
    v_mfma_f32_16x16x32_bf16 v[56:59], v[136:139], v[232:235], 0
    v_cvt_pk_bf16_f32 v72, v48, v52
    v_cvt_pk_bf16_f32 v73, v49, v53
    v_mfma_f32_16x16x32_bf16 v[60:63], v[136:139], v[236:239], 0
    v_cvt_pk_bf16_f32 v74, v50, v54
    v_cvt_pk_bf16_f32 v75, v51, v55
    v_mfma_f32_16x16x32_bf16 v[40:43], v[80:83], v[184:187], v[40:43]
    v_cvt_pk_bf16_f32 v92, v32, v33
    v_cvt_pk_bf16_f32 v94, v36, v37
    v_mfma_f32_16x16x32_bf16 v[44:47], v[80:83], v[192:195], v[44:47]
    v_cvt_pk_bf16_f32 v93, v34, v35
    v_cvt_pk_bf16_f32 v95, v38, v39
    v_mfma_f32_16x16x32_bf16 v[64:67], v[140:143], v[232:235], 0
    v_cvt_pk_bf16_f32 v76, v56, v60
    v_cvt_pk_bf16_f32 v77, v57, v61
    v_mfma_f32_16x16x32_bf16 v[68:71], v[140:143], v[236:239], 0
    v_cvt_pk_bf16_f32 v78, v58, v62
    v_cvt_pk_bf16_f32 v79, v59, v63
    v_mfma_f32_16x16x32_bf16 v[40:43], v[72:75], v[180:183], v[40:43]
    v_permlane16_swap_b32_e64 v92, v94
    v_permlane16_swap_b32_e64 v93, v95
    v_mfma_f32_16x16x32_bf16 v[44:47], v[72:75], v[188:191], v[44:47]
    buffer_store_dwordx4 v[92:95], v228, s[16:19], s29 offen sc1
    s_add_u32 s29, s29, 0xa0000
    v_cvt_pk_bf16_f32 v80, v64, v68
    v_mfma_f32_16x16x32_bf16 v[44:47], v[76:79], v[184:187], v[44:47]
    v_cvt_pk_bf16_f32 v81, v65, v69
    v_cvt_pk_bf16_f32 v82, v66, v70
    v_cvt_pk_bf16_f32 v83, v67, v71
    s_nop 0
    s_nop 0
    v_mfma_f32_16x16x32_bf16 v[44:47], v[80:83], v[180:183], v[44:47]
    v_cvt_pk_bf16_f32 v96, v40, v41
    s_nop 5
    s_nop 0
    v_cvt_pk_bf16_f32 v98, v44, v45
    v_cvt_pk_bf16_f32 v97, v42, v43
    v_cvt_pk_bf16_f32 v99, v46, v47
    v_permlane16_swap_b32_e64 v96, v98
    s_nop 0
    s_nop 0
    v_permlane16_swap_b32_e64 v97, v99
    buffer_store_dwordx4 v[96:99], v228, s[16:19], s29 offen sc1
    s_add_u32 s29, s29, 0xa0000
    s_add_u32 s40, s4, 15340544
    s_addc_u32 s41, s5, 0
    s_and_b32 s41, s41, 0xffff
    s_mov_b32 s42, 4096
    s_mov_b32 s43, 0x20000
    v_lshlrev_b32 v13, 9, v1
    s_and_b32 s46, s33, 3
    s_lshl_b32 s46, s46, 7
    s_waitcnt vmcnt(0)
    v_readfirstlane_b32 s49, v249
    s_cmp_lg_u32 s49, 0
    s_cbranch_scc1 S_ZE_OK
    s_mov_b32 s48, 0
S_ZE:
    buffer_load_dword v9, off, s[36:39], 0 offset:8 sc1
    s_add_u32 s48, s48, 1
    s_waitcnt vmcnt(0)
    v_readfirstlane_b32 s49, v9
    s_cmp_lg_u32 s49, 0
    s_cbranch_scc1 S_ZE_OK
    s_sleep 2
    s_cmp_lt_u32 s48, 262144
    s_cbranch_scc1 S_ZE
S_ZE_OK:
    v_mov_b32 v14, 1
    s_mov_b64 exec, 1
    ds_add_rtn_u32 v15, v230, v14 offset:20
    s_waitcnt lgkmcnt(0)
    v_readfirstlane_b32 s27, v15
    s_mov_b64 exec, -1
    s_cmp_lg_u32 s27, 3
    s_cbranch_scc1 M_FFN_C
    s_lshl_b32 s47, s46, 1
    s_add_u32 s47, s47, 15339520
    s_mov_b32 s49, 1
    s_atomic_add s49, s[4:5], s47 glc
    s_waitcnt lgkmcnt(0)
    s_cmp_lg_u32 s49, 39
    s_cbranch_scc1 M_FFN_C
    buffer_store_dword v14, v13, s[40:43], s46 offen sc0 sc1
    s_branch M_FFN_C
M_J:
    s_cmp_ge_u32 s33, 27
    s_cselect_b32 s29, 1, 0
    s_cselect_b32 s58, s74, s72
    s_cselect_b32 s59, s75, s73
    s_mov_b32 s36, s80
    s_and_b32 s37, s81, 0xffff
    s_mov_b32 s38, 256
    s_mov_b32 s39, 0x20000
    s_add_u32 s16, s4, 15335424
    s_addc_u32 s17, s5, 0
    s_and_b32 s17, s17, 0xffff
    s_mov_b32 s18, 13824
    s_mov_b32 s19, 0x20000
    s_cmp_eq_u32 s26, 672
    s_cselect_b32 s18, s18, 0
    v_lshlrev_b32 v2, 8, v1
    v_mov_b32 v48, 0
    v_mov_b32 v49, 0
    v_mov_b32 v50, 0
    v_mov_b32 v51, 0
    buffer_store_dwordx4 v[48:51], v2, s[16:19], 0 offen sc0 sc1
    buffer_store_dwordx4 v[48:51], v2, s[16:19], 0 offen offset:128 sc0 sc1
    s_add_u32 s12, s4, 15400960
    s_addc_u32 s13, s5, 0
    s_and_b32 s13, s13, 0xffff
    s_mov_b32 s14, 16384
    s_mov_b32 s15, 0x20000
    v_mov_b32 v14, 0x3f803f80
    s_mov_b32 s46, 0
    s_waitcnt vmcnt(2)
    buffer_load_dword v61, off, s[36:39], 0 sc1
J_ST:
    v_mov_b32 v12, 0
    v_mov_b32 v13, 0
    v_dot2c_f32_bf16 v12, v16, v14
    v_dot2c_f32_bf16 v13, v16, v16
    v_dot2c_f32_bf16 v12, v17, v14
    v_dot2c_f32_bf16 v13, v17, v17
    v_dot2c_f32_bf16 v12, v18, v14
    v_dot2c_f32_bf16 v13, v18, v18
    v_dot2c_f32_bf16 v12, v19, v14
    v_dot2c_f32_bf16 v13, v19, v19
PADA2:
    s_cbranch_execz PAD_RET
    s_nop 0
    v_dot2c_f32_bf16 v12, v20, v14
    v_dot2c_f32_bf16 v13, v20, v20
    v_dot2c_f32_bf16 v12, v21, v14
    v_dot2c_f32_bf16 v13, v21, v21
    v_dot2c_f32_bf16 v12, v22, v14
    v_dot2c_f32_bf16 v13, v22, v22
    v_dot2c_f32_bf16 v12, v23, v14
    v_dot2c_f32_bf16 v13, v23, v23
    v_dot2c_f32_bf16 v12, v24, v14
    v_dot2c_f32_bf16 v13, v24, v24
    v_dot2c_f32_bf16 v12, v25, v14
    v_dot2c_f32_bf16 v13, v25, v25
    v_dot2c_f32_bf16 v12, v26, v14
    v_dot2c_f32_bf16 v13, v26, v26
    v_dot2c_f32_bf16 v12, v27, v14
    v_dot2c_f32_bf16 v13, v27, v27
    s_nop 2
    v_add_f32_dpp v12, v12, v12 row_ror:1 row_mask:0xf bank_mask:0xf
    v_add_f32_dpp v13, v13, v13 row_ror:1 row_mask:0xf bank_mask:0xf
    s_nop 0
    v_add_f32_dpp v12, v12, v12 row_ror:2 row_mask:0xf bank_mask:0xf
    v_add_f32_dpp v13, v13, v13 row_ror:2 row_mask:0xf bank_mask:0xf
    s_nop 0
    v_add_f32_dpp v12, v12, v12 row_ror:4 row_mask:0xf bank_mask:0xf
    v_add_f32_dpp v13, v13, v13 row_ror:4 row_mask:0xf bank_mask:0xf
    s_nop 0
    v_add_f32_dpp v12, v12, v12 row_ror:8 row_mask:0xf bank_mask:0xf
    v_add_f32_dpp v13, v13, v13 row_ror:8 row_mask:0xf bank_mask:0xf
    s_nop 0
    v_mov_b32 v40, v12
    v_mov_b32 v41, v13
    s_nop 1
    v_permlane16_swap_b32 v40, v12
    v_permlane16_swap_b32 v41, v13
    s_nop 1
    v_add_f32 v12, v12, v40
    v_add_f32 v13, v13, v41
    v_mul_f32 v12, 0x3acccccd, v12
    v_mul_f32 v13, 0x3acccccd, v13
    v_fma_f32 v13, -v12, v12, v13
    v_max_f32 v13, 0, v13
    v_add_f32 v13, 0x3727c5ac, v13
    v_rsq_f32 v40, v13
    s_nop 0
    v_mul_f32 v41, -v12, v40
    v_mov_b32 v42, v40
    v_mov_b32 v43, v41
    s_nop 1
    v_permlane32_swap_b32 v40, v42
    v_permlane32_swap_b32 v41, v43
    s_cmp_lg_u32 s46, 0
    s_cbranch_scc1 J_NOK
    s_mov_b32 s48, 0
    s_waitcnt vmcnt(0)
J_NP:
    v_readfirstlane_b32 s46, v61
    s_add_u32 s48, s48, 1
    s_cmp_lg_u32 s46, 0
    s_cbranch_scc1 J_NOK
    buffer_load_dword v61, off, s[36:39], 0 sc1
    s_cmp_lt_u32 s48, 262144
    s_waitcnt vmcnt(0)
    s_cbranch_scc1 J_NP
J_NOK:
    s_mov_b32 s47, 117835008
    v_perm_b32 v44, v40, v61, s47
    s_mov_b32 s47, 117835009
    v_perm_b32 v45, v42, v61, s47
    s_mov_b32 s47, 117835010
    v_perm_b32 v46, v41, v61, s47
    s_mov_b32 s47, 117835011
    v_perm_b32 v47, v43, v61, s47
    s_lshl_b32 s27, s26, 4
    s_mov_b64 exec, 1
    buffer_store_dwordx4 v[44:47], off, s[12:15], s27 sc1
    s_mov_b64 exec, -1
    s_cmp_ge_u32 s26, 256
    s_cbranch_scc1 J_ST2
    s_add_u32 s26, s26, 768
    v_mov_b32 v16, v28
    v_mov_b32 v17, v29
    v_mov_b32 v18, v30
    v_mov_b32 v19, v31
    v_mov_b32 v20, v32
    v_mov_b32 v21, v33
    v_mov_b32 v22, v34
    v_mov_b32 v23, v35
    v_mov_b32 v24, v36
    v_mov_b32 v25, v37
    v_mov_b32 v26, v38
    v_mov_b32 v27, v39
    s_branch J_ST
J_ST2:
    s_cmp_lg_u32 s26, 672
    s_cbranch_scc1 J_NZ
    v_mov_b32 v4, 1
    s_mov_b64 exec, 1
    buffer_store_dword v4, off, s[36:39], 0 offset:8 sc0 sc1
    s_mov_b64 exec, -1
J_NZ:
    s_cmp_ge_u32 s33, 54
    s_cbranch_scc1 J_WD
    s_mul_i32 s23, s29, 27
    s_sub_u32 s23, s33, s23
    s_mov_b32 s16, s58
    s_and_b32 s17, s59, 0xffff
    s_mov_b32 s18, 2211840
    s_mov_b32 s19, 0x20000
    v_lshrrev_b32 v2, 3, v1
    v_mul_u32_u24 v5, 3456, v2
    v_and_b32 v3, 7, v1
    v_lshl_add_u32 v5, v3, 4, v5
    s_lshl_b32 s26, s23, 7
    s_mul_i32 s27, s24, 27648
    s_add_u32 s26, s26, s27
    buffer_load_dwordx4 v[72:75], v5, s[16:19], s26 offen
    s_add_u32 s26, s26, 221184
    buffer_load_dwordx4 v[76:79], v5, s[16:19], s26 offen
    s_add_u32 s26, s26, 221184
    buffer_load_dwordx4 v[80:83], v5, s[16:19], s26 offen
    s_add_u32 s26, s26, 221184
    v_mov_b32 v16, 0
    v_mov_b32 v17, 0
    v_mov_b32 v18, 0
    v_mov_b32 v19, 0
    v_mov_b32 v20, 0
    v_mov_b32 v21, 0
    v_mov_b32 v22, 0
    v_mov_b32 v23, 0
    s_waitcnt vmcnt(2)
    buffer_load_dwordx4 v[84:87], v5, s[16:19], s26 offen
    s_add_u32 s26, s26, 221184
    buffer_load_dwordx4 v[88:91], v5, s[16:19], s26 offen
    s_add_u32 s26, s26, 221184
    buffer_load_dwordx4 v[92:95], v5, s[16:19], s26 offen
    s_add_u32 s26, s26, 221184
    buffer_load_dwordx4 v[96:99], v5, s[16:19], s26 offen
    s_add_u32 s26, s26, 221184
    buffer_load_dwordx4 v[100:103], v5, s[16:19], s26 offen
    s_add_u32 s26, s26, 221184
    buffer_load_dwordx4 v[104:107], v5, s[16:19], s26 offen
    s_add_u32 s26, s26, 221184
    buffer_load_dwordx4 v[108:111], v5, s[16:19], s26 offen
    s_add_u32 s26, s26, 221184
    v_lshlrev_b32 v24, 16, v72
    v_and_b32 v25, 0xffff0000, v72
    v_pk_add_f32 v[16:17], v[16:17], v[24:25]
    v_lshlrev_b32 v24, 16, v73
    v_and_b32 v25, 0xffff0000, v73
    v_pk_add_f32 v[18:19], v[18:19], v[24:25]
    v_lshlrev_b32 v24, 16, v74
    v_and_b32 v25, 0xffff0000, v74
    v_pk_add_f32 v[20:21], v[20:21], v[24:25]
    v_lshlrev_b32 v24, 16, v75
    v_and_b32 v25, 0xffff0000, v75
    v_pk_add_f32 v[22:23], v[22:23], v[24:25]
    s_waitcnt vmcnt(8)
    v_lshlrev_b32 v24, 16, v76
    v_and_b32 v25, 0xffff0000, v76
    v_pk_add_f32 v[16:17], v[16:17], v[24:25]
    v_lshlrev_b32 v24, 16, v77
    v_and_b32 v25, 0xffff0000, v77
    v_pk_add_f32 v[18:19], v[18:19], v[24:25]
    v_lshlrev_b32 v24, 16, v78
    v_and_b32 v25, 0xffff0000, v78
    v_pk_add_f32 v[20:21], v[20:21], v[24:25]
    v_lshlrev_b32 v24, 16, v79
    v_and_b32 v25, 0xffff0000, v79
    v_pk_add_f32 v[22:23], v[22:23], v[24:25]
    s_waitcnt vmcnt(7)
    v_lshlrev_b32 v24, 16, v80
    v_and_b32 v25, 0xffff0000, v80
    v_pk_add_f32 v[16:17], v[16:17], v[24:25]
    v_lshlrev_b32 v24, 16, v81
    v_and_b32 v25, 0xffff0000, v81
    v_pk_add_f32 v[18:19], v[18:19], v[24:25]
    v_lshlrev_b32 v24, 16, v82
    v_and_b32 v25, 0xffff0000, v82
    v_pk_add_f32 v[20:21], v[20:21], v[24:25]
    v_lshlrev_b32 v24, 16, v83
    v_and_b32 v25, 0xffff0000, v83
    v_pk_add_f32 v[22:23], v[22:23], v[24:25]
    s_waitcnt vmcnt(6)
    v_lshlrev_b32 v24, 16, v84
    v_and_b32 v25, 0xffff0000, v84
    v_pk_add_f32 v[16:17], v[16:17], v[24:25]
    v_lshlrev_b32 v24, 16, v85
    v_and_b32 v25, 0xffff0000, v85
    v_pk_add_f32 v[18:19], v[18:19], v[24:25]
    v_lshlrev_b32 v24, 16, v86
    v_and_b32 v25, 0xffff0000, v86
    v_pk_add_f32 v[20:21], v[20:21], v[24:25]
    v_lshlrev_b32 v24, 16, v87
    v_and_b32 v25, 0xffff0000, v87
    v_pk_add_f32 v[22:23], v[22:23], v[24:25]
    s_waitcnt vmcnt(5)
    v_lshlrev_b32 v24, 16, v88
    v_and_b32 v25, 0xffff0000, v88
    v_pk_add_f32 v[16:17], v[16:17], v[24:25]
    v_lshlrev_b32 v24, 16, v89
    v_and_b32 v25, 0xffff0000, v89
    v_pk_add_f32 v[18:19], v[18:19], v[24:25]
    v_lshlrev_b32 v24, 16, v90
    v_and_b32 v25, 0xffff0000, v90
    v_pk_add_f32 v[20:21], v[20:21], v[24:25]
    v_lshlrev_b32 v24, 16, v91
    v_and_b32 v25, 0xffff0000, v91
    v_pk_add_f32 v[22:23], v[22:23], v[24:25]
    s_waitcnt vmcnt(4)
    v_lshlrev_b32 v24, 16, v92
    v_and_b32 v25, 0xffff0000, v92
    v_pk_add_f32 v[16:17], v[16:17], v[24:25]
    v_lshlrev_b32 v24, 16, v93
    v_and_b32 v25, 0xffff0000, v93
    v_pk_add_f32 v[18:19], v[18:19], v[24:25]
    v_lshlrev_b32 v24, 16, v94
    v_and_b32 v25, 0xffff0000, v94
    v_pk_add_f32 v[20:21], v[20:21], v[24:25]
    v_lshlrev_b32 v24, 16, v95
    v_and_b32 v25, 0xffff0000, v95
    v_pk_add_f32 v[22:23], v[22:23], v[24:25]
    s_waitcnt vmcnt(3)
    v_lshlrev_b32 v24, 16, v96
    v_and_b32 v25, 0xffff0000, v96
    v_pk_add_f32 v[16:17], v[16:17], v[24:25]
    v_lshlrev_b32 v24, 16, v97
    v_and_b32 v25, 0xffff0000, v97
    v_pk_add_f32 v[18:19], v[18:19], v[24:25]
    v_lshlrev_b32 v24, 16, v98
    v_and_b32 v25, 0xffff0000, v98
    v_pk_add_f32 v[20:21], v[20:21], v[24:25]
    v_lshlrev_b32 v24, 16, v99
    v_and_b32 v25, 0xffff0000, v99
    v_pk_add_f32 v[22:23], v[22:23], v[24:25]
    s_waitcnt vmcnt(2)
    v_lshlrev_b32 v24, 16, v100
    v_and_b32 v25, 0xffff0000, v100
    v_pk_add_f32 v[16:17], v[16:17], v[24:25]
    v_lshlrev_b32 v24, 16, v101
    v_and_b32 v25, 0xffff0000, v101
    v_pk_add_f32 v[18:19], v[18:19], v[24:25]
    v_lshlrev_b32 v24, 16, v102
    v_and_b32 v25, 0xffff0000, v102
    v_pk_add_f32 v[20:21], v[20:21], v[24:25]
    v_lshlrev_b32 v24, 16, v103
    v_and_b32 v25, 0xffff0000, v103
    v_pk_add_f32 v[22:23], v[22:23], v[24:25]
    s_waitcnt vmcnt(1)
    v_lshlrev_b32 v24, 16, v104
    v_and_b32 v25, 0xffff0000, v104
    v_pk_add_f32 v[16:17], v[16:17], v[24:25]
    v_lshlrev_b32 v24, 16, v105
    v_and_b32 v25, 0xffff0000, v105
    v_pk_add_f32 v[18:19], v[18:19], v[24:25]
    v_lshlrev_b32 v24, 16, v106
    v_and_b32 v25, 0xffff0000, v106
    v_pk_add_f32 v[20:21], v[20:21], v[24:25]
    v_lshlrev_b32 v24, 16, v107
    v_and_b32 v25, 0xffff0000, v107
    v_pk_add_f32 v[22:23], v[22:23], v[24:25]
    s_waitcnt vmcnt(0)
    v_lshlrev_b32 v24, 16, v108
    v_and_b32 v25, 0xffff0000, v108
    v_pk_add_f32 v[16:17], v[16:17], v[24:25]
    v_lshlrev_b32 v24, 16, v109
    v_and_b32 v25, 0xffff0000, v109
    v_pk_add_f32 v[18:19], v[18:19], v[24:25]
    v_lshlrev_b32 v24, 16, v110
    v_and_b32 v25, 0xffff0000, v110
    v_pk_add_f32 v[20:21], v[20:21], v[24:25]
    v_lshlrev_b32 v24, 16, v111
    v_and_b32 v25, 0xffff0000, v111
    v_pk_add_f32 v[22:23], v[22:23], v[24:25]
    s_lshl_b32 s27, s24, 11
    s_add_u32 s27, s27, 0
    v_lshlrev_b32 v10, 5, v1
    v_add_u32 v10, s27, v10
    ds_write_b128 v10, v[16:19]
    ds_write_b128 v10, v[20:23] offset:16
    s_mov_b32 s48, 0
J_ZC:
    buffer_load_dword v9, off, s[36:39], 0 offset:8 sc1
    s_add_u32 s48, s48, 1
    s_waitcnt vmcnt(0)
    v_readfirstlane_b32 s49, v9
    s_cmp_lg_u32 s49, 0
    s_cbranch_scc1 J_ZC_OK
    s_sleep 2
    s_cmp_lt_u32 s48, 262144
    s_cbranch_scc1 J_ZC
J_ZC_OK:
    s_waitcnt lgkmcnt(0)
    s_barrier
    s_cmp_lg_u32 s24, 7
    s_cbranch_scc1 J_OUTB
    s_add_u32 s12, s4, 15302656
    s_addc_u32 s13, s5, 0
    s_and_b32 s13, s13, 0xffff
    s_mov_b32 s14, 14336
    s_mov_b32 s15, 0x20000
    v_lshlrev_b32 v10, 2, v1
    v_add_u32 v11, 0, v10
    v_mov_b32 v16, 0
    v_mov_b32 v17, 0
    ds_read2st64_b32 v[32:33], v11 offset0:0 offset1:1
    ds_read2st64_b32 v[34:35], v11 offset0:2 offset1:3
    ds_read2st64_b32 v[36:37], v11 offset0:4 offset1:5
    ds_read2st64_b32 v[38:39], v11 offset0:6 offset1:7
    ds_read2st64_b32 v[40:41], v11 offset0:8 offset1:9
    ds_read2st64_b32 v[42:43], v11 offset0:10 offset1:11
    ds_read2st64_b32 v[44:45], v11 offset0:12 offset1:13
    ds_read2st64_b32 v[46:47], v11 offset0:14 offset1:15
    s_waitcnt lgkmcnt(0)
    v_pk_add_f32 v[16:17], v[16:17], v[32:33]
    v_pk_add_f32 v[16:17], v[16:17], v[34:35]
    v_pk_add_f32 v[16:17], v[16:17], v[36:37]
    v_pk_add_f32 v[16:17], v[16:17], v[38:39]
    v_pk_add_f32 v[16:17], v[16:17], v[40:41]
    v_pk_add_f32 v[16:17], v[16:17], v[42:43]
    v_pk_add_f32 v[16:17], v[16:17], v[44:45]
    v_pk_add_f32 v[16:17], v[16:17], v[46:47]
    ds_read2st64_b32 v[32:33], v11 offset0:16 offset1:17
    ds_read2st64_b32 v[34:35], v11 offset0:18 offset1:19
    ds_read2st64_b32 v[36:37], v11 offset0:20 offset1:21
    ds_read2st64_b32 v[38:39], v11 offset0:22 offset1:23
    ds_read2st64_b32 v[40:41], v11 offset0:24 offset1:25
    ds_read2st64_b32 v[42:43], v11 offset0:26 offset1:27
    ds_read2st64_b32 v[44:45], v11 offset0:28 offset1:29
    ds_read2st64_b32 v[46:47], v11 offset0:30 offset1:31
    s_waitcnt lgkmcnt(0)
    v_pk_add_f32 v[16:17], v[16:17], v[32:33]
    v_pk_add_f32 v[16:17], v[16:17], v[34:35]
    v_pk_add_f32 v[16:17], v[16:17], v[36:37]
    v_pk_add_f32 v[16:17], v[16:17], v[38:39]
    v_pk_add_f32 v[16:17], v[16:17], v[40:41]
    v_pk_add_f32 v[16:17], v[16:17], v[42:43]
    v_pk_add_f32 v[16:17], v[16:17], v[44:45]
    v_pk_add_f32 v[16:17], v[16:17], v[46:47]
    ds_read2st64_b32 v[32:33], v11 offset0:32 offset1:33
    ds_read2st64_b32 v[34:35], v11 offset0:34 offset1:35
    ds_read2st64_b32 v[36:37], v11 offset0:36 offset1:37
    ds_read2st64_b32 v[38:39], v11 offset0:38 offset1:39
    ds_read2st64_b32 v[40:41], v11 offset0:40 offset1:41
    ds_read2st64_b32 v[42:43], v11 offset0:42 offset1:43
    ds_read2st64_b32 v[44:45], v11 offset0:44 offset1:45
    ds_read2st64_b32 v[46:47], v11 offset0:46 offset1:47
    s_waitcnt lgkmcnt(0)
    v_pk_add_f32 v[16:17], v[16:17], v[32:33]
    v_pk_add_f32 v[16:17], v[16:17], v[34:35]
    v_pk_add_f32 v[16:17], v[16:17], v[36:37]
    v_pk_add_f32 v[16:17], v[16:17], v[38:39]
    v_pk_add_f32 v[16:17], v[16:17], v[40:41]
    v_pk_add_f32 v[16:17], v[16:17], v[42:43]
    v_pk_add_f32 v[16:17], v[16:17], v[44:45]
    v_pk_add_f32 v[16:17], v[16:17], v[46:47]
    ds_read2st64_b32 v[32:33], v11 offset0:48 offset1:49
    ds_read2st64_b32 v[34:35], v11 offset0:50 offset1:51
    ds_read2st64_b32 v[36:37], v11 offset0:52 offset1:53
    ds_read2st64_b32 v[38:39], v11 offset0:54 offset1:55
    ds_read2st64_b32 v[40:41], v11 offset0:56 offset1:57
    ds_read2st64_b32 v[42:43], v11 offset0:58 offset1:59
    ds_read2st64_b32 v[44:45], v11 offset0:60 offset1:61
    ds_read2st64_b32 v[46:47], v11 offset0:62 offset1:63
    s_waitcnt lgkmcnt(0)
    v_pk_add_f32 v[16:17], v[16:17], v[32:33]
    v_pk_add_f32 v[16:17], v[16:17], v[34:35]
    v_pk_add_f32 v[16:17], v[16:17], v[36:37]
    v_pk_add_f32 v[16:17], v[16:17], v[38:39]
    v_pk_add_f32 v[16:17], v[16:17], v[40:41]
    v_pk_add_f32 v[16:17], v[16:17], v[42:43]
    v_pk_add_f32 v[16:17], v[16:17], v[44:45]
    v_pk_add_f32 v[16:17], v[16:17], v[46:47]
    v_add_f32 v16, v16, v17
    s_mul_i32 s30, s29, 7168
    s_lshl_b32 s27, s23, 8
    s_add_u32 s30, s30, s27
    buffer_store_dword v16, v10, s[12:15], s30 offen sc1
    s_barrier
J_ARR:
    s_mov_b32 s47, 15344640
    s_mov_b32 s49, 1
    s_waitcnt vmcnt(0)
    s_atomic_add s49, s[4:5], s47 glc
    s_add_u32 s12, s4, 15344896
    s_addc_u32 s13, s5, 0
    s_and_b32 s13, s13, 0xffff
    s_mov_b32 s14, 4
    s_mov_b32 s15, 0x20000
    v_mov_b32 v16, 1
    v_lshlrev_b32 v10, 2, v1
    s_waitcnt lgkmcnt(0)
    s_cmp_lg_u32 s49, 85
    s_cbranch_scc1 J_NG
    buffer_store_dword v16, v10, s[12:15], 0 offen sc0 sc1
J_NG:
    s_branch J_OUT
J_WD:
    s_cmp_ge_u32 s33, 64
    s_cbranch_scc1 J_WD2
    s_mov_b32 s48, 0
J_ZF:
    buffer_load_dword v9, off, s[36:39], 0 offset:8 sc1
    s_add_u32 s48, s48, 1
    s_waitcnt vmcnt(0)
    v_readfirstlane_b32 s49, v9
    s_cmp_lg_u32 s49, 0
    s_cbranch_scc1 J_ZF_OK
    s_sleep 2
    s_cmp_lt_u32 s48, 262144
    s_cbranch_scc1 J_ZF
J_ZF_OK:
    s_branch J_OUT
J_WD2:
    s_mov_b32 s40, s76
    s_and_b32 s41, s77, 0xffff
    s_mov_b32 s42, 2211840
    s_mov_b32 s43, 0x20000
    s_sub_u32 s22, s33, 64
    s_mul_i32 s31, s22, 40960
    s_mul_i32 s27, s24, 5120
    s_add_u32 s31, s31, s27
    s_add_u32 s28, s31, 1310720
    v_lshlrev_b32 v6, 4, v1
    v_add_u32 v7, 4096, v6
    s_add_u32 m0, s27, 0
    s_nop 0
    buffer_load_dwordx4 v6, s[40:43], s31 offen offset:0 lds
    s_waitcnt vmcnt(2)
    s_add_u32 m0, s27, 0
    s_nop 0
    buffer_load_dwordx4 v6, s[40:43], s31 offen offset:1024 lds
    s_waitcnt vmcnt(2)
    s_add_u32 m0, s27, 0
    s_nop 0
    buffer_load_dwordx4 v6, s[40:43], s31 offen offset:2048 lds
    s_waitcnt vmcnt(2)
    s_add_u32 m0, s27, 0
    s_nop 0
    buffer_load_dwordx4 v6, s[40:43], s31 offen offset:3072 lds
    s_add_u32 m0, s27, 4096
    s_nop 0
    buffer_load_dwordx4 v7, s[40:43], s31 offen offset:0 lds
    s_add_u32 m0, s27, 40960
    s_nop 0
    buffer_load_dwordx4 v6, s[40:43], s28 offen offset:0 lds
    s_add_u32 m0, s27, 40960
    s_nop 0
    buffer_load_dwordx4 v6, s[40:43], s28 offen offset:1024 lds
    s_add_u32 m0, s27, 40960
    s_nop 0
    buffer_load_dwordx4 v6, s[40:43], s28 offen offset:2048 lds
    s_add_u32 m0, s27, 40960
    s_nop 0
    buffer_load_dwordx4 v6, s[40:43], s28 offen offset:3072 lds
    s_add_u32 m0, s27, 45056
    s_nop 0
    buffer_load_dwordx4 v7, s[40:43], s28 offen offset:0 lds
    s_mul_i32 s26, s24, 276480
    s_add_u32 s26, s26, 20971520
    s_add_u32 s12, s4, s26
    s_addc_u32 s13, s5, 0
    s_and_b32 s13, s13, 0xffff
    s_mov_b32 s14, 276480
    s_mov_b32 s15, 0x20000
    v_lshrrev_b32 v2, 2, v1
    v_mul_u32_u24 v2, 1280, v2
    v_and_b32 v3, 3, v1
    v_mul_u32_u24 v3, 40, v3
    s_mul_i32 s27, s24, 160
    v_add3_u32 v4, v2, v3, s27
    s_mul_i32 s31, s22, 5120
    s_waitcnt vmcnt(0)
    s_barrier
    ds_read_b64_tr_b16 v[48:49], v4 offset:0
    ds_read_b64_tr_b16 v[50:51], v4 offset:20480
    ds_read_b64_tr_b16 v[52:53], v4 offset:8
    ds_read_b64_tr_b16 v[54:55], v4 offset:20488
    ds_read_b64_tr_b16 v[56:57], v4 offset:16
    ds_read_b64_tr_b16 v[58:59], v4 offset:20496
    ds_read_b64_tr_b16 v[60:61], v4 offset:24
    ds_read_b64_tr_b16 v[62:63], v4 offset:20504
    ds_read_b64_tr_b16 v[64:65], v4 offset:32
    ds_read_b64_tr_b16 v[66:67], v4 offset:20512
    s_waitcnt lgkmcnt(8)
    buffer_store_dwordx4 v[48:51], v6, s[12:15], s31 offen offset:0 sc1
    s_waitcnt lgkmcnt(6)
    buffer_store_dwordx4 v[52:55], v6, s[12:15], s31 offen offset:1024 sc1
    s_waitcnt lgkmcnt(4)
    buffer_store_dwordx4 v[56:59], v6, s[12:15], s31 offen offset:2048 sc1
    s_waitcnt lgkmcnt(2)
    buffer_store_dwordx4 v[60:63], v6, s[12:15], s31 offen offset:3072 sc1
    s_waitcnt lgkmcnt(0)
    buffer_store_dwordx4 v[64:67], v7, s[12:15], s31 offen sc1
    s_add_u32 s31, s31, 163840
    ds_read_b64_tr_b16 v[68:69], v4 offset:40960
    ds_read_b64_tr_b16 v[70:71], v4 offset:61440
    ds_read_b64_tr_b16 v[72:73], v4 offset:40968
    ds_read_b64_tr_b16 v[74:75], v4 offset:61448
    ds_read_b64_tr_b16 v[76:77], v4 offset:40976
    ds_read_b64_tr_b16 v[78:79], v4 offset:61456
    ds_read_b64_tr_b16 v[80:81], v4 offset:40984
    ds_read_b64_tr_b16 v[82:83], v4 offset:61464
    ds_read_b64_tr_b16 v[84:85], v4 offset:40992
    ds_read_b64_tr_b16 v[86:87], v4 offset:61472
    s_waitcnt lgkmcnt(8)
    buffer_store_dwordx4 v[68:71], v6, s[12:15], s31 offen offset:0 sc1
    s_waitcnt lgkmcnt(6)
    buffer_store_dwordx4 v[72:75], v6, s[12:15], s31 offen offset:1024 sc1
    s_waitcnt lgkmcnt(4)
    buffer_store_dwordx4 v[76:79], v6, s[12:15], s31 offen offset:2048 sc1
    s_waitcnt lgkmcnt(2)
    buffer_store_dwordx4 v[80:83], v6, s[12:15], s31 offen offset:3072 sc1
    s_waitcnt lgkmcnt(0)
    buffer_store_dwordx4 v[84:87], v7, s[12:15], s31 offen sc1
    s_add_u32 s31, s31, 163840
    s_mov_b32 s48, 0
J_ZD:
    buffer_load_dword v9, off, s[36:39], 0 offset:8 sc1
    s_add_u32 s48, s48, 1
    s_waitcnt vmcnt(0)
    v_readfirstlane_b32 s49, v9
    s_cmp_lg_u32 s49, 0
    s_cbranch_scc1 J_ZD_OK
    s_sleep 2
    s_cmp_lt_u32 s48, 262144
    s_cbranch_scc1 J_ZD
J_ZD_OK:
    s_barrier
    s_cmp_eq_u32 s24, 7
    s_cbranch_scc1 J_ARR
    s_branch J_OUT
J_OUTB:
    s_barrier
J_OUT:
    s_cmp_ge_u32 s24, 4
    s_cbranch_scc1 M_FFN_C
    s_branch M_FFN_L
M_SPLIT:
M_FFN_L:
    s_mul_i32 s26, s21, 37
    s_lshr_b32 s26, s26, 8
    s_and_b32 s22, s20, 3
    s_lshl_b32 s22, s22, 2
    s_add_u32 s22, s22, s26
    s_lshr_b32 s23, s20, 2
    s_sub_u32 s23, s23, s26
    s_mul_i32 s23, s23, 7
    s_add_u32 s23, s23, s21
    s_and_b32 s26, s26, 1
    s_cselect_b32 s62, 6, 13
    s_cmp_eq_u32 s23, s62
    s_cselect_b32 s62, 1, 0
    s_lshr_b32 s27, s20, 2
    s_and_b32 s26, s26, s27
    s_lshl_b32 s23, s23, 1
    s_sub_u32 s23, s23, s26
    s_and_b32 s44, s20, 3
    s_lshl_b32 s44, s44, 3
    s_and_b32 s26, s21, 7
    s_add_u32 s44, s44, s26
    s_lshr_b32 s45, s20, 2
    s_lshl_b32 s45, s45, 2
    s_lshr_b32 s26, s21, 3
    s_add_u32 s45, s45, s26
    s_mul_i32 s27, s45, 276480
    s_add_u32 s27, s27, 20971520
    s_add_u32 s52, s4, s27
    s_addc_u32 s53, s5, 0
    s_and_b32 s53, s53, 0xffff
    s_mov_b32 s54, 276480
    s_mov_b32 s55, 0x20000
    s_add_u32 s40, s4, 15269888
    s_addc_u32 s41, s5, 0
    s_and_b32 s41, s41, 0xffff
    s_mov_b32 s42, 49152
    s_mov_b32 s43, 0x20000
    v_lshlrev_b32 v6, 4, v1
    s_add_u32 s36, s4, 15335424
    s_addc_u32 s37, s5, 0
    s_and_b32 s37, s37, 0xffff
    s_mov_b32 s38, 13824
    s_mov_b32 s39, 0x20000
    s_mul_i32 s50, s25, 10240
    s_cmp_ge_u32 s21, 28
    s_cbranch_scc1 F_L_STAT
    s_mul_i32 s26, s22, 163840
    s_add_u32 s26, s26, 12582912
    s_add_u32 s8, s4, s26
    s_addc_u32 s9, s5, 0
    s_and_b32 s9, s9, 0xffff
    s_mov_b32 s10, 163840
    s_mov_b32 s11, 0x20000
    v_lshrrev_b32 v10, 4, v1
    v_lshlrev_b32 v11, 5, v10
    v_xor_b32 v2, v6, v11
    v_xor_b32 v3, 128, v2
    v_and_b32 v4, 255, v2
    v_xor_b32 v5, 128, v4
    v_mul_u32_u24 v10, 3456, v10
    s_cmp_eq_u32 s62, 1
    s_cselect_b32 s26, 1, 2
    s_lshl_b32 s26, s26, 7
    v_mov_b32 v11, 0x7fff0000
    v_cmp_gt_u32 vcc, s26, v4
    v_add_u32 v4, v4, v10
    s_nop 0
    v_cndmask_b32 v4, v11, v4, vcc
    v_cmp_gt_u32 vcc, s26, v5
    v_add_u32 v5, v5, v10
    v_add_u32 v5, 12800, v5
    v_cndmask_b32 v5, v11, v5, vcc
    s_lshl_b32 s32, s25, 11
    s_mov_b32 s34, s32
    s_mul_i32 s33, s25, 27648
    s_lshl_b32 s26, s23, 7
    s_add_u32 s33, s33, s26
    v_add_u32 v13, s34, v6
    v_add_u32 v12, 24576, v13
    v_add_u32 v13, 98304, v13
    s_mov_b32 s12, s72
    s_and_b32 s13, s73, 0xffff
    s_mov_b32 s14, 2211840
    s_mov_b32 s15, 0x20000
    s_mov_b32 s16, s74
    s_and_b32 s17, s75, 0xffff
    s_mov_b32 s18, 2211840
    s_mov_b32 s19, 0x20000
    s_add_u32 m0, s34, 122880
    s_nop 0
    buffer_load_dwordx4 v4, s[12:15], s33 offen lds
    buffer_load_dwordx4 v5, s[12:15], s33 offen offset:1024 lds
    s_add_u32 m0, s34, 131072
    s_nop 0
    buffer_load_dwordx4 v4, s[16:19], s33 offen lds
    buffer_load_dwordx4 v5, s[16:19], s33 offen offset:1024 lds
    s_add_u32 s33, s33, 110592
    s_add_u32 m0, s34, 147456
    s_nop 0
    buffer_load_dwordx4 v4, s[12:15], s33 offen lds
    buffer_load_dwordx4 v5, s[12:15], s33 offen offset:1024 lds
    s_add_u32 m0, s34, 155648
    s_nop 0
    buffer_load_dwordx4 v4, s[16:19], s33 offen lds
    buffer_load_dwordx4 v5, s[16:19], s33 offen offset:1024 lds
    s_add_u32 s33, s33, 110592
    s_add_u32 m0, s34, 24576
    s_nop 0
    buffer_load_dwordx4 v4, s[12:15], s33 offen lds
    buffer_load_dwordx4 v5, s[12:15], s33 offen offset:1024 lds
    s_add_u32 m0, s34, 32768
    s_nop 0
    buffer_load_dwordx4 v4, s[16:19], s33 offen lds
    buffer_load_dwordx4 v5, s[16:19], s33 offen offset:1024 lds
    s_add_u32 s33, s33, 110592
    s_add_u32 m0, s34, 49152
    s_nop 0
    buffer_load_dwordx4 v4, s[12:15], s33 offen lds
    buffer_load_dwordx4 v5, s[12:15], s33 offen offset:1024 lds
    s_add_u32 m0, s34, 57344
    s_nop 0
    buffer_load_dwordx4 v4, s[16:19], s33 offen lds
    buffer_load_dwordx4 v5, s[16:19], s33 offen offset:1024 lds
    s_add_u32 s33, s33, 110592
    s_add_u32 m0, s34, 73728
    s_nop 0
    buffer_load_dwordx4 v4, s[12:15], s33 offen lds
    buffer_load_dwordx4 v5, s[12:15], s33 offen offset:1024 lds
    s_add_u32 m0, s34, 81920
    s_nop 0
    buffer_load_dwordx4 v4, s[16:19], s33 offen lds
    buffer_load_dwordx4 v5, s[16:19], s33 offen offset:1024 lds
    s_add_u32 s33, s33, 110592
    s_add_u32 m0, s34, 98304
    s_nop 0
    buffer_load_dwordx4 v4, s[12:15], s33 offen lds
    buffer_load_dwordx4 v5, s[12:15], s33 offen offset:1024 lds
    s_add_u32 m0, s34, 106496
    s_nop 0
    buffer_load_dwordx4 v4, s[16:19], s33 offen lds
    buffer_load_dwordx4 v5, s[16:19], s33 offen offset:1024 lds
    s_add_u32 s33, s33, 110592
PADB0:
    s_cbranch_execz PADB1
    s_nop 0
    s_cmp_lg_u32 s24, 1
    s_cbranch_scc1 F_L_NH
    s_mov_b64 exec, 0
    s_call_b64 s[84:85], PADB0
F_L_NH:
    s_barrier
    s_add_u32 m0, s34, 114688
    s_nop 0
    buffer_load_dwordx4 v2, s[8:11], s32 offen sc1 lds
    buffer_load_dwordx4 v3, s[8:11], s32 offen offset:1024 sc1 lds
    s_add_u32 s32, s32, 8192
    s_add_u32 m0, s34, 139264
    s_nop 0
    buffer_load_dwordx4 v2, s[8:11], s32 offen sc1 lds
    buffer_load_dwordx4 v3, s[8:11], s32 offen offset:1024 sc1 lds
    s_add_u32 s32, s32, 8192
    s_add_u32 m0, s34, 16384
    s_nop 0
    buffer_load_dwordx4 v2, s[8:11], s32 offen sc1 lds
    buffer_load_dwordx4 v3, s[8:11], s32 offen offset:1024 sc1 lds
    s_add_u32 s32, s32, 8192
    s_add_u32 m0, s34, 40960
    s_nop 0
    buffer_load_dwordx4 v2, s[8:11], s32 offen sc1 lds
    buffer_load_dwordx4 v3, s[8:11], s32 offen offset:1024 sc1 lds
    s_add_u32 s32, s32, 8192
    v_mov_b32 v8, 9472
    v_mov_b32 v7, 1
    s_waitcnt vmcnt(6) lgkmcnt(0)
    s_barrier
    s_add_u32 m0, s34, 65536
    s_nop 0
    buffer_load_dwordx4 v2, s[8:11], s32 offen sc1 lds
    buffer_load_dwordx4 v3, s[8:11], s32 offen offset:1024 sc1 lds
    s_add_u32 s32, s32, 8192
    s_add_u32 m0, s34, 90112
    s_nop 0
    buffer_load_dwordx4 v2, s[8:11], s32 offen sc1 lds
    buffer_load_dwordx4 v3, s[8:11], s32 offen offset:1024 sc1 lds
    s_add_u32 s32, s32, 8192
    s_waitcnt vmcnt(8) lgkmcnt(0)
    s_barrier
    s_add_u32 m0, s34, 114688
    s_nop 0
    buffer_load_dwordx4 v2, s[8:11], s32 offen sc1 lds
    buffer_load_dwordx4 v3, s[8:11], s32 offen offset:1024 sc1 lds
    s_add_u32 s32, s32, 8192
    s_add_u32 m0, s34, 122880
    s_nop 0
    buffer_load_dwordx4 v4, s[12:15], s33 offen lds
    buffer_load_dwordx4 v5, s[12:15], s33 offen offset:1024 lds
    s_add_u32 m0, s34, 131072
    s_nop 0
    buffer_load_dwordx4 v4, s[16:19], s33 offen lds
    buffer_load_dwordx4 v5, s[16:19], s33 offen offset:1024 lds
    s_add_u32 s33, s33, 110592
    s_waitcnt vmcnt(12) lgkmcnt(0)
    s_barrier
    s_add_u32 m0, s34, 139264
    s_nop 0
    buffer_load_dwordx4 v2, s[8:11], s32 offen sc1 lds
    buffer_load_dwordx4 v3, s[8:11], s32 offen offset:1024 sc1 lds
    s_add_u32 s32, s32, 8192
    s_add_u32 m0, s34, 147456
    s_nop 0
    buffer_load_dwordx4 v4, s[12:15], s33 offen lds
    buffer_load_dwordx4 v5, s[12:15], s33 offen offset:1024 lds
    s_add_u32 m0, s34, 155648
    s_nop 0
    buffer_load_dwordx4 v4, s[16:19], s33 offen lds
    buffer_load_dwordx4 v5, s[16:19], s33 offen offset:1024 lds
    s_add_u32 s33, s33, 110592
    s_waitcnt vmcnt(16) lgkmcnt(0)
    s_barrier
    s_add_u32 m0, s34, 16384
    s_nop 0
    buffer_load_dwordx4 v2, s[8:11], s32 offen sc1 lds
    buffer_load_dwordx4 v3, s[8:11], s32 offen offset:1024 sc1 lds
    s_add_u32 s32, s32, 8192
    s_add_u32 m0, s34, 24576
    s_nop 0
    buffer_load_dwordx4 v4, s[12:15], s33 offen lds
    buffer_load_dwordx4 v5, s[12:15], s33 offen offset:1024 lds
    s_add_u32 m0, s34, 32768
    s_nop 0
    buffer_load_dwordx4 v4, s[16:19], s33 offen lds
    buffer_load_dwordx4 v5, s[16:19], s33 offen offset:1024 lds
    s_add_u32 s33, s33, 110592
    s_waitcnt vmcnt(20) lgkmcnt(0)
    s_barrier
    s_add_u32 m0, s34, 40960
    s_nop 0
    buffer_load_dwordx4 v2, s[8:11], s32 offen sc1 lds
    buffer_load_dwordx4 v3, s[8:11], s32 offen offset:1024 sc1 lds
    s_add_u32 s32, s32, 8192
    s_add_u32 m0, s34, 49152
    s_nop 0
    buffer_load_dwordx4 v4, s[12:15], s33 offen lds
    buffer_load_dwordx4 v5, s[12:15], s33 offen offset:1024 lds
    s_add_u32 m0, s34, 57344
    s_nop 0
    buffer_load_dwordx4 v4, s[16:19], s33 offen lds
    buffer_load_dwordx4 v5, s[16:19], s33 offen offset:1024 lds
    s_add_u32 s33, s33, 110592
    s_waitcnt vmcnt(24) lgkmcnt(0)
    s_barrier
    s_add_u32 m0, s34, 65536
    s_nop 0
    buffer_load_dwordx4 v2, s[8:11], s32 offen sc1 lds
    buffer_load_dwordx4 v3, s[8:11], s32 offen offset:1024 sc1 lds
    s_add_u32 s32, s32, 8192
    s_add_u32 m0, s34, 73728
    s_nop 0
    buffer_load_dwordx4 v4, s[12:15], s33 offen lds
    buffer_load_dwordx4 v5, s[12:15], s33 offen offset:1024 lds
    s_add_u32 m0, s34, 81920
    s_nop 0
    buffer_load_dwordx4 v4, s[16:19], s33 offen lds
    buffer_load_dwordx4 v5, s[16:19], s33 offen offset:1024 lds
    s_add_u32 s33, s33, 110592
    buffer_load_dword v9, v8, s[36:39], 0 offen sc1
    s_waitcnt vmcnt(25) lgkmcnt(0)
    s_barrier
    s_add_u32 m0, s34, 90112
    s_nop 0
    buffer_load_dwordx4 v2, s[8:11], s32 offen sc1 lds
    buffer_load_dwordx4 v3, s[8:11], s32 offen offset:1024 sc1 lds
    s_add_u32 s32, s32, 8192
    s_add_u32 m0, s34, 98304
    s_nop 0
    buffer_load_dwordx4 v4, s[12:15], s33 offen lds
    buffer_load_dwordx4 v5, s[12:15], s33 offen offset:1024 lds
    s_add_u32 m0, s34, 106496
    s_nop 0
    buffer_load_dwordx4 v4, s[16:19], s33 offen lds
    buffer_load_dwordx4 v5, s[16:19], s33 offen offset:1024 lds
    s_add_u32 s33, s33, 110592
    s_waitcnt vmcnt(25) lgkmcnt(0)
    s_barrier
    s_add_u32 m0, s34, 114688
    s_nop 0
    buffer_load_dwordx4 v2, s[8:11], s32 offen sc1 lds
    buffer_load_dwordx4 v3, s[8:11], s32 offen offset:1024 sc1 lds
    s_add_u32 s32, s32, 8192
    s_add_u32 m0, s34, 122880
    s_nop 0
    buffer_load_dwordx4 v4, s[12:15], s33 offen lds
    buffer_load_dwordx4 v5, s[12:15], s33 offen offset:1024 lds
    s_add_u32 m0, s34, 131072
    s_nop 0
    buffer_load_dwordx4 v4, s[16:19], s33 offen lds
    buffer_load_dwordx4 v5, s[16:19], s33 offen offset:1024 lds
    s_add_u32 s33, s33, 110592
    s_waitcnt vmcnt(25) lgkmcnt(0)
    s_barrier
    s_add_u32 m0, s34, 139264
    s_nop 0
    buffer_load_dwordx4 v2, s[8:11], s32 offen sc1 lds
    buffer_load_dwordx4 v3, s[8:11], s32 offen offset:1024 sc1 lds
    s_add_u32 s32, s32, 8192
    s_add_u32 m0, s34, 147456
    s_nop 0
    buffer_load_dwordx4 v4, s[12:15], s33 offen lds
    buffer_load_dwordx4 v5, s[12:15], s33 offen offset:1024 lds
    s_add_u32 m0, s34, 155648
    s_nop 0
    buffer_load_dwordx4 v4, s[16:19], s33 offen lds
    buffer_load_dwordx4 v5, s[16:19], s33 offen offset:1024 lds
    s_add_u32 s33, s33, 110592
    s_waitcnt vmcnt(18)
    s_mov_b32 s48, 0
F_L_PW:
    v_cmp_gt_u32 vcc, v7, v9
    s_add_u32 s48, s48, 1
    s_cbranch_vccz F_L_PW_OK
    s_sleep 4
    buffer_load_dword v9, v8, s[36:39], 0 offen sc1
    s_cmp_lt_u32 s48, 262144
    s_waitcnt vmcnt(0)
    s_cbranch_scc1 F_L_PW
F_L_PW_OK:
    v_lshrrev_b32 v10, 5, v1
    v_mul_u32_u24 v10, 6656, v10
    v_add_u32 v10, v10, v6
    s_lshl_b32 s26, s23, 8
    s_add_u32 s26, s26, 32768
    s_mov_b32 m0, 12288
    s_nop 0
    buffer_load_dwordx4 v10, s[40:43], s26 offen sc1 lds
    s_lshl_b32 s26, s22, 8
    s_add_u32 s26, s26, 9728
    v_mov_b32 v8, s26
    v_mov_b32 v7, 2
    s_waitcnt vmcnt(26) lgkmcnt(0)
    s_barrier
    s_add_u32 m0, s34, 16384
    s_nop 0
    buffer_load_dwordx4 v2, s[8:11], s32 offen sc1 lds
    buffer_load_dwordx4 v3, s[8:11], s32 offen offset:1024 sc1 lds
    s_add_u32 s32, s32, 8192
    s_add_u32 m0, s34, 24576
    s_nop 0
    buffer_load_dwordx4 v4, s[12:15], s33 offen lds
    buffer_load_dwordx4 v5, s[12:15], s33 offen offset:1024 lds
    s_add_u32 m0, s34, 32768
    s_nop 0
    buffer_load_dwordx4 v4, s[16:19], s33 offen lds
    buffer_load_dwordx4 v5, s[16:19], s33 offen offset:1024 lds
    s_add_u32 s33, s33, 110592
    buffer_load_dword v9, v8, s[36:39], 0 offen sc1
    s_waitcnt vmcnt(27) lgkmcnt(0)
    s_barrier
    s_add_u32 m0, s34, 40960
    s_nop 0
    buffer_load_dwordx4 v2, s[8:11], s32 offen sc1 lds
    buffer_load_dwordx4 v3, s[8:11], s32 offen offset:1024 sc1 lds
    s_add_u32 s32, s32, 8192
    s_add_u32 m0, s34, 49152
    s_nop 0
    buffer_load_dwordx4 v4, s[12:15], s33 offen lds
    buffer_load_dwordx4 v5, s[12:15], s33 offen offset:1024 lds
    s_add_u32 m0, s34, 57344
    s_nop 0
    buffer_load_dwordx4 v4, s[16:19], s33 offen lds
    buffer_load_dwordx4 v5, s[16:19], s33 offen offset:1024 lds
    s_add_u32 s33, s33, 110592
    s_waitcnt vmcnt(26) lgkmcnt(0)
    s_barrier
    s_add_u32 m0, s34, 65536
    s_nop 0
    buffer_load_dwordx4 v2, s[8:11], s32 offen sc1 lds
    buffer_load_dwordx4 v3, s[8:11], s32 offen offset:1024 sc1 lds
    s_add_u32 s32, s32, 8192
    s_add_u32 m0, s34, 73728
    s_nop 0
    buffer_load_dwordx4 v4, s[12:15], s33 offen lds
    buffer_load_dwordx4 v5, s[12:15], s33 offen offset:1024 lds
    s_add_u32 m0, s34, 81920
    s_nop 0
    buffer_load_dwordx4 v4, s[16:19], s33 offen lds
    buffer_load_dwordx4 v5, s[16:19], s33 offen offset:1024 lds
    s_add_u32 s33, s33, 110592
    s_waitcnt vmcnt(26) lgkmcnt(0)
    s_barrier
    s_add_u32 m0, s34, 90112
    s_nop 0
    buffer_load_dwordx4 v2, s[8:11], s32 offen sc1 lds
    buffer_load_dwordx4 v3, s[8:11], s32 offen offset:1024 sc1 lds
    s_add_u32 s32, s32, 8192
    s_add_u32 m0, s34, 98304
    s_nop 0
    buffer_load_dwordx4 v4, s[12:15], s33 offen lds
    buffer_load_dwordx4 v5, s[12:15], s33 offen offset:1024 lds
    s_add_u32 m0, s34, 106496
    s_nop 0
    buffer_load_dwordx4 v4, s[16:19], s33 offen lds
    buffer_load_dwordx4 v5, s[16:19], s33 offen offset:1024 lds
    s_add_u32 s33, s33, 110592
    s_waitcnt vmcnt(18)
    s_mov_b32 s48, 0
F_L_PM:
    v_cmp_gt_u32 vcc, v7, v9
    s_add_u32 s48, s48, 1
    s_cbranch_vccz F_L_PM_OK
    s_sleep 4
    buffer_load_dword v9, v8, s[36:39], 0 offen sc1
    s_cmp_lt_u32 s48, 262144
    s_waitcnt vmcnt(0)
    s_cbranch_scc1 F_L_PM
F_L_PM_OK:
    s_lshl_b32 s26, s22, 9
    s_add_u32 s26, s26, 16384
    s_mov_b32 m0, 13312
    s_nop 0
    buffer_load_dwordx4 v6, s[40:43], s26 offen sc1 lds
    s_waitcnt vmcnt(27) lgkmcnt(0)
    s_barrier
    s_add_u32 m0, s34, 114688
    s_nop 0
    buffer_load_dwordx4 v2, s[8:11], s32 offen sc1 lds
    buffer_load_dwordx4 v3, s[8:11], s32 offen offset:1024 sc1 lds
    s_add_u32 s32, s32, 8192
    s_add_u32 m0, s34, 122880
    s_nop 0
    buffer_load_dwordx4 v4, s[12:15], s33 offen lds
    buffer_load_dwordx4 v5, s[12:15], s33 offen offset:1024 lds
    s_add_u32 m0, s34, 131072
    s_nop 0
    buffer_load_dwordx4 v4, s[16:19], s33 offen lds
    buffer_load_dwordx4 v5, s[16:19], s33 offen offset:1024 lds
    s_add_u32 s33, s33, 110592
    s_waitcnt vmcnt(26) lgkmcnt(0)
    s_barrier
    s_add_u32 m0, s34, 139264
    s_nop 0
    buffer_load_dwordx4 v2, s[8:11], s32 offen sc1 lds
    buffer_load_dwordx4 v3, s[8:11], s32 offen offset:1024 sc1 lds
    s_add_u32 s32, s32, 8192
    s_add_u32 m0, s34, 147456
    s_nop 0
    buffer_load_dwordx4 v4, s[12:15], s33 offen lds
    buffer_load_dwordx4 v5, s[12:15], s33 offen offset:1024 lds
    s_add_u32 m0, s34, 155648
    s_nop 0
    buffer_load_dwordx4 v4, s[16:19], s33 offen lds
    buffer_load_dwordx4 v5, s[16:19], s33 offen offset:1024 lds
    s_add_u32 s33, s33, 110592
    s_waitcnt vmcnt(25) lgkmcnt(0)
    s_waitcnt vmcnt(12)
    s_barrier
    s_waitcnt vmcnt(0) lgkmcnt(0)
    s_barrier
    buffer_load_dwordx4 v[64:67], v6, s[52:55], s50 offen offset:0 sc1
    buffer_load_dwordx4 v[68:71], v6, s[52:55], s50 offen offset:1024 sc1
    buffer_load_dwordx4 v[72:75], v6, s[52:55], s50 offen offset:2048 sc1
    s_add_u32 s50, s50, 40960
    buffer_load_dwordx4 v[76:79], v6, s[52:55], s50 offen offset:0 sc1
    buffer_load_dwordx4 v[80:83], v6, s[52:55], s50 offen offset:1024 sc1
    buffer_load_dwordx4 v[84:87], v6, s[52:55], s50 offen offset:2048 sc1
    s_add_u32 s50, s50, 40960
    buffer_load_dwordx4 v[88:91], v6, s[52:55], s50 offen offset:0 sc1
    buffer_load_dwordx4 v[92:95], v6, s[52:55], s50 offen offset:1024 sc1
    buffer_load_dwordx4 v[96:99], v6, s[52:55], s50 offen offset:2048 sc1
    s_add_u32 s50, s50, 40960
    buffer_load_dwordx4 v[100:103], v6, s[52:55], s50 offen offset:0 sc1
    buffer_load_dwordx4 v[104:107], v6, s[52:55], s50 offen offset:1024 sc1
    buffer_load_dwordx4 v[108:111], v6, s[52:55], s50 offen offset:2048 sc1
    s_add_u32 s50, s50, 40960
    buffer_load_dwordx4 v[112:115], v6, s[52:55], s50 offen offset:0 sc1
    buffer_load_dwordx4 v[116:119], v6, s[52:55], s50 offen offset:1024 sc1
    buffer_load_dwordx4 v[120:123], v6, s[52:55], s50 offen offset:2048 sc1
    s_add_u32 s50, s50, 40960
    buffer_load_dwordx4 v[124:127], v6, s[52:55], s50 offen offset:0 sc1
    buffer_load_dwordx4 v[128:131], v6, s[52:55], s50 offen offset:1024 sc1
    buffer_load_dwordx4 v[132:135], v6, s[52:55], s50 offen offset:2048 sc1
    s_add_u32 s50, s50, 40960
    buffer_load_dwordx4 v[136:139], v6, s[52:55], s50 offen offset:0 sc1
    buffer_load_dwordx4 v[140:143], v6, s[52:55], s50 offen offset:1024 sc1
    buffer_load_dwordx4 v[144:147], v6, s[52:55], s50 offen offset:2048 sc1
    s_sub_u32 s50, s50, 240640
    buffer_load_dwordx4 v[148:151], v6, s[52:55], s50 offen offset:0 sc1
    buffer_load_dwordx4 v[152:155], v6, s[52:55], s50 offen offset:1024 sc1
    buffer_load_dwordx4 v[156:159], v6, s[52:55], s50 offen offset:2048 sc1
    s_add_u32 s50, s50, 40960
    buffer_load_dwordx4 v[160:163], v6, s[52:55], s50 offen offset:0 sc1
    buffer_load_dwordx4 v[164:167], v6, s[52:55], s50 offen offset:1024 sc1
    buffer_load_dwordx4 v[168:171], v6, s[52:55], s50 offen offset:2048 sc1
    s_add_u32 s50, s50, 40960
    buffer_load_dwordx4 v[172:175], v6, s[52:55], s50 offen offset:0 sc1
    buffer_load_dwordx4 v[176:179], v6, s[52:55], s50 offen offset:1024 sc1
    buffer_load_dwordx4 v[180:183], v6, s[52:55], s50 offen offset:2048 sc1
    s_add_u32 s50, s50, 40960
    buffer_load_dwordx4 v[184:187], v6, s[52:55], s50 offen offset:0 sc1
    buffer_load_dwordx4 v[188:191], v6, s[52:55], s50 offen offset:1024 sc1
    buffer_load_dwordx4 v[192:195], v6, s[52:55], s50 offen offset:2048 sc1
    s_add_u32 s50, s50, 40960
    buffer_load_dwordx4 v[196:199], v6, s[52:55], s50 offen offset:0 sc1
    buffer_load_dwordx4 v[200:203], v6, s[52:55], s50 offen offset:1024 sc1
    buffer_load_dwordx4 v[204:207], v6, s[52:55], s50 offen offset:2048 sc1
    s_add_u32 s50, s50, 40960
    s_add_u32 s56, s4, 12582912
    s_addc_u32 s57, s5, 0
    s_and_b32 s57, s57, 0xffff
    s_mov_b32 s58, 2621440
    s_mov_b32 s59, 0x20000
    s_lshr_b32 s26, s44, 1
    s_mul_i32 s26, s26, 163840
    s_mul_i32 s27, s45, 20480
    s_add_u32 s26, s26, s27
    s_and_b32 s27, s44, 1
    s_lshl_b32 s27, s27, 7
    s_add_u32 s26, s26, s27
    s_mul_i32 s27, s25, 6144
    s_add_u32 s26, s26, s27
    v_lshrrev_b32 v10, 3, v1
    v_lshlrev_b32 v10, 8, v10
    v_and_b32 v11, 7, v1
    v_lshl_add_u32 v10, v11, 4, v10
    s_mul_i32 s46, s25, 3072
    s_add_u32 s46, s46, 0
    s_add_u32 m0, s46, 0
    s_nop 0
    buffer_load_dwordx4 v10, s[56:59], s26 offen sc1 lds
    s_add_u32 s26, s26, 2048
    s_add_u32 m0, s46, 1024
    s_nop 0
    buffer_load_dwordx4 v10, s[56:59], s26 offen sc1 lds
    s_add_u32 s26, s26, 2048
    s_add_u32 m0, s46, 2048
    s_nop 0
    buffer_load_dwordx4 v10, s[56:59], s26 offen sc1 lds
    s_add_u32 s26, s26, 2048
    s_lshl_b32 s47, s22, 8
    s_branch F_L_ARR
F_L_STAT:
    s_cmp_lg_u32 s24, 1
    s_cbranch_scc1 F_L_NH2
    s_mov_b64 exec, 0
    s_call_b64 s[84:85], PADB0
F_L_NH2:
    s_barrier
    v_mov_b32 v8, 9472
    v_mov_b32 v7, 1
    buffer_load_dword v9, v8, s[36:39], 0 offen sc1
    s_waitcnt vmcnt(0)
    s_mov_b32 s48, 0
F_L_PW2:
    v_cmp_gt_u32 vcc, v7, v9
    s_add_u32 s48, s48, 1
    s_cbranch_vccz F_L_PW2_OK
    s_sleep 4
    buffer_load_dword v9, v8, s[36:39], 0 offen sc1
    s_cmp_lt_u32 s48, 262144
    s_waitcnt vmcnt(0)
    s_cbranch_scc1 F_L_PW2
F_L_PW2_OK:
    s_barrier
    s_barrier
    s_lshr_b32 s26, s20, 2
    s_mul_i32 s26, s26, 1105920
    s_add_u32 s26, s26, 20971520
    s_add_u32 s8, s4, s26
    s_addc_u32 s9, s5, 0
    s_and_b32 s9, s9, 0xffff
    s_mov_b32 s10, 829440
    s_mov_b32 s11, 0x20000
    s_and_b32 s26, s21, 3
    s_lshl_b32 s26, s26, 2
    s_add_u32 s26, s26, s25
    s_lshl_b32 s26, s26, 13
    v_lshlrev_b32 v10, 7, v1
    s_mov_b32 s27, 0
F_L_WARM:
    buffer_load_dword v11, v10, s[8:11], s26 offen sc1
    s_add_u32 s26, s26, 0x20000
    s_add_u32 s27, s27, 1
    s_cmp_lt_u32 s27, 7
    s_cbranch_scc1 F_L_WARM
    s_waitcnt vmcnt(0)
    s_add_u32 s56, s4, 12582912
    s_addc_u32 s57, s5, 0
    s_and_b32 s57, s57, 0xffff
    s_mov_b32 s58, 2621440
    s_mov_b32 s59, 0x20000
    s_lshr_b32 s26, s44, 1
    s_mul_i32 s26, s26, 163840
    s_mul_i32 s27, s45, 20480
    s_add_u32 s26, s26, s27
    s_and_b32 s27, s44, 1
    s_lshl_b32 s27, s27, 7
    s_add_u32 s26, s26, s27
    s_mul_i32 s27, s25, 6144
    s_add_u32 s26, s26, s27
    v_lshrrev_b32 v10, 3, v1
    v_lshlrev_b32 v10, 8, v10
    v_and_b32 v11, 7, v1
    v_lshl_add_u32 v10, v11, 4, v10
    s_mul_i32 s46, s25, 3072
    s_add_u32 s46, s46, 0
    s_add_u32 m0, s46, 0
    s_nop 0
    buffer_load_dwordx4 v10, s[56:59], s26 offen sc1 lds
    s_add_u32 s26, s26, 2048
    s_add_u32 m0, s46, 1024
    s_nop 0
    buffer_load_dwordx4 v10, s[56:59], s26 offen sc1 lds
    s_add_u32 s26, s26, 2048
    s_add_u32 m0, s46, 2048
    s_nop 0
    buffer_load_dwordx4 v10, s[56:59], s26 offen sc1 lds
    s_add_u32 s26, s26, 2048
    buffer_load_dwordx4 v[64:67], v6, s[52:55], s50 offen offset:0 sc1
    buffer_load_dwordx4 v[68:71], v6, s[52:55], s50 offen offset:1024 sc1
    buffer_load_dwordx4 v[72:75], v6, s[52:55], s50 offen offset:2048 sc1
    s_add_u32 s50, s50, 40960
    buffer_load_dwordx4 v[76:79], v6, s[52:55], s50 offen offset:0 sc1
    buffer_load_dwordx4 v[80:83], v6, s[52:55], s50 offen offset:1024 sc1
    buffer_load_dwordx4 v[84:87], v6, s[52:55], s50 offen offset:2048 sc1
    s_add_u32 s50, s50, 40960
    buffer_load_dwordx4 v[88:91], v6, s[52:55], s50 offen offset:0 sc1
    buffer_load_dwordx4 v[92:95], v6, s[52:55], s50 offen offset:1024 sc1
    buffer_load_dwordx4 v[96:99], v6, s[52:55], s50 offen offset:2048 sc1
    s_add_u32 s50, s50, 40960
    buffer_load_dwordx4 v[100:103], v6, s[52:55], s50 offen offset:0 sc1
    buffer_load_dwordx4 v[104:107], v6, s[52:55], s50 offen offset:1024 sc1
    buffer_load_dwordx4 v[108:111], v6, s[52:55], s50 offen offset:2048 sc1
    s_add_u32 s50, s50, 40960
    buffer_load_dwordx4 v[112:115], v6, s[52:55], s50 offen offset:0 sc1
    buffer_load_dwordx4 v[116:119], v6, s[52:55], s50 offen offset:1024 sc1
    buffer_load_dwordx4 v[120:123], v6, s[52:55], s50 offen offset:2048 sc1
    s_add_u32 s50, s50, 40960
    buffer_load_dwordx4 v[124:127], v6, s[52:55], s50 offen offset:0 sc1
    buffer_load_dwordx4 v[128:131], v6, s[52:55], s50 offen offset:1024 sc1
    buffer_load_dwordx4 v[132:135], v6, s[52:55], s50 offen offset:2048 sc1
    s_add_u32 s50, s50, 40960
    buffer_load_dwordx4 v[136:139], v6, s[52:55], s50 offen offset:0 sc1
    buffer_load_dwordx4 v[140:143], v6, s[52:55], s50 offen offset:1024 sc1
    buffer_load_dwordx4 v[144:147], v6, s[52:55], s50 offen offset:2048 sc1
    s_sub_u32 s50, s50, 240640
    buffer_load_dwordx4 v[148:151], v6, s[52:55], s50 offen offset:0 sc1
    buffer_load_dwordx4 v[152:155], v6, s[52:55], s50 offen offset:1024 sc1
    buffer_load_dwordx4 v[156:159], v6, s[52:55], s50 offen offset:2048 sc1
    s_add_u32 s50, s50, 40960
    buffer_load_dwordx4 v[160:163], v6, s[52:55], s50 offen offset:0 sc1
    buffer_load_dwordx4 v[164:167], v6, s[52:55], s50 offen offset:1024 sc1
    buffer_load_dwordx4 v[168:171], v6, s[52:55], s50 offen offset:2048 sc1
    s_add_u32 s50, s50, 40960
    buffer_load_dwordx4 v[172:175], v6, s[52:55], s50 offen offset:0 sc1
    buffer_load_dwordx4 v[176:179], v6, s[52:55], s50 offen offset:1024 sc1
    buffer_load_dwordx4 v[180:183], v6, s[52:55], s50 offen offset:2048 sc1
    s_add_u32 s50, s50, 40960
    buffer_load_dwordx4 v[184:187], v6, s[52:55], s50 offen offset:0 sc1
    buffer_load_dwordx4 v[188:191], v6, s[52:55], s50 offen offset:1024 sc1
    buffer_load_dwordx4 v[192:195], v6, s[52:55], s50 offen offset:2048 sc1
    s_add_u32 s50, s50, 40960
    buffer_load_dwordx4 v[196:199], v6, s[52:55], s50 offen offset:0 sc1
    buffer_load_dwordx4 v[200:203], v6, s[52:55], s50 offen offset:1024 sc1
    buffer_load_dwordx4 v[204:207], v6, s[52:55], s50 offen offset:2048 sc1
    s_add_u32 s50, s50, 40960
    s_sub_u32 s47, s2, 224
    s_lshr_b32 s47, s47, 1
    s_lshl_b32 s47, s47, 8
F_L_ARR:
PADB1:
    s_cbranch_execz PADB2
    s_nop 0
    s_lshl_b32 s29, s44, 8
    s_lshl_b32 s30, s25, 6
    s_add_u32 s29, s29, s30
    v_and_b32 v11, 15, v1
    v_lshlrev_b32 v12, 2, v11
    s_lshl_b32 s28, s25, 12
    s_add_u32 s28, s28, 16384
    v_add_u32 v2, s28, v6
    v_add_u32 v3, 0x10000, v2
    v_add_u32 v4, 0x20000, v2
    s_add_u32 s28, s25, 1
    s_and_b32 s28, s28, 3
    s_mul_i32 s28, s28, 15360
    s_add_u32 s28, s28, 98304
    v_add_u32 v7, s28, v6
    s_add_u32 s28, s25, 2
    s_and_b32 s28, s28, 3
    s_mul_i32 s28, s28, 15360
    s_add_u32 s28, s28, 103424
    v_add_u32 v8, s28, v6
    s_add_u32 s28, s25, 3
    s_and_b32 s28, s28, 3
    s_mul_i32 s28, s28, 15360
    s_add_u32 s28, s28, 108544
    v_add_u32 v9, s28, v6
    s_mul_i32 s28, s25, 15360
    s_add_u32 s28, s28, 98304
    v_add_u32 v14, s28, v6
    v_lshrrev_b32 v5, 4, v1
    v_mul_u32_u24 v5, 20, v5
    v_lshrrev_b32 v10, 2, v1
    v_and_b32 v10, 3, v10
    v_add_u32 v5, v5, v10
    v_lshlrev_b32 v5, 7, v5
    v_and_b32 v10, 3, v1
    v_lshl_add_u32 v5, v10, 3, v5
    s_lshl_b32 s28, s25, 5
    s_add_u32 s28, s28, 0
    v_add_u32 v5, s28, v5
    s_lshl_b32 s28, s44, 6
    s_lshl_b32 s30, s25, 4
    s_add_u32 s28, s28, s30
    s_mul_i32 s28, s28, 1280
    s_mul_i32 s30, s45, 160
    s_add_u32 s28, s28, s30
    v_mul_u32_u24 v11, 1280, v11
    v_lshrrev_b32 v10, 4, v1
    v_mul_u32_u24 v10, 40, v10
    v_add_u32 v11, v11, v10
    s_mov_b32 s16, s78
    s_and_b32 s17, s79, 0xffff
    s_mov_b32 s18, 2621440
    s_mov_b32 s19, 0x20000
    s_add_u32 s61, s47, 128
    s_add_u32 s47, s47, 15335424
    s_lshr_b32 s46, s44, 1
    s_lshl_b32 s46, s46, 8
    s_cmp_lt_u32 s21, 28
    s_cselect_b32 s49, 1, 0
    v_mov_b32 v15, 128
    v_mov_b32 v10, s49
    s_barrier
    s_cmp_lg_u32 s24, 0
    s_cbranch_scc1 F_L_NS
    s_atomic_add s49, s[4:5], s47
F_L_NS:
    s_cmp_lg_u32 s24, 0
    s_cbranch_scc1 F_L_GO
    s_add_u32 s60, s46, 15335424
    s_mov_b32 s48, 0
F_L_P3:
    s_mov_b32 s51, 0
    s_atomic_add s51, s[4:5], s60 glc
    s_waitcnt lgkmcnt(0)
    s_add_u32 s48, s48, 1
    s_cmp_ge_u32 s51, 16
    s_cbranch_scc1 F_L_GO1
    s_sleep 1
    s_cmp_lt_u32 s48, 262144
    s_cbranch_scc1 F_L_P3
F_L_GO1:
    s_waitcnt vmcnt(0)
    s_barrier
    s_mov_b64 exec, 1
    buffer_atomic_add v10, off, s[36:39], s61 sc1
    s_mov_b64 exec, -1
    s_branch F_L_G2
F_L_GO:
    s_waitcnt vmcnt(0)
    s_barrier
F_L_G2:
    buffer_load_dword v13, v12, s[40:43], s29 offen sc1
    s_barrier
    ds_read_b128 v[232:235], v2 offset:0
    ds_read_b128 v[236:239], v2 offset:1024
    ds_read_b128 v[240:243], v2 offset:2048
    ds_read_b128 v[244:247], v2 offset:3072
    s_waitcnt lgkmcnt(0)
    s_barrier
    v_mfma_f32_16x16x32_bf16 v[16:19], v[64:67], v[232:235], 0
    buffer_load_dwordx4 v[208:211], v6, s[52:55], s50 offen offset:0 sc1
    v_mfma_f32_16x16x32_bf16 v[20:23], v[68:71], v[232:235], 0
    buffer_load_dwordx4 v[212:215], v6, s[52:55], s50 offen offset:1024 sc1
    v_mfma_f32_16x16x32_bf16 v[24:27], v[72:75], v[232:235], 0
    v_mfma_f32_16x16x32_bf16 v[28:31], v[64:67], v[236:239], 0
    v_mfma_f32_16x16x32_bf16 v[32:35], v[68:71], v[236:239], 0
    v_mfma_f32_16x16x32_bf16 v[36:39], v[72:75], v[236:239], 0
    v_mfma_f32_16x16x32_bf16 v[40:43], v[64:67], v[240:243], 0
    v_mfma_f32_16x16x32_bf16 v[44:47], v[68:71], v[240:243], 0
    v_mfma_f32_16x16x32_bf16 v[48:51], v[72:75], v[240:243], 0
    v_mfma_f32_16x16x32_bf16 v[52:55], v[64:67], v[244:247], 0
    v_mfma_f32_16x16x32_bf16 v[56:59], v[68:71], v[244:247], 0
    v_mfma_f32_16x16x32_bf16 v[60:63], v[72:75], v[244:247], 0
    ds_read_b128 v[232:235], v2 offset:16384
    ds_read_b128 v[236:239], v2 offset:17408
    ds_read_b128 v[240:243], v2 offset:18432
    ds_read_b128 v[244:247], v2 offset:19456
    s_waitcnt lgkmcnt(0)
    s_barrier
    v_mfma_f32_16x16x32_bf16 v[16:19], v[76:79], v[232:235], v[16:19]
    buffer_load_dwordx4 v[216:219], v6, s[52:55], s50 offen offset:2048 sc1
    s_add_u32 s50, s50, 40960
    v_mfma_f32_16x16x32_bf16 v[20:23], v[80:83], v[232:235], v[20:23]
    buffer_load_dwordx4 v[220:223], v6, s[52:55], s50 offen offset:0 sc1
PADB2:
    s_cbranch_execz PADB3
    s_nop 0
    v_mfma_f32_16x16x32_bf16 v[24:27], v[84:87], v[232:235], v[24:27]
    v_mfma_f32_16x16x32_bf16 v[28:31], v[76:79], v[236:239], v[28:31]
    v_mfma_f32_16x16x32_bf16 v[32:35], v[80:83], v[236:239], v[32:35]
    v_mfma_f32_16x16x32_bf16 v[36:39], v[84:87], v[236:239], v[36:39]
    v_mfma_f32_16x16x32_bf16 v[40:43], v[76:79], v[240:243], v[40:43]
    v_mfma_f32_16x16x32_bf16 v[44:47], v[80:83], v[240:243], v[44:47]
    v_mfma_f32_16x16x32_bf16 v[48:51], v[84:87], v[240:243], v[48:51]
    v_mfma_f32_16x16x32_bf16 v[52:55], v[76:79], v[244:247], v[52:55]
    v_mfma_f32_16x16x32_bf16 v[56:59], v[80:83], v[244:247], v[56:59]
    v_mfma_f32_16x16x32_bf16 v[60:63], v[84:87], v[244:247], v[60:63]
    ds_read_b128 v[232:235], v2 offset:32768
    ds_read_b128 v[236:239], v2 offset:33792
    ds_read_b128 v[240:243], v2 offset:34816
    ds_read_b128 v[244:247], v2 offset:35840
    buffer_load_dword v10, v15, s[36:39], s46 offen sc1
    s_waitcnt lgkmcnt(0)
    s_barrier
    v_mfma_f32_16x16x32_bf16 v[16:19], v[88:91], v[232:235], v[16:19]
    ds_read_b128 v[64:67], v2 offset:49152
    v_mfma_f32_16x16x32_bf16 v[20:23], v[92:95], v[232:235], v[20:23]
    ds_read_b128 v[68:71], v2 offset:50176
    v_mfma_f32_16x16x32_bf16 v[24:27], v[96:99], v[232:235], v[24:27]
    ds_read_b128 v[72:75], v2 offset:51200
    v_mfma_f32_16x16x32_bf16 v[28:31], v[88:91], v[236:239], v[28:31]
    ds_read_b128 v[76:79], v2 offset:52224
    v_mfma_f32_16x16x32_bf16 v[32:35], v[92:95], v[236:239], v[32:35]
    v_mfma_f32_16x16x32_bf16 v[36:39], v[96:99], v[236:239], v[36:39]
    v_mfma_f32_16x16x32_bf16 v[40:43], v[88:91], v[240:243], v[40:43]
    v_mfma_f32_16x16x32_bf16 v[44:47], v[92:95], v[240:243], v[44:47]
    v_mfma_f32_16x16x32_bf16 v[48:51], v[96:99], v[240:243], v[48:51]
    v_mfma_f32_16x16x32_bf16 v[52:55], v[88:91], v[244:247], v[52:55]
    v_mfma_f32_16x16x32_bf16 v[56:59], v[92:95], v[244:247], v[56:59]
    v_mfma_f32_16x16x32_bf16 v[60:63], v[96:99], v[244:247], v[60:63]
    s_waitcnt vmcnt(0)
    s_mov_b32 s48, 0
F_L_PB:
    v_cmp_gt_u32 vcc, 16, v10
    s_add_u32 s48, s48, 1
    s_cbranch_vccz F_L_PBK
    buffer_load_dword v10, v15, s[36:39], s46 offen sc1
    s_cmp_lt_u32 s48, 262144
    s_waitcnt vmcnt(0)
    s_cbranch_scc1 F_L_PB
F_L_PBK:
    s_waitcnt lgkmcnt(0)
    s_barrier
    v_mfma_f32_16x16x32_bf16 v[16:19], v[100:103], v[64:67], v[16:19]
    ds_read_b128 v[232:235], v3 offset:0
    v_mfma_f32_16x16x32_bf16 v[20:23], v[104:107], v[64:67], v[20:23]
    ds_read_b128 v[236:239], v3 offset:1024
    v_mfma_f32_16x16x32_bf16 v[24:27], v[108:111], v[64:67], v[24:27]
    ds_read_b128 v[240:243], v3 offset:2048
    v_mfma_f32_16x16x32_bf16 v[28:31], v[100:103], v[68:71], v[28:31]
    ds_read_b128 v[244:247], v3 offset:3072
    v_mfma_f32_16x16x32_bf16 v[32:35], v[104:107], v[68:71], v[32:35]
    buffer_load_dwordx4 v[224:227], v6, s[52:55], s50 offen offset:1024 sc1
    v_mfma_f32_16x16x32_bf16 v[36:39], v[108:111], v[68:71], v[36:39]
    buffer_load_dwordx4 v[228:231], v6, s[52:55], s50 offen offset:2048 sc1
    s_add_u32 s50, s50, 40960
    v_mfma_f32_16x16x32_bf16 v[40:43], v[100:103], v[72:75], v[40:43]
    v_mfma_f32_16x16x32_bf16 v[44:47], v[104:107], v[72:75], v[44:47]
    v_mfma_f32_16x16x32_bf16 v[48:51], v[108:111], v[72:75], v[48:51]
    v_mfma_f32_16x16x32_bf16 v[52:55], v[100:103], v[76:79], v[52:55]
    v_mfma_f32_16x16x32_bf16 v[56:59], v[104:107], v[76:79], v[56:59]
    v_mfma_f32_16x16x32_bf16 v[60:63], v[108:111], v[76:79], v[60:63]
    s_waitcnt lgkmcnt(0)
    s_barrier
    v_mfma_f32_16x16x32_bf16 v[16:19], v[112:115], v[232:235], v[16:19]
    ds_read_b128 v[64:67], v3 offset:16384
    v_mfma_f32_16x16x32_bf16 v[20:23], v[116:119], v[232:235], v[20:23]
    ds_read_b128 v[68:71], v3 offset:17408
    v_mfma_f32_16x16x32_bf16 v[24:27], v[120:123], v[232:235], v[24:27]
    ds_read_b128 v[72:75], v3 offset:18432
    v_mfma_f32_16x16x32_bf16 v[28:31], v[112:115], v[236:239], v[28:31]
    ds_read_b128 v[76:79], v3 offset:19456
    v_mfma_f32_16x16x32_bf16 v[32:35], v[116:119], v[236:239], v[32:35]
    v_mfma_f32_16x16x32_bf16 v[36:39], v[120:123], v[236:239], v[36:39]
    v_mfma_f32_16x16x32_bf16 v[40:43], v[112:115], v[240:243], v[40:43]
    v_mfma_f32_16x16x32_bf16 v[44:47], v[116:119], v[240:243], v[44:47]
    v_mfma_f32_16x16x32_bf16 v[48:51], v[120:123], v[240:243], v[48:51]
    v_mfma_f32_16x16x32_bf16 v[52:55], v[112:115], v[244:247], v[52:55]
    v_mfma_f32_16x16x32_bf16 v[56:59], v[116:119], v[244:247], v[56:59]
    v_mfma_f32_16x16x32_bf16 v[60:63], v[120:123], v[244:247], v[60:63]
    s_waitcnt lgkmcnt(0)
    s_barrier
    v_mfma_f32_16x16x32_bf16 v[16:19], v[124:127], v[64:67], v[16:19]
    ds_read_b128 v[232:235], v3 offset:32768
    v_mfma_f32_16x16x32_bf16 v[20:23], v[128:131], v[64:67], v[20:23]
    ds_read_b128 v[236:239], v3 offset:33792
    v_mfma_f32_16x16x32_bf16 v[24:27], v[132:135], v[64:67], v[24:27]
    ds_read_b128 v[240:243], v3 offset:34816
    v_mfma_f32_16x16x32_bf16 v[28:31], v[124:127], v[68:71], v[28:31]
    ds_read_b128 v[244:247], v3 offset:35840
    v_mfma_f32_16x16x32_bf16 v[32:35], v[128:131], v[68:71], v[32:35]
    v_mfma_f32_16x16x32_bf16 v[36:39], v[132:135], v[68:71], v[36:39]
    v_mfma_f32_16x16x32_bf16 v[40:43], v[124:127], v[72:75], v[40:43]
    v_mfma_f32_16x16x32_bf16 v[44:47], v[128:131], v[72:75], v[44:47]
    v_mfma_f32_16x16x32_bf16 v[48:51], v[132:135], v[72:75], v[48:51]
    v_mfma_f32_16x16x32_bf16 v[52:55], v[124:127], v[76:79], v[52:55]
    v_mfma_f32_16x16x32_bf16 v[56:59], v[128:131], v[76:79], v[56:59]
    v_mfma_f32_16x16x32_bf16 v[60:63], v[132:135], v[76:79], v[60:63]
    s_waitcnt lgkmcnt(0)
    s_barrier
    v_mfma_f32_16x16x32_bf16 v[16:19], v[136:139], v[232:235], v[16:19]
    ds_read_b128 v[64:67], v3 offset:49152
    v_mfma_f32_16x16x32_bf16 v[20:23], v[140:143], v[232:235], v[20:23]
    ds_read_b128 v[68:71], v3 offset:50176
    v_mfma_f32_16x16x32_bf16 v[24:27], v[144:147], v[232:235], v[24:27]
    ds_read_b128 v[72:75], v3 offset:51200
    v_mfma_f32_16x16x32_bf16 v[28:31], v[136:139], v[236:239], v[28:31]
    ds_read_b128 v[76:79], v3 offset:52224
    v_mfma_f32_16x16x32_bf16 v[32:35], v[140:143], v[236:239], v[32:35]
    v_mfma_f32_16x16x32_bf16 v[36:39], v[144:147], v[236:239], v[36:39]
    v_mfma_f32_16x16x32_bf16 v[40:43], v[136:139], v[240:243], v[40:43]
    v_mfma_f32_16x16x32_bf16 v[44:47], v[140:143], v[240:243], v[44:47]
    v_mfma_f32_16x16x32_bf16 v[48:51], v[144:147], v[240:243], v[48:51]
    v_mfma_f32_16x16x32_bf16 v[52:55], v[136:139], v[244:247], v[52:55]
    v_mfma_f32_16x16x32_bf16 v[56:59], v[140:143], v[244:247], v[56:59]
    v_mfma_f32_16x16x32_bf16 v[60:63], v[144:147], v[244:247], v[60:63]
    s_waitcnt lgkmcnt(0)
    s_barrier
    v_mfma_f32_16x16x32_bf16 v[16:19], v[148:151], v[64:67], v[16:19]
    ds_read_b128 v[232:235], v4 offset:0
    v_mfma_f32_16x16x32_bf16 v[20:23], v[152:155], v[64:67], v[20:23]
    ds_read_b128 v[236:239], v4 offset:1024
    v_mfma_f32_16x16x32_bf16 v[24:27], v[156:159], v[64:67], v[24:27]
    ds_read_b128 v[240:243], v4 offset:2048
    v_mfma_f32_16x16x32_bf16 v[28:31], v[148:151], v[68:71], v[28:31]
    ds_read_b128 v[244:247], v4 offset:3072
    v_mfma_f32_16x16x32_bf16 v[32:35], v[152:155], v[68:71], v[32:35]
    v_mfma_f32_16x16x32_bf16 v[36:39], v[156:159], v[68:71], v[36:39]
    v_mfma_f32_16x16x32_bf16 v[40:43], v[148:151], v[72:75], v[40:43]
    v_mfma_f32_16x16x32_bf16 v[44:47], v[152:155], v[72:75], v[44:47]
    v_mfma_f32_16x16x32_bf16 v[48:51], v[156:159], v[72:75], v[48:51]
    v_mfma_f32_16x16x32_bf16 v[52:55], v[148:151], v[76:79], v[52:55]
    v_mfma_f32_16x16x32_bf16 v[56:59], v[152:155], v[76:79], v[56:59]
    v_mfma_f32_16x16x32_bf16 v[60:63], v[156:159], v[76:79], v[60:63]
    s_waitcnt lgkmcnt(0)
    s_barrier
    v_mfma_f32_16x16x32_bf16 v[16:19], v[160:163], v[232:235], v[16:19]
    ds_read_b128 v[64:67], v2 offset:0
    v_mfma_f32_16x16x32_bf16 v[20:23], v[164:167], v[232:235], v[20:23]
    ds_read_b128 v[68:71], v2 offset:1024
    v_mfma_f32_16x16x32_bf16 v[24:27], v[168:171], v[232:235], v[24:27]
    ds_read_b128 v[72:75], v2 offset:2048
    v_mfma_f32_16x16x32_bf16 v[28:31], v[160:163], v[236:239], v[28:31]
    ds_read_b128 v[76:79], v2 offset:3072
    v_mfma_f32_16x16x32_bf16 v[32:35], v[164:167], v[236:239], v[32:35]
    v_mfma_f32_16x16x32_bf16 v[36:39], v[168:171], v[236:239], v[36:39]
    v_mfma_f32_16x16x32_bf16 v[40:43], v[160:163], v[240:243], v[40:43]
    v_mfma_f32_16x16x32_bf16 v[44:47], v[164:167], v[240:243], v[44:47]
    v_mfma_f32_16x16x32_bf16 v[48:51], v[168:171], v[240:243], v[48:51]
    v_mfma_f32_16x16x32_bf16 v[52:55], v[160:163], v[244:247], v[52:55]
    v_mfma_f32_16x16x32_bf16 v[56:59], v[164:167], v[244:247], v[56:59]
    v_mfma_f32_16x16x32_bf16 v[60:63], v[168:171], v[244:247], v[60:63]
    s_waitcnt lgkmcnt(0)
    s_barrier
    v_mfma_f32_16x16x32_bf16 v[16:19], v[172:175], v[64:67], v[16:19]
    ds_read_b128 v[232:235], v2 offset:16384
    v_mfma_f32_16x16x32_bf16 v[20:23], v[176:179], v[64:67], v[20:23]
    ds_read_b128 v[236:239], v2 offset:17408
    v_mfma_f32_16x16x32_bf16 v[24:27], v[180:183], v[64:67], v[24:27]
    ds_read_b128 v[240:243], v2 offset:18432
    v_mfma_f32_16x16x32_bf16 v[28:31], v[172:175], v[68:71], v[28:31]
    ds_read_b128 v[244:247], v2 offset:19456
    v_mfma_f32_16x16x32_bf16 v[32:35], v[176:179], v[68:71], v[32:35]
    v_mfma_f32_16x16x32_bf16 v[36:39], v[180:183], v[68:71], v[36:39]
    v_mfma_f32_16x16x32_bf16 v[40:43], v[172:175], v[72:75], v[40:43]
    v_mfma_f32_16x16x32_bf16 v[44:47], v[176:179], v[72:75], v[44:47]
    v_mfma_f32_16x16x32_bf16 v[48:51], v[180:183], v[72:75], v[48:51]
    v_mfma_f32_16x16x32_bf16 v[52:55], v[172:175], v[76:79], v[52:55]
    v_mfma_f32_16x16x32_bf16 v[56:59], v[176:179], v[76:79], v[56:59]
    v_mfma_f32_16x16x32_bf16 v[60:63], v[180:183], v[76:79], v[60:63]
    s_waitcnt lgkmcnt(0)
    s_barrier
    v_mfma_f32_16x16x32_bf16 v[16:19], v[184:187], v[232:235], v[16:19]
    ds_read_b128 v[64:67], v2 offset:32768
    v_mfma_f32_16x16x32_bf16 v[20:23], v[188:191], v[232:235], v[20:23]
    ds_read_b128 v[68:71], v2 offset:33792
    v_mfma_f32_16x16x32_bf16 v[24:27], v[192:195], v[232:235], v[24:27]
    ds_read_b128 v[72:75], v2 offset:34816
    v_mfma_f32_16x16x32_bf16 v[28:31], v[184:187], v[236:239], v[28:31]
    ds_read_b128 v[76:79], v2 offset:35840
    v_mfma_f32_16x16x32_bf16 v[32:35], v[188:191], v[236:239], v[32:35]
    v_mfma_f32_16x16x32_bf16 v[36:39], v[192:195], v[236:239], v[36:39]
    v_mfma_f32_16x16x32_bf16 v[40:43], v[184:187], v[240:243], v[40:43]
    v_mfma_f32_16x16x32_bf16 v[44:47], v[188:191], v[240:243], v[44:47]
    v_mfma_f32_16x16x32_bf16 v[48:51], v[192:195], v[240:243], v[48:51]
    v_mfma_f32_16x16x32_bf16 v[52:55], v[184:187], v[244:247], v[52:55]
    v_mfma_f32_16x16x32_bf16 v[56:59], v[188:191], v[244:247], v[56:59]
    v_mfma_f32_16x16x32_bf16 v[60:63], v[192:195], v[244:247], v[60:63]
    s_waitcnt lgkmcnt(0)
    s_barrier
    v_mfma_f32_16x16x32_bf16 v[16:19], v[196:199], v[64:67], v[16:19]
    ds_read_b128 v[232:235], v2 offset:49152
    v_mfma_f32_16x16x32_bf16 v[20:23], v[200:203], v[64:67], v[20:23]
    ds_read_b128 v[236:239], v2 offset:50176
    v_mfma_f32_16x16x32_bf16 v[24:27], v[204:207], v[64:67], v[24:27]
    ds_read_b128 v[240:243], v2 offset:51200
    v_mfma_f32_16x16x32_bf16 v[28:31], v[196:199], v[68:71], v[28:31]
    ds_read_b128 v[244:247], v2 offset:52224
    v_mfma_f32_16x16x32_bf16 v[32:35], v[200:203], v[68:71], v[32:35]
    v_mfma_f32_16x16x32_bf16 v[36:39], v[204:207], v[68:71], v[36:39]
    v_mfma_f32_16x16x32_bf16 v[40:43], v[196:199], v[72:75], v[40:43]
    v_mfma_f32_16x16x32_bf16 v[44:47], v[200:203], v[72:75], v[44:47]
    v_mfma_f32_16x16x32_bf16 v[48:51], v[204:207], v[72:75], v[48:51]
    v_mfma_f32_16x16x32_bf16 v[52:55], v[196:199], v[76:79], v[52:55]
    v_mfma_f32_16x16x32_bf16 v[56:59], v[200:203], v[76:79], v[56:59]
    v_mfma_f32_16x16x32_bf16 v[60:63], v[204:207], v[76:79], v[60:63]
    s_waitcnt vmcnt(4)
    s_waitcnt lgkmcnt(0)
    s_barrier
    v_mfma_f32_16x16x32_bf16 v[16:19], v[208:211], v[232:235], v[16:19]
    ds_read_b128 v[64:67], v3 offset:0
    v_mfma_f32_16x16x32_bf16 v[20:23], v[212:215], v[232:235], v[20:23]
    ds_read_b128 v[68:71], v3 offset:1024
    v_mfma_f32_16x16x32_bf16 v[24:27], v[216:219], v[232:235], v[24:27]
    ds_read_b128 v[72:75], v3 offset:2048
    v_mfma_f32_16x16x32_bf16 v[28:31], v[208:211], v[236:239], v[28:31]
    ds_read_b128 v[76:79], v3 offset:3072
    v_mfma_f32_16x16x32_bf16 v[32:35], v[212:215], v[236:239], v[32:35]
    v_mfma_f32_16x16x32_bf16 v[36:39], v[216:219], v[236:239], v[36:39]
    v_mfma_f32_16x16x32_bf16 v[40:43], v[208:211], v[240:243], v[40:43]
    v_mfma_f32_16x16x32_bf16 v[44:47], v[212:215], v[240:243], v[44:47]
    v_mfma_f32_16x16x32_bf16 v[48:51], v[216:219], v[240:243], v[48:51]
    v_mfma_f32_16x16x32_bf16 v[52:55], v[208:211], v[244:247], v[52:55]
    v_mfma_f32_16x16x32_bf16 v[56:59], v[212:215], v[244:247], v[56:59]
    v_mfma_f32_16x16x32_bf16 v[60:63], v[216:219], v[244:247], v[60:63]
    s_waitcnt vmcnt(0)
    s_waitcnt lgkmcnt(0)
    v_mfma_f32_16x16x32_bf16 v[52:55], v[220:223], v[76:79], v[52:55]
    v_mfma_f32_16x16x32_bf16 v[56:59], v[224:227], v[76:79], v[56:59]
    v_mfma_f32_16x16x32_bf16 v[60:63], v[228:231], v[76:79], v[60:63]
    v_mfma_f32_16x16x32_bf16 v[40:43], v[220:223], v[72:75], v[40:43]
    v_mfma_f32_16x16x32_bf16 v[44:47], v[224:227], v[72:75], v[44:47]
    v_mfma_f32_16x16x32_bf16 v[48:51], v[228:231], v[72:75], v[48:51]
    v_mfma_f32_16x16x32_bf16 v[28:31], v[220:223], v[68:71], v[28:31]
    s_nop 1
    s_nop 0
    ds_write_b128 v9, v[52:55] offset:0
    v_mfma_f32_16x16x32_bf16 v[32:35], v[224:227], v[68:71], v[32:35]
    ds_write_b128 v9, v[56:59] offset:1024
    v_mfma_f32_16x16x32_bf16 v[36:39], v[228:231], v[68:71], v[36:39]
    ds_write_b128 v9, v[60:63] offset:2048
    v_mfma_f32_16x16x32_bf16 v[16:19], v[220:223], v[64:67], v[16:19]
    ds_write_b128 v8, v[40:43] offset:0
    v_mfma_f32_16x16x32_bf16 v[20:23], v[224:227], v[64:67], v[20:23]
    ds_write_b128 v8, v[44:47] offset:1024
    v_mfma_f32_16x16x32_bf16 v[24:27], v[228:231], v[64:67], v[24:27]
    ds_write_b128 v8, v[48:51] offset:2048
    s_nop 4
    ds_write_b128 v7, v[28:31] offset:0
    ds_write_b128 v7, v[32:35] offset:1024
    ds_write_b128 v7, v[36:39] offset:2048
    ds_read_b64_tr_b16 v[64:65], v5 offset:0
    ds_read_b64_tr_b16 v[66:67], v5 offset:512
    ds_read_b64_tr_b16 v[68:69], v5 offset:1024
    s_waitcnt lgkmcnt(0)
    s_barrier
    ds_read_b128 v[72:75], v14 offset:0
    ds_read_b128 v[76:79], v14 offset:1024
    ds_read_b128 v[80:83], v14 offset:2048
    ds_read_b128 v[84:87], v14 offset:5120
    ds_read_b128 v[88:91], v14 offset:6144
    ds_read_b128 v[92:95], v14 offset:7168
    ds_read_b128 v[96:99], v14 offset:10240
    ds_read_b128 v[100:103], v14 offset:11264
    ds_read_b128 v[104:107], v14 offset:12288
    v_lshlrev_b32 v112, 16, v64
    v_and_b32 v113, 0xffff0000, v64
    v_lshlrev_b32 v114, 16, v65
    v_and_b32 v115, 0xffff0000, v65
    v_lshlrev_b32 v116, 16, v66
    v_and_b32 v117, 0xffff0000, v66
    v_lshlrev_b32 v118, 16, v67
    v_and_b32 v119, 0xffff0000, v67
    v_lshlrev_b32 v120, 16, v68
    v_and_b32 v121, 0xffff0000, v68
    v_lshlrev_b32 v122, 16, v69
    v_and_b32 v123, 0xffff0000, v69
    s_waitcnt vmcnt(0)
    v_mov_b32 v12, v13
    s_waitcnt lgkmcnt(6)
    v_pk_add_f32 v[16:17], v[16:17], v[72:73]
    v_pk_add_f32 v[18:19], v[18:19], v[74:75]
    v_pk_add_f32 v[20:21], v[20:21], v[76:77]
    v_pk_add_f32 v[22:23], v[22:23], v[78:79]
    v_pk_add_f32 v[24:25], v[24:25], v[80:81]
    v_pk_add_f32 v[26:27], v[26:27], v[82:83]
    s_waitcnt lgkmcnt(3)
    v_pk_add_f32 v[16:17], v[16:17], v[84:85]
    v_pk_add_f32 v[18:19], v[18:19], v[86:87]
    v_pk_add_f32 v[20:21], v[20:21], v[88:89]
    v_pk_add_f32 v[22:23], v[22:23], v[90:91]
    v_pk_add_f32 v[24:25], v[24:25], v[92:93]
    v_pk_add_f32 v[26:27], v[26:27], v[94:95]
    s_waitcnt lgkmcnt(0)
    v_pk_add_f32 v[16:17], v[16:17], v[96:97]
    v_pk_add_f32 v[18:19], v[18:19], v[98:99]
    v_pk_add_f32 v[20:21], v[20:21], v[100:101]
    v_pk_add_f32 v[22:23], v[22:23], v[102:103]
    v_pk_add_f32 v[24:25], v[24:25], v[104:105]
    v_pk_add_f32 v[26:27], v[26:27], v[106:107]
    v_pk_fma_f32 v[16:17], v[16:17], v[12:13], v[112:113]
    v_cvt_pk_bf16_f32 v64, v16, v17
    v_pk_fma_f32 v[18:19], v[18:19], v[12:13], v[114:115]
    v_cvt_pk_bf16_f32 v65, v18, v19
    v_pk_fma_f32 v[20:21], v[20:21], v[12:13], v[116:117]
    v_cvt_pk_bf16_f32 v66, v20, v21
    v_pk_fma_f32 v[22:23], v[22:23], v[12:13], v[118:119]
    v_cvt_pk_bf16_f32 v67, v22, v23
    v_pk_fma_f32 v[24:25], v[24:25], v[12:13], v[120:121]
    v_cvt_pk_bf16_f32 v68, v24, v25
    v_pk_fma_f32 v[26:27], v[26:27], v[12:13], v[122:123]
    v_cvt_pk_bf16_f32 v69, v26, v27
    buffer_store_dwordx4 v[64:67], v11, s[16:19], s28 offen
    buffer_store_dwordx2 v[68:69], v11, s[16:19], s28 offen offset:16
    s_endpgm
M_FFN_C:
PADB3:
    s_cbranch_execz PADB4
    s_nop 0
    s_mul_i32 s26, s21, 37
    s_lshr_b32 s26, s26, 8
    s_and_b32 s22, s20, 3
    s_lshl_b32 s22, s22, 2
    s_add_u32 s22, s22, s26
    s_lshr_b32 s23, s20, 2
    s_sub_u32 s23, s23, s26
    s_mul_i32 s23, s23, 7
    s_add_u32 s23, s23, s21
    s_and_b32 s26, s26, 1
    s_cselect_b32 s62, 6, 13
    s_cmp_eq_u32 s23, s62
    s_cselect_b32 s62, 1, 0
    s_lshr_b32 s27, s20, 2
    s_and_b32 s26, s26, s27
    s_lshl_b32 s23, s23, 1
    s_sub_u32 s23, s23, s26
    s_and_b32 s44, s20, 3
    s_lshl_b32 s44, s44, 3
    s_and_b32 s26, s21, 7
    s_add_u32 s44, s44, s26
    s_lshr_b32 s45, s20, 2
    s_lshl_b32 s45, s45, 2
    s_lshr_b32 s26, s21, 3
    s_add_u32 s45, s45, s26
    s_mul_i32 s27, s45, 276480
    s_add_u32 s27, s27, 20971520
    s_add_u32 s52, s4, s27
    s_addc_u32 s53, s5, 0
    s_and_b32 s53, s53, 0xffff
    s_mov_b32 s54, 276480
    s_mov_b32 s55, 0x20000
    s_add_u32 s40, s4, 15269888
    s_addc_u32 s41, s5, 0
    s_and_b32 s41, s41, 0xffff
    s_mov_b32 s42, 49152
    s_mov_b32 s43, 0x20000
    v_lshlrev_b32 v6, 4, v1
    s_mul_i32 s50, s25, 10240
    s_add_u32 s50, s50, 3072
    s_cmp_ge_u32 s21, 28
    s_cbranch_scc1 F_C_STAT
    s_and_b32 s28, s25, 1
    s_lshr_b32 s29, s25, 1
    v_lshrrev_b32 v12, 2, v1
    v_and_b32 v13, 7, v12
    v_lshlrev_b32 v13, 5, v13
    v_lshl_add_u32 v13, v12, 8, v13
    v_and_b32 v12, 3, v1
    v_lshl_add_u32 v13, v12, 3, v13
    s_lshl_b32 s30, s28, 7
    v_xor_b32 v2, s30, v13
    s_lshl_b32 s30, s29, 7
    s_add_u32 s30, s30, 8192
    v_xor_b32 v8, s30, v13
    v_xor_b32 v3, 32, v2
    v_xor_b32 v9, 32, v8
    v_xor_b32 v4, 64, v2
    v_xor_b32 v10, 64, v8
    v_xor_b32 v5, 96, v2
    v_xor_b32 v11, 96, v8
    v_add_u32 v240, 90112, v2
    v_add_u32 v244, 90112, v8
    v_add_u32 v241, 90112, v3
    v_add_u32 v245, 90112, v9
    v_add_u32 v242, 90112, v4
    v_add_u32 v246, 90112, v10
    v_add_u32 v243, 90112, v5
    v_add_u32 v247, 90112, v11
    v_add_u32 v2, 16384, v2
    v_add_u32 v8, 16384, v8
    v_add_u32 v3, 16384, v3
    v_add_u32 v9, 16384, v9
    v_add_u32 v4, 16384, v4
    v_add_u32 v10, 16384, v10
    v_add_u32 v5, 16384, v5
    v_add_u32 v11, 16384, v11
    v_mov_b32 v112, 0
    v_mov_b32 v113, 0
    v_mov_b32 v114, 0
    v_mov_b32 v115, 0
    v_mov_b32 v116, 0
    v_mov_b32 v117, 0
    v_mov_b32 v118, 0
    v_mov_b32 v119, 0
    v_mov_b32 v120, 0
    v_mov_b32 v121, 0
    v_mov_b32 v122, 0
    v_mov_b32 v123, 0
    v_mov_b32 v124, 0
    v_mov_b32 v125, 0
    v_mov_b32 v126, 0
    v_mov_b32 v127, 0
    v_mov_b32 v128, 0
    v_mov_b32 v129, 0
    v_mov_b32 v130, 0
    v_mov_b32 v131, 0
    v_mov_b32 v132, 0
    v_mov_b32 v133, 0
    v_mov_b32 v134, 0
    v_mov_b32 v135, 0
    v_mov_b32 v136, 0
    v_mov_b32 v137, 0
    v_mov_b32 v138, 0
    v_mov_b32 v139, 0
    v_mov_b32 v140, 0
    v_mov_b32 v141, 0
    v_mov_b32 v142, 0
    v_mov_b32 v143, 0
    v_mov_b32 v144, 0
    v_mov_b32 v145, 0
    v_mov_b32 v146, 0
    v_mov_b32 v147, 0
    v_mov_b32 v148, 0
    v_mov_b32 v149, 0
    v_mov_b32 v150, 0
    v_mov_b32 v151, 0
    v_mov_b32 v152, 0
    v_mov_b32 v153, 0
    v_mov_b32 v154, 0
    v_mov_b32 v155, 0
    v_mov_b32 v156, 0
    v_mov_b32 v157, 0
    v_mov_b32 v158, 0
    v_mov_b32 v159, 0
    v_mov_b32 v160, 0
    v_mov_b32 v161, 0
    v_mov_b32 v162, 0
    v_mov_b32 v163, 0
    v_mov_b32 v164, 0
    v_mov_b32 v165, 0
    v_mov_b32 v166, 0
    v_mov_b32 v167, 0
    v_mov_b32 v168, 0
    v_mov_b32 v169, 0
    v_mov_b32 v170, 0
    v_mov_b32 v171, 0
    v_mov_b32 v172, 0
    v_mov_b32 v173, 0
    v_mov_b32 v174, 0
    v_mov_b32 v175, 0
    v_mov_b32 v176, 0
    v_mov_b32 v177, 0
    v_mov_b32 v178, 0
    v_mov_b32 v179, 0
    v_mov_b32 v180, 0
    v_mov_b32 v181, 0
    v_mov_b32 v182, 0
    v_mov_b32 v183, 0
    v_mov_b32 v184, 0
    v_mov_b32 v185, 0
    v_mov_b32 v186, 0
    v_mov_b32 v187, 0
    v_mov_b32 v188, 0
    v_mov_b32 v189, 0
    v_mov_b32 v190, 0
    v_mov_b32 v191, 0
    v_mov_b32 v192, 0
    v_mov_b32 v193, 0
    v_mov_b32 v194, 0
    v_mov_b32 v195, 0
    v_mov_b32 v196, 0
    v_mov_b32 v197, 0
    v_mov_b32 v198, 0
    v_mov_b32 v199, 0
    v_mov_b32 v200, 0
    v_mov_b32 v201, 0
    v_mov_b32 v202, 0
    v_mov_b32 v203, 0
    v_mov_b32 v204, 0
    v_mov_b32 v205, 0
    v_mov_b32 v206, 0
    v_mov_b32 v207, 0
    v_mov_b32 v208, 0
    v_mov_b32 v209, 0
    v_mov_b32 v210, 0
    v_mov_b32 v211, 0
    v_mov_b32 v212, 0
    v_mov_b32 v213, 0
    v_mov_b32 v214, 0
    v_mov_b32 v215, 0
    v_mov_b32 v216, 0
    v_mov_b32 v217, 0
    v_mov_b32 v218, 0
    v_mov_b32 v219, 0
    v_mov_b32 v220, 0
    v_mov_b32 v221, 0
    v_mov_b32 v222, 0
    v_mov_b32 v223, 0
    v_mov_b32 v224, 0
    v_mov_b32 v225, 0
    v_mov_b32 v226, 0
    v_mov_b32 v227, 0
    v_mov_b32 v228, 0
    v_mov_b32 v229, 0
    v_mov_b32 v230, 0
    v_mov_b32 v231, 0
    v_mov_b32 v232, 0
    v_mov_b32 v233, 0
    v_mov_b32 v234, 0
    v_mov_b32 v235, 0
    v_mov_b32 v236, 0
    v_mov_b32 v237, 0
    v_mov_b32 v238, 0
    v_mov_b32 v239, 0
    s_add_u32 s16, s4, 24117248
    s_addc_u32 s17, s5, 0
    s_and_b32 s17, s17, 0xffff
    s_mov_b32 s18, 7077888
    s_mov_b32 s19, 0x20000
    s_cmp_eq_u32 s62, 1
    s_cselect_b32 s31, s29, 0
    s_cmp_eq_u32 s31, 1
    s_cselect_b32 s18, 0, s18
    s_lshl_b32 s26, s22, 1
    s_add_u32 s26, s26, s28
    s_mul_i32 s26, s26, 221184
    s_lshl_b32 s27, s23, 13
    s_add_u32 s26, s26, s27
    s_lshl_b32 s27, s29, 13
    s_add_u32 s26, s26, s27
    s_add_u32 s27, s26, 4096
    v_lshrrev_b32 v14, 4, v1
    v_lshlrev_b32 v14, 4, v14
    s_lshl_b32 s30, s29, 8
    s_add_u32 s30, s30, 12288
    v_add_u32 v14, s30, v14
    v_and_b32 v15, 15, v1
    v_lshlrev_b32 v15, 2, v15
    s_lshl_b32 s30, s28, 8
    s_add_u32 s30, s30, 13312
    v_add_u32 v15, s30, v15
    s_setprio 3
    s_cmp_lg_u32 s24, 4
    s_cbranch_scc1 F_C_S2_OK
    s_add_u32 s36, s4, 15335424
    s_addc_u32 s37, s5, 0
    s_and_b32 s37, s37, 0xffff
    s_mov_b32 s38, 13824
    s_mov_b32 s39, 0x20000
    s_lshl_b32 s30, s20, 9
    s_add_u32 s30, s30, 5120
    v_and_b32 v12, 3, v1
    v_lshlrev_b32 v12, 7, v12
    s_mov_b32 s48, 0
F_C_S2:
    buffer_load_dword v13, v12, s[36:39], s30 offen sc1
    s_add_u32 s48, s48, 1
    s_waitcnt vmcnt(0)
    v_cmp_gt_u32 vcc, 1, v13
    s_cbranch_vccz F_C_S2_OK
    s_sleep 1
    s_cmp_lt_u32 s48, 262144
    s_cbranch_scc1 F_C_S2
F_C_S2_OK:
    s_barrier
    s_mov_b32 s36, 0
    s_barrier
    ds_read_b64_tr_b16 v[16:17], v244 offset:24576
    ds_read_b64_tr_b16 v[18:19], v244 offset:28672
    ds_read_b64_tr_b16 v[48:49], v240 offset:24576
    ds_read_b64_tr_b16 v[50:51], v240 offset:28672
    ds_read_b64_tr_b16 v[52:53], v241 offset:24576
    ds_read_b64_tr_b16 v[54:55], v241 offset:28672
    ds_read_b64_tr_b16 v[56:57], v242 offset:24576
    ds_read_b64_tr_b16 v[58:59], v242 offset:28672
    ds_read_b64_tr_b16 v[60:61], v243 offset:24576
    ds_read_b64_tr_b16 v[62:63], v243 offset:28672
    ds_read_b64_tr_b16 v[20:21], v245 offset:24576
    ds_read_b64_tr_b16 v[22:23], v245 offset:28672
    ds_read_b64_tr_b16 v[24:25], v244 offset:32768
    ds_read_b64_tr_b16 v[26:27], v244 offset:36864
    ds_read_b64_tr_b16 v[28:29], v245 offset:32768
    ds_read_b64_tr_b16 v[30:31], v245 offset:36864
    ds_read_b64_tr_b16 v[32:33], v246 offset:24576
    ds_read_b64_tr_b16 v[34:35], v246 offset:28672
    ds_read_b64_tr_b16 v[36:37], v247 offset:24576
    ds_read_b64_tr_b16 v[38:39], v247 offset:28672
    ds_read_b64_tr_b16 v[40:41], v246 offset:32768
    ds_read_b64_tr_b16 v[42:43], v246 offset:36864
    ds_read_b64_tr_b16 v[44:45], v247 offset:32768
    ds_read_b64_tr_b16 v[46:47], v247 offset:36864
    s_waitcnt lgkmcnt(0)
    s_barrier
    .p2align 3
F_C_LOOP:
    v_mfma_f32_16x16x32_bf16 v[112:115], v[16:19], v[48:51], v[112:115]
    ds_read_b64_tr_b16 v[64:65], v244 offset:49152
    v_mfma_f32_16x16x32_bf16 v[116:119], v[16:19], v[52:55], v[116:119]
    ds_read_b64_tr_b16 v[66:67], v244 offset:53248
    v_mfma_f32_16x16x32_bf16 v[120:123], v[16:19], v[56:59], v[120:123]
    ds_read_b64_tr_b16 v[96:97], v240 offset:49152
    v_mfma_f32_16x16x32_bf16 v[124:127], v[16:19], v[60:63], v[124:127]
    ds_read_b64_tr_b16 v[98:99], v240 offset:53248
    v_mfma_f32_16x16x32_bf16 v[128:131], v[20:23], v[48:51], v[128:131]
    ds_read_b64_tr_b16 v[100:101], v241 offset:49152
    v_mfma_f32_16x16x32_bf16 v[132:135], v[20:23], v[52:55], v[132:135]
    ds_read_b64_tr_b16 v[102:103], v241 offset:53248
    v_mfma_f32_16x16x32_bf16 v[136:139], v[20:23], v[56:59], v[136:139]
    ds_read_b64_tr_b16 v[104:105], v242 offset:49152
    v_mfma_f32_16x16x32_bf16 v[140:143], v[20:23], v[60:63], v[140:143]
    ds_read_b64_tr_b16 v[106:107], v242 offset:53248
    v_mfma_f32_16x16x32_bf16 v[144:147], v[24:27], v[48:51], v[144:147]
    ds_read_b64_tr_b16 v[108:109], v243 offset:49152
    v_mfma_f32_16x16x32_bf16 v[148:151], v[24:27], v[52:55], v[148:151]
    ds_read_b64_tr_b16 v[110:111], v243 offset:53248
    v_mfma_f32_16x16x32_bf16 v[152:155], v[24:27], v[56:59], v[152:155]
    ds_read_b64_tr_b16 v[68:69], v245 offset:49152
    v_mfma_f32_16x16x32_bf16 v[156:159], v[24:27], v[60:63], v[156:159]
    ds_read_b64_tr_b16 v[70:71], v245 offset:53248
    v_mfma_f32_16x16x32_bf16 v[160:163], v[28:31], v[48:51], v[160:163]
    ds_read_b64_tr_b16 v[72:73], v244 offset:57344
    v_mfma_f32_16x16x32_bf16 v[164:167], v[28:31], v[52:55], v[164:167]
    ds_read_b64_tr_b16 v[74:75], v244 offset:61440
    v_mfma_f32_16x16x32_bf16 v[168:171], v[28:31], v[56:59], v[168:171]
    ds_read_b64_tr_b16 v[76:77], v245 offset:57344
    v_mfma_f32_16x16x32_bf16 v[172:175], v[28:31], v[60:63], v[172:175]
    ds_read_b64_tr_b16 v[78:79], v245 offset:61440
    v_mfma_f32_16x16x32_bf16 v[176:179], v[32:35], v[48:51], v[176:179]
    ds_read_b64_tr_b16 v[80:81], v246 offset:49152
    v_mfma_f32_16x16x32_bf16 v[180:183], v[32:35], v[52:55], v[180:183]
    ds_read_b64_tr_b16 v[82:83], v246 offset:53248
    v_mfma_f32_16x16x32_bf16 v[184:187], v[32:35], v[56:59], v[184:187]
    ds_read_b64_tr_b16 v[84:85], v247 offset:49152
    v_mfma_f32_16x16x32_bf16 v[188:191], v[32:35], v[60:63], v[188:191]
    ds_read_b64_tr_b16 v[86:87], v247 offset:53248
    v_mfma_f32_16x16x32_bf16 v[192:195], v[36:39], v[48:51], v[192:195]
    ds_read_b64_tr_b16 v[88:89], v246 offset:57344
PADB4:
    s_cbranch_execz PADB5
    s_nop 0
    v_mfma_f32_16x16x32_bf16 v[196:199], v[36:39], v[52:55], v[196:199]
    ds_read_b64_tr_b16 v[90:91], v246 offset:61440
    v_mfma_f32_16x16x32_bf16 v[200:203], v[36:39], v[56:59], v[200:203]
    ds_read_b64_tr_b16 v[92:93], v247 offset:57344
    v_mfma_f32_16x16x32_bf16 v[204:207], v[36:39], v[60:63], v[204:207]
    ds_read_b64_tr_b16 v[94:95], v247 offset:61440
    v_mfma_f32_16x16x32_bf16 v[208:211], v[40:43], v[48:51], v[208:211]
    v_mfma_f32_16x16x32_bf16 v[212:215], v[40:43], v[52:55], v[212:215]
    v_mfma_f32_16x16x32_bf16 v[216:219], v[40:43], v[56:59], v[216:219]
    v_mfma_f32_16x16x32_bf16 v[220:223], v[40:43], v[60:63], v[220:223]
    v_mfma_f32_16x16x32_bf16 v[224:227], v[44:47], v[48:51], v[224:227]
    v_mfma_f32_16x16x32_bf16 v[228:231], v[44:47], v[52:55], v[228:231]
    v_mfma_f32_16x16x32_bf16 v[232:235], v[44:47], v[56:59], v[232:235]
    s_waitcnt lgkmcnt(0)
    s_add_u32 s36, s36, 1
    v_mfma_f32_16x16x32_bf16 v[236:239], v[44:47], v[60:63], v[236:239]
    s_barrier
    s_nop 0
    v_mfma_f32_16x16x32_bf16 v[112:115], v[64:67], v[96:99], v[112:115]
    ds_read_b64_tr_b16 v[16:17], v8 offset:0
    v_mfma_f32_16x16x32_bf16 v[116:119], v[64:67], v[100:103], v[116:119]
    ds_read_b64_tr_b16 v[18:19], v8 offset:4096
    v_mfma_f32_16x16x32_bf16 v[120:123], v[64:67], v[104:107], v[120:123]
    ds_read_b64_tr_b16 v[48:49], v2 offset:0
    v_mfma_f32_16x16x32_bf16 v[124:127], v[64:67], v[108:111], v[124:127]
    ds_read_b64_tr_b16 v[50:51], v2 offset:4096
    v_mfma_f32_16x16x32_bf16 v[128:131], v[68:71], v[96:99], v[128:131]
    ds_read_b64_tr_b16 v[52:53], v3 offset:0
    v_mfma_f32_16x16x32_bf16 v[132:135], v[68:71], v[100:103], v[132:135]
    ds_read_b64_tr_b16 v[54:55], v3 offset:4096
    v_mfma_f32_16x16x32_bf16 v[136:139], v[68:71], v[104:107], v[136:139]
    ds_read_b64_tr_b16 v[56:57], v4 offset:0
    v_mfma_f32_16x16x32_bf16 v[140:143], v[68:71], v[108:111], v[140:143]
    ds_read_b64_tr_b16 v[58:59], v4 offset:4096
    v_mfma_f32_16x16x32_bf16 v[144:147], v[72:75], v[96:99], v[144:147]
    ds_read_b64_tr_b16 v[60:61], v5 offset:0
    v_mfma_f32_16x16x32_bf16 v[148:151], v[72:75], v[100:103], v[148:151]
    ds_read_b64_tr_b16 v[62:63], v5 offset:4096
    v_mfma_f32_16x16x32_bf16 v[152:155], v[72:75], v[104:107], v[152:155]
    ds_read_b64_tr_b16 v[20:21], v9 offset:0
    v_mfma_f32_16x16x32_bf16 v[156:159], v[72:75], v[108:111], v[156:159]
    ds_read_b64_tr_b16 v[22:23], v9 offset:4096
    v_mfma_f32_16x16x32_bf16 v[160:163], v[76:79], v[96:99], v[160:163]
    ds_read_b64_tr_b16 v[24:25], v8 offset:8192
    v_mfma_f32_16x16x32_bf16 v[164:167], v[76:79], v[100:103], v[164:167]
    ds_read_b64_tr_b16 v[26:27], v8 offset:12288
    v_mfma_f32_16x16x32_bf16 v[168:171], v[76:79], v[104:107], v[168:171]
    ds_read_b64_tr_b16 v[28:29], v9 offset:8192
    v_mfma_f32_16x16x32_bf16 v[172:175], v[76:79], v[108:111], v[172:175]
    ds_read_b64_tr_b16 v[30:31], v9 offset:12288
    v_mfma_f32_16x16x32_bf16 v[176:179], v[80:83], v[96:99], v[176:179]
    ds_read_b64_tr_b16 v[32:33], v10 offset:0
    v_mfma_f32_16x16x32_bf16 v[180:183], v[80:83], v[100:103], v[180:183]
    ds_read_b64_tr_b16 v[34:35], v10 offset:4096
    v_mfma_f32_16x16x32_bf16 v[184:187], v[80:83], v[104:107], v[184:187]
    ds_read_b64_tr_b16 v[36:37], v11 offset:0
    v_mfma_f32_16x16x32_bf16 v[188:191], v[80:83], v[108:111], v[188:191]
    ds_read_b64_tr_b16 v[38:39], v11 offset:4096
    v_mfma_f32_16x16x32_bf16 v[192:195], v[84:87], v[96:99], v[192:195]
    ds_read_b64_tr_b16 v[40:41], v10 offset:8192
    v_mfma_f32_16x16x32_bf16 v[196:199], v[84:87], v[100:103], v[196:199]
    ds_read_b64_tr_b16 v[42:43], v10 offset:12288
    v_mfma_f32_16x16x32_bf16 v[200:203], v[84:87], v[104:107], v[200:203]
    ds_read_b64_tr_b16 v[44:45], v11 offset:8192
    v_mfma_f32_16x16x32_bf16 v[204:207], v[84:87], v[108:111], v[204:207]
    ds_read_b64_tr_b16 v[46:47], v11 offset:12288
    v_mfma_f32_16x16x32_bf16 v[208:211], v[88:91], v[96:99], v[208:211]
    v_mfma_f32_16x16x32_bf16 v[212:215], v[88:91], v[100:103], v[212:215]
    v_mfma_f32_16x16x32_bf16 v[216:219], v[88:91], v[104:107], v[216:219]
    v_mfma_f32_16x16x32_bf16 v[220:223], v[88:91], v[108:111], v[220:223]
    v_mfma_f32_16x16x32_bf16 v[224:227], v[92:95], v[96:99], v[224:227]
    v_mfma_f32_16x16x32_bf16 v[228:231], v[92:95], v[100:103], v[228:231]
    v_mfma_f32_16x16x32_bf16 v[232:235], v[92:95], v[104:107], v[232:235]
    s_waitcnt lgkmcnt(0)
    s_cmp_lt_u32 s36, 2
    v_mfma_f32_16x16x32_bf16 v[236:239], v[92:95], v[108:111], v[236:239]
    s_barrier
    s_nop 0
    v_mfma_f32_16x16x32_bf16 v[112:115], v[16:19], v[48:51], v[112:115]
    ds_read_b64_tr_b16 v[64:65], v8 offset:24576
    v_mfma_f32_16x16x32_bf16 v[116:119], v[16:19], v[52:55], v[116:119]
    ds_read_b64_tr_b16 v[66:67], v8 offset:28672
    v_mfma_f32_16x16x32_bf16 v[120:123], v[16:19], v[56:59], v[120:123]
    ds_read_b64_tr_b16 v[96:97], v2 offset:24576
    v_mfma_f32_16x16x32_bf16 v[124:127], v[16:19], v[60:63], v[124:127]
    ds_read_b64_tr_b16 v[98:99], v2 offset:28672
    v_mfma_f32_16x16x32_bf16 v[128:131], v[20:23], v[48:51], v[128:131]
    ds_read_b64_tr_b16 v[100:101], v3 offset:24576
    v_mfma_f32_16x16x32_bf16 v[132:135], v[20:23], v[52:55], v[132:135]
    ds_read_b64_tr_b16 v[102:103], v3 offset:28672
    v_mfma_f32_16x16x32_bf16 v[136:139], v[20:23], v[56:59], v[136:139]
    ds_read_b64_tr_b16 v[104:105], v4 offset:24576
    v_mfma_f32_16x16x32_bf16 v[140:143], v[20:23], v[60:63], v[140:143]
    ds_read_b64_tr_b16 v[106:107], v4 offset:28672
    v_mfma_f32_16x16x32_bf16 v[144:147], v[24:27], v[48:51], v[144:147]
    ds_read_b64_tr_b16 v[108:109], v5 offset:24576
    v_mfma_f32_16x16x32_bf16 v[148:151], v[24:27], v[52:55], v[148:151]
    ds_read_b64_tr_b16 v[110:111], v5 offset:28672
    v_mfma_f32_16x16x32_bf16 v[152:155], v[24:27], v[56:59], v[152:155]
    ds_read_b64_tr_b16 v[68:69], v9 offset:24576
    v_mfma_f32_16x16x32_bf16 v[156:159], v[24:27], v[60:63], v[156:159]
    ds_read_b64_tr_b16 v[70:71], v9 offset:28672
    v_mfma_f32_16x16x32_bf16 v[160:163], v[28:31], v[48:51], v[160:163]
    ds_read_b64_tr_b16 v[72:73], v8 offset:32768
    v_mfma_f32_16x16x32_bf16 v[164:167], v[28:31], v[52:55], v[164:167]
    ds_read_b64_tr_b16 v[74:75], v8 offset:36864
    v_mfma_f32_16x16x32_bf16 v[168:171], v[28:31], v[56:59], v[168:171]
    ds_read_b64_tr_b16 v[76:77], v9 offset:32768
    v_mfma_f32_16x16x32_bf16 v[172:175], v[28:31], v[60:63], v[172:175]
    ds_read_b64_tr_b16 v[78:79], v9 offset:36864
    v_mfma_f32_16x16x32_bf16 v[176:179], v[32:35], v[48:51], v[176:179]
    ds_read_b64_tr_b16 v[80:81], v10 offset:24576
    v_mfma_f32_16x16x32_bf16 v[180:183], v[32:35], v[52:55], v[180:183]
    ds_read_b64_tr_b16 v[82:83], v10 offset:28672
    v_mfma_f32_16x16x32_bf16 v[184:187], v[32:35], v[56:59], v[184:187]
    ds_read_b64_tr_b16 v[84:85], v11 offset:24576
    v_mfma_f32_16x16x32_bf16 v[188:191], v[32:35], v[60:63], v[188:191]
    ds_read_b64_tr_b16 v[86:87], v11 offset:28672
    v_mfma_f32_16x16x32_bf16 v[192:195], v[36:39], v[48:51], v[192:195]
    ds_read_b64_tr_b16 v[88:89], v10 offset:32768
    v_mfma_f32_16x16x32_bf16 v[196:199], v[36:39], v[52:55], v[196:199]
    ds_read_b64_tr_b16 v[90:91], v10 offset:36864
    v_mfma_f32_16x16x32_bf16 v[200:203], v[36:39], v[56:59], v[200:203]
    ds_read_b64_tr_b16 v[92:93], v11 offset:32768
    v_mfma_f32_16x16x32_bf16 v[204:207], v[36:39], v[60:63], v[204:207]
    ds_read_b64_tr_b16 v[94:95], v11 offset:36864
    v_mfma_f32_16x16x32_bf16 v[208:211], v[40:43], v[48:51], v[208:211]
    v_mfma_f32_16x16x32_bf16 v[212:215], v[40:43], v[52:55], v[212:215]
    v_mfma_f32_16x16x32_bf16 v[216:219], v[40:43], v[56:59], v[216:219]
    v_mfma_f32_16x16x32_bf16 v[220:223], v[40:43], v[60:63], v[220:223]
    v_mfma_f32_16x16x32_bf16 v[224:227], v[44:47], v[48:51], v[224:227]
    v_mfma_f32_16x16x32_bf16 v[228:231], v[44:47], v[52:55], v[228:231]
    v_mfma_f32_16x16x32_bf16 v[232:235], v[44:47], v[56:59], v[232:235]
    s_waitcnt lgkmcnt(0)
    s_nop 0
    v_mfma_f32_16x16x32_bf16 v[236:239], v[44:47], v[60:63], v[236:239]
    s_barrier
    s_nop 0
    v_mfma_f32_16x16x32_bf16 v[112:115], v[64:67], v[96:99], v[112:115]
    ds_read_b64_tr_b16 v[16:17], v8 offset:49152
    v_mfma_f32_16x16x32_bf16 v[116:119], v[64:67], v[100:103], v[116:119]
    ds_read_b64_tr_b16 v[18:19], v8 offset:53248
    v_mfma_f32_16x16x32_bf16 v[120:123], v[64:67], v[104:107], v[120:123]
    ds_read_b64_tr_b16 v[48:49], v2 offset:49152
    v_mfma_f32_16x16x32_bf16 v[124:127], v[64:67], v[108:111], v[124:127]
    ds_read_b64_tr_b16 v[50:51], v2 offset:53248
    v_mfma_f32_16x16x32_bf16 v[128:131], v[68:71], v[96:99], v[128:131]
    ds_read_b64_tr_b16 v[52:53], v3 offset:49152
    v_mfma_f32_16x16x32_bf16 v[132:135], v[68:71], v[100:103], v[132:135]
    ds_read_b64_tr_b16 v[54:55], v3 offset:53248
    v_mfma_f32_16x16x32_bf16 v[136:139], v[68:71], v[104:107], v[136:139]
    ds_read_b64_tr_b16 v[56:57], v4 offset:49152
    v_mfma_f32_16x16x32_bf16 v[140:143], v[68:71], v[108:111], v[140:143]
    ds_read_b64_tr_b16 v[58:59], v4 offset:53248
    v_mfma_f32_16x16x32_bf16 v[144:147], v[72:75], v[96:99], v[144:147]
    ds_read_b64_tr_b16 v[60:61], v5 offset:49152
    v_mfma_f32_16x16x32_bf16 v[148:151], v[72:75], v[100:103], v[148:151]
    ds_read_b64_tr_b16 v[62:63], v5 offset:53248
    v_mfma_f32_16x16x32_bf16 v[152:155], v[72:75], v[104:107], v[152:155]
    ds_read_b64_tr_b16 v[20:21], v9 offset:49152
    v_mfma_f32_16x16x32_bf16 v[156:159], v[72:75], v[108:111], v[156:159]
    ds_read_b64_tr_b16 v[22:23], v9 offset:53248
    v_mfma_f32_16x16x32_bf16 v[160:163], v[76:79], v[96:99], v[160:163]
    ds_read_b64_tr_b16 v[24:25], v8 offset:57344
    v_mfma_f32_16x16x32_bf16 v[164:167], v[76:79], v[100:103], v[164:167]
    ds_read_b64_tr_b16 v[26:27], v8 offset:61440
    v_mfma_f32_16x16x32_bf16 v[168:171], v[76:79], v[104:107], v[168:171]
    ds_read_b64_tr_b16 v[28:29], v9 offset:57344
    v_mfma_f32_16x16x32_bf16 v[172:175], v[76:79], v[108:111], v[172:175]
    ds_read_b64_tr_b16 v[30:31], v9 offset:61440
    v_mfma_f32_16x16x32_bf16 v[176:179], v[80:83], v[96:99], v[176:179]
    ds_read_b64_tr_b16 v[32:33], v10 offset:49152
    v_mfma_f32_16x16x32_bf16 v[180:183], v[80:83], v[100:103], v[180:183]
    ds_read_b64_tr_b16 v[34:35], v10 offset:53248
    v_mfma_f32_16x16x32_bf16 v[184:187], v[80:83], v[104:107], v[184:187]
    ds_read_b64_tr_b16 v[36:37], v11 offset:49152
    v_mfma_f32_16x16x32_bf16 v[188:191], v[80:83], v[108:111], v[188:191]
    ds_read_b64_tr_b16 v[38:39], v11 offset:53248
    v_mfma_f32_16x16x32_bf16 v[192:195], v[84:87], v[96:99], v[192:195]
    ds_read_b64_tr_b16 v[40:41], v10 offset:57344
    v_mfma_f32_16x16x32_bf16 v[196:199], v[84:87], v[100:103], v[196:199]
    ds_read_b64_tr_b16 v[42:43], v10 offset:61440
    v_mfma_f32_16x16x32_bf16 v[200:203], v[84:87], v[104:107], v[200:203]
    ds_read_b64_tr_b16 v[44:45], v11 offset:57344
    v_mfma_f32_16x16x32_bf16 v[204:207], v[84:87], v[108:111], v[204:207]
    ds_read_b64_tr_b16 v[46:47], v11 offset:61440
    v_mfma_f32_16x16x32_bf16 v[208:211], v[88:91], v[96:99], v[208:211]
    v_mfma_f32_16x16x32_bf16 v[212:215], v[88:91], v[100:103], v[212:215]
    v_mfma_f32_16x16x32_bf16 v[216:219], v[88:91], v[104:107], v[216:219]
    v_mfma_f32_16x16x32_bf16 v[220:223], v[88:91], v[108:111], v[220:223]
    v_mfma_f32_16x16x32_bf16 v[224:227], v[92:95], v[96:99], v[224:227]
    v_mfma_f32_16x16x32_bf16 v[228:231], v[92:95], v[100:103], v[228:231]
    v_mfma_f32_16x16x32_bf16 v[232:235], v[92:95], v[104:107], v[232:235]
    s_waitcnt lgkmcnt(0)
    s_nop 0
    v_mfma_f32_16x16x32_bf16 v[236:239], v[92:95], v[108:111], v[236:239]
    s_barrier
    s_nop 0
    v_mfma_f32_16x16x32_bf16 v[112:115], v[16:19], v[48:51], v[112:115]
    ds_read_b64_tr_b16 v[64:65], v244 offset:0
    v_mfma_f32_16x16x32_bf16 v[116:119], v[16:19], v[52:55], v[116:119]
    ds_read_b64_tr_b16 v[66:67], v244 offset:4096
    v_mfma_f32_16x16x32_bf16 v[120:123], v[16:19], v[56:59], v[120:123]
    ds_read_b64_tr_b16 v[96:97], v240 offset:0
    v_mfma_f32_16x16x32_bf16 v[124:127], v[16:19], v[60:63], v[124:127]
    ds_read_b64_tr_b16 v[98:99], v240 offset:4096
    v_mfma_f32_16x16x32_bf16 v[128:131], v[20:23], v[48:51], v[128:131]
    ds_read_b64_tr_b16 v[100:101], v241 offset:0
    v_mfma_f32_16x16x32_bf16 v[132:135], v[20:23], v[52:55], v[132:135]
    ds_read_b64_tr_b16 v[102:103], v241 offset:4096
    v_mfma_f32_16x16x32_bf16 v[136:139], v[20:23], v[56:59], v[136:139]
    ds_read_b64_tr_b16 v[104:105], v242 offset:0
    v_mfma_f32_16x16x32_bf16 v[140:143], v[20:23], v[60:63], v[140:143]
    ds_read_b64_tr_b16 v[106:107], v242 offset:4096
    v_mfma_f32_16x16x32_bf16 v[144:147], v[24:27], v[48:51], v[144:147]
    ds_read_b64_tr_b16 v[108:109], v243 offset:0
    v_mfma_f32_16x16x32_bf16 v[148:151], v[24:27], v[52:55], v[148:151]
    ds_read_b64_tr_b16 v[110:111], v243 offset:4096
    v_mfma_f32_16x16x32_bf16 v[152:155], v[24:27], v[56:59], v[152:155]
    ds_read_b64_tr_b16 v[68:69], v245 offset:0
    v_mfma_f32_16x16x32_bf16 v[156:159], v[24:27], v[60:63], v[156:159]
    ds_read_b64_tr_b16 v[70:71], v245 offset:4096
    v_mfma_f32_16x16x32_bf16 v[160:163], v[28:31], v[48:51], v[160:163]
    ds_read_b64_tr_b16 v[72:73], v244 offset:8192
    v_mfma_f32_16x16x32_bf16 v[164:167], v[28:31], v[52:55], v[164:167]
    ds_read_b64_tr_b16 v[74:75], v244 offset:12288
    v_mfma_f32_16x16x32_bf16 v[168:171], v[28:31], v[56:59], v[168:171]
    ds_read_b64_tr_b16 v[76:77], v245 offset:8192
    v_mfma_f32_16x16x32_bf16 v[172:175], v[28:31], v[60:63], v[172:175]
    ds_read_b64_tr_b16 v[78:79], v245 offset:12288
    v_mfma_f32_16x16x32_bf16 v[176:179], v[32:35], v[48:51], v[176:179]
    ds_read_b64_tr_b16 v[80:81], v246 offset:0
    v_mfma_f32_16x16x32_bf16 v[180:183], v[32:35], v[52:55], v[180:183]
    ds_read_b64_tr_b16 v[82:83], v246 offset:4096
    v_mfma_f32_16x16x32_bf16 v[184:187], v[32:35], v[56:59], v[184:187]
    ds_read_b64_tr_b16 v[84:85], v247 offset:0
    v_mfma_f32_16x16x32_bf16 v[188:191], v[32:35], v[60:63], v[188:191]
    ds_read_b64_tr_b16 v[86:87], v247 offset:4096
    v_mfma_f32_16x16x32_bf16 v[192:195], v[36:39], v[48:51], v[192:195]
    ds_read_b64_tr_b16 v[88:89], v246 offset:8192
    v_mfma_f32_16x16x32_bf16 v[196:199], v[36:39], v[52:55], v[196:199]
    ds_read_b64_tr_b16 v[90:91], v246 offset:12288
    v_mfma_f32_16x16x32_bf16 v[200:203], v[36:39], v[56:59], v[200:203]
    ds_read_b64_tr_b16 v[92:93], v247 offset:8192
    v_mfma_f32_16x16x32_bf16 v[204:207], v[36:39], v[60:63], v[204:207]
    ds_read_b64_tr_b16 v[94:95], v247 offset:12288
    v_mfma_f32_16x16x32_bf16 v[208:211], v[40:43], v[48:51], v[208:211]
    v_mfma_f32_16x16x32_bf16 v[212:215], v[40:43], v[52:55], v[212:215]
    v_mfma_f32_16x16x32_bf16 v[216:219], v[40:43], v[56:59], v[216:219]
    v_mfma_f32_16x16x32_bf16 v[220:223], v[40:43], v[60:63], v[220:223]
    v_mfma_f32_16x16x32_bf16 v[224:227], v[44:47], v[48:51], v[224:227]
    v_mfma_f32_16x16x32_bf16 v[228:231], v[44:47], v[52:55], v[228:231]
    v_mfma_f32_16x16x32_bf16 v[232:235], v[44:47], v[56:59], v[232:235]
    s_waitcnt lgkmcnt(0)
    s_nop 0
    v_mfma_f32_16x16x32_bf16 v[236:239], v[44:47], v[60:63], v[236:239]
    s_barrier
    s_nop 0
    v_mfma_f32_16x16x32_bf16 v[112:115], v[64:67], v[96:99], v[112:115]
    ds_read_b64_tr_b16 v[16:17], v244 offset:24576
    v_mfma_f32_16x16x32_bf16 v[116:119], v[64:67], v[100:103], v[116:119]
    ds_read_b64_tr_b16 v[18:19], v244 offset:28672
    v_mfma_f32_16x16x32_bf16 v[120:123], v[64:67], v[104:107], v[120:123]
    ds_read_b64_tr_b16 v[48:49], v240 offset:24576
    v_mfma_f32_16x16x32_bf16 v[124:127], v[64:67], v[108:111], v[124:127]
    ds_read_b64_tr_b16 v[50:51], v240 offset:28672
    v_mfma_f32_16x16x32_bf16 v[128:131], v[68:71], v[96:99], v[128:131]
    ds_read_b64_tr_b16 v[52:53], v241 offset:24576
    v_mfma_f32_16x16x32_bf16 v[132:135], v[68:71], v[100:103], v[132:135]
    ds_read_b64_tr_b16 v[54:55], v241 offset:28672
    v_mfma_f32_16x16x32_bf16 v[136:139], v[68:71], v[104:107], v[136:139]
    ds_read_b64_tr_b16 v[56:57], v242 offset:24576
    v_mfma_f32_16x16x32_bf16 v[140:143], v[68:71], v[108:111], v[140:143]
    ds_read_b64_tr_b16 v[58:59], v242 offset:28672
    v_mfma_f32_16x16x32_bf16 v[144:147], v[72:75], v[96:99], v[144:147]
    ds_read_b64_tr_b16 v[60:61], v243 offset:24576
    v_mfma_f32_16x16x32_bf16 v[148:151], v[72:75], v[100:103], v[148:151]
    ds_read_b64_tr_b16 v[62:63], v243 offset:28672
    v_mfma_f32_16x16x32_bf16 v[152:155], v[72:75], v[104:107], v[152:155]
    ds_read_b64_tr_b16 v[20:21], v245 offset:24576
    v_mfma_f32_16x16x32_bf16 v[156:159], v[72:75], v[108:111], v[156:159]
    ds_read_b64_tr_b16 v[22:23], v245 offset:28672
    v_mfma_f32_16x16x32_bf16 v[160:163], v[76:79], v[96:99], v[160:163]
    ds_read_b64_tr_b16 v[24:25], v244 offset:32768
    v_mfma_f32_16x16x32_bf16 v[164:167], v[76:79], v[100:103], v[164:167]
    ds_read_b64_tr_b16 v[26:27], v244 offset:36864
    v_mfma_f32_16x16x32_bf16 v[168:171], v[76:79], v[104:107], v[168:171]
    ds_read_b64_tr_b16 v[28:29], v245 offset:32768
    v_mfma_f32_16x16x32_bf16 v[172:175], v[76:79], v[108:111], v[172:175]
    ds_read_b64_tr_b16 v[30:31], v245 offset:36864
    v_mfma_f32_16x16x32_bf16 v[176:179], v[80:83], v[96:99], v[176:179]
    ds_read_b64_tr_b16 v[32:33], v246 offset:24576
    v_mfma_f32_16x16x32_bf16 v[180:183], v[80:83], v[100:103], v[180:183]
    ds_read_b64_tr_b16 v[34:35], v246 offset:28672
    v_mfma_f32_16x16x32_bf16 v[184:187], v[80:83], v[104:107], v[184:187]
    ds_read_b64_tr_b16 v[36:37], v247 offset:24576
    v_mfma_f32_16x16x32_bf16 v[188:191], v[80:83], v[108:111], v[188:191]
    ds_read_b64_tr_b16 v[38:39], v247 offset:28672
    v_mfma_f32_16x16x32_bf16 v[192:195], v[84:87], v[96:99], v[192:195]
    ds_read_b64_tr_b16 v[40:41], v246 offset:32768
    v_mfma_f32_16x16x32_bf16 v[196:199], v[84:87], v[100:103], v[196:199]
    ds_read_b64_tr_b16 v[42:43], v246 offset:36864
    v_mfma_f32_16x16x32_bf16 v[200:203], v[84:87], v[104:107], v[200:203]
    ds_read_b64_tr_b16 v[44:45], v247 offset:32768
    v_mfma_f32_16x16x32_bf16 v[204:207], v[84:87], v[108:111], v[204:207]
    ds_read_b64_tr_b16 v[46:47], v247 offset:36864
    v_mfma_f32_16x16x32_bf16 v[208:211], v[88:91], v[96:99], v[208:211]
    v_mfma_f32_16x16x32_bf16 v[212:215], v[88:91], v[100:103], v[212:215]
    v_mfma_f32_16x16x32_bf16 v[216:219], v[88:91], v[104:107], v[216:219]
    v_mfma_f32_16x16x32_bf16 v[220:223], v[88:91], v[108:111], v[220:223]
    v_mfma_f32_16x16x32_bf16 v[224:227], v[92:95], v[96:99], v[224:227]
    v_mfma_f32_16x16x32_bf16 v[228:231], v[92:95], v[100:103], v[228:231]
    v_mfma_f32_16x16x32_bf16 v[232:235], v[92:95], v[104:107], v[232:235]
    s_waitcnt lgkmcnt(0)
    s_nop 0
    v_mfma_f32_16x16x32_bf16 v[236:239], v[92:95], v[108:111], v[236:239]
    s_barrier
    s_cbranch_scc1 F_C_LOOP
    v_mfma_f32_16x16x32_bf16 v[112:115], v[16:19], v[48:51], v[112:115]
    ds_read_b64_tr_b16 v[64:65], v244 offset:49152
    v_mfma_f32_16x16x32_bf16 v[116:119], v[16:19], v[52:55], v[116:119]
    ds_read_b64_tr_b16 v[66:67], v244 offset:53248
    v_mfma_f32_16x16x32_bf16 v[120:123], v[16:19], v[56:59], v[120:123]
    ds_read_b64_tr_b16 v[96:97], v240 offset:49152
    v_mfma_f32_16x16x32_bf16 v[124:127], v[16:19], v[60:63], v[124:127]
    ds_read_b64_tr_b16 v[98:99], v240 offset:53248
    v_mfma_f32_16x16x32_bf16 v[128:131], v[20:23], v[48:51], v[128:131]
    ds_read_b64_tr_b16 v[100:101], v241 offset:49152
    v_mfma_f32_16x16x32_bf16 v[132:135], v[20:23], v[52:55], v[132:135]
    ds_read_b64_tr_b16 v[102:103], v241 offset:53248
    v_mfma_f32_16x16x32_bf16 v[136:139], v[20:23], v[56:59], v[136:139]
    ds_read_b64_tr_b16 v[104:105], v242 offset:49152
    v_mfma_f32_16x16x32_bf16 v[140:143], v[20:23], v[60:63], v[140:143]
    ds_read_b64_tr_b16 v[106:107], v242 offset:53248
    v_mfma_f32_16x16x32_bf16 v[144:147], v[24:27], v[48:51], v[144:147]
    ds_read_b64_tr_b16 v[108:109], v243 offset:49152
    v_mfma_f32_16x16x32_bf16 v[148:151], v[24:27], v[52:55], v[148:151]
    ds_read_b64_tr_b16 v[110:111], v243 offset:53248
    v_mfma_f32_16x16x32_bf16 v[152:155], v[24:27], v[56:59], v[152:155]
    ds_read_b64_tr_b16 v[68:69], v245 offset:49152
    v_mfma_f32_16x16x32_bf16 v[156:159], v[24:27], v[60:63], v[156:159]
    ds_read_b64_tr_b16 v[70:71], v245 offset:53248
    v_mfma_f32_16x16x32_bf16 v[160:163], v[28:31], v[48:51], v[160:163]
    ds_read_b64_tr_b16 v[72:73], v244 offset:57344
    v_mfma_f32_16x16x32_bf16 v[164:167], v[28:31], v[52:55], v[164:167]
    ds_read_b64_tr_b16 v[74:75], v244 offset:61440
    v_mfma_f32_16x16x32_bf16 v[168:171], v[28:31], v[56:59], v[168:171]
    ds_read_b64_tr_b16 v[76:77], v245 offset:57344
    v_mfma_f32_16x16x32_bf16 v[172:175], v[28:31], v[60:63], v[172:175]
    ds_read_b64_tr_b16 v[78:79], v245 offset:61440
    v_mfma_f32_16x16x32_bf16 v[176:179], v[32:35], v[48:51], v[176:179]
    ds_read_b64_tr_b16 v[80:81], v246 offset:49152
    v_mfma_f32_16x16x32_bf16 v[180:183], v[32:35], v[52:55], v[180:183]
    ds_read_b64_tr_b16 v[82:83], v246 offset:53248
    v_mfma_f32_16x16x32_bf16 v[184:187], v[32:35], v[56:59], v[184:187]
    ds_read_b64_tr_b16 v[84:85], v247 offset:49152
    v_mfma_f32_16x16x32_bf16 v[188:191], v[32:35], v[60:63], v[188:191]
    ds_read_b64_tr_b16 v[86:87], v247 offset:53248
    v_mfma_f32_16x16x32_bf16 v[192:195], v[36:39], v[48:51], v[192:195]
    ds_read_b64_tr_b16 v[88:89], v246 offset:57344
    v_mfma_f32_16x16x32_bf16 v[196:199], v[36:39], v[52:55], v[196:199]
    ds_read_b64_tr_b16 v[90:91], v246 offset:61440
    v_mfma_f32_16x16x32_bf16 v[200:203], v[36:39], v[56:59], v[200:203]
    ds_read_b64_tr_b16 v[92:93], v247 offset:57344
    v_mfma_f32_16x16x32_bf16 v[204:207], v[36:39], v[60:63], v[204:207]
    ds_read_b64_tr_b16 v[94:95], v247 offset:61440
    v_mfma_f32_16x16x32_bf16 v[208:211], v[40:43], v[48:51], v[208:211]
    v_mfma_f32_16x16x32_bf16 v[212:215], v[40:43], v[52:55], v[212:215]
    v_mfma_f32_16x16x32_bf16 v[216:219], v[40:43], v[56:59], v[216:219]
    v_mfma_f32_16x16x32_bf16 v[220:223], v[40:43], v[60:63], v[220:223]
    v_mfma_f32_16x16x32_bf16 v[224:227], v[44:47], v[48:51], v[224:227]
    v_mfma_f32_16x16x32_bf16 v[228:231], v[44:47], v[52:55], v[228:231]
    v_mfma_f32_16x16x32_bf16 v[232:235], v[44:47], v[56:59], v[232:235]
    s_waitcnt lgkmcnt(0)
    s_nop 0
    v_mfma_f32_16x16x32_bf16 v[236:239], v[44:47], v[60:63], v[236:239]
    s_barrier
    s_nop 0
    v_mfma_f32_16x16x32_bf16 v[112:115], v[64:67], v[96:99], v[112:115]
    ds_read_b64_tr_b16 v[16:17], v8 offset:0
    v_mfma_f32_16x16x32_bf16 v[116:119], v[64:67], v[100:103], v[116:119]
    ds_read_b64_tr_b16 v[18:19], v8 offset:4096
    v_mfma_f32_16x16x32_bf16 v[120:123], v[64:67], v[104:107], v[120:123]
    ds_read_b64_tr_b16 v[48:49], v2 offset:0
    v_mfma_f32_16x16x32_bf16 v[124:127], v[64:67], v[108:111], v[124:127]
    ds_read_b64_tr_b16 v[50:51], v2 offset:4096
    v_mfma_f32_16x16x32_bf16 v[128:131], v[68:71], v[96:99], v[128:131]
    ds_read_b64_tr_b16 v[52:53], v3 offset:0
    v_mfma_f32_16x16x32_bf16 v[132:135], v[68:71], v[100:103], v[132:135]
    ds_read_b64_tr_b16 v[54:55], v3 offset:4096
    v_mfma_f32_16x16x32_bf16 v[136:139], v[68:71], v[104:107], v[136:139]
    ds_read_b64_tr_b16 v[56:57], v4 offset:0
    v_mfma_f32_16x16x32_bf16 v[140:143], v[68:71], v[108:111], v[140:143]
    ds_read_b64_tr_b16 v[58:59], v4 offset:4096
    v_mfma_f32_16x16x32_bf16 v[144:147], v[72:75], v[96:99], v[144:147]
    ds_read_b64_tr_b16 v[60:61], v5 offset:0
    v_mfma_f32_16x16x32_bf16 v[148:151], v[72:75], v[100:103], v[148:151]
    ds_read_b64_tr_b16 v[62:63], v5 offset:4096
    v_mfma_f32_16x16x32_bf16 v[152:155], v[72:75], v[104:107], v[152:155]
    ds_read_b64_tr_b16 v[20:21], v9 offset:0
    v_mfma_f32_16x16x32_bf16 v[156:159], v[72:75], v[108:111], v[156:159]
    ds_read_b64_tr_b16 v[22:23], v9 offset:4096
    v_mfma_f32_16x16x32_bf16 v[160:163], v[76:79], v[96:99], v[160:163]
    ds_read_b64_tr_b16 v[24:25], v8 offset:8192
    v_mfma_f32_16x16x32_bf16 v[164:167], v[76:79], v[100:103], v[164:167]
    ds_read_b64_tr_b16 v[26:27], v8 offset:12288
    v_mfma_f32_16x16x32_bf16 v[168:171], v[76:79], v[104:107], v[168:171]
    ds_read_b64_tr_b16 v[28:29], v9 offset:8192
    v_mfma_f32_16x16x32_bf16 v[172:175], v[76:79], v[108:111], v[172:175]
    ds_read_b64_tr_b16 v[30:31], v9 offset:12288
    v_mfma_f32_16x16x32_bf16 v[176:179], v[80:83], v[96:99], v[176:179]
    ds_read_b64_tr_b16 v[32:33], v10 offset:0
    v_mfma_f32_16x16x32_bf16 v[180:183], v[80:83], v[100:103], v[180:183]
    ds_read_b64_tr_b16 v[34:35], v10 offset:4096
    v_mfma_f32_16x16x32_bf16 v[184:187], v[80:83], v[104:107], v[184:187]
    ds_read_b64_tr_b16 v[36:37], v11 offset:0
    v_mfma_f32_16x16x32_bf16 v[188:191], v[80:83], v[108:111], v[188:191]
    ds_read_b64_tr_b16 v[38:39], v11 offset:4096
    v_mfma_f32_16x16x32_bf16 v[192:195], v[84:87], v[96:99], v[192:195]
    ds_read_b64_tr_b16 v[40:41], v10 offset:8192
    v_mfma_f32_16x16x32_bf16 v[196:199], v[84:87], v[100:103], v[196:199]
    ds_read_b64_tr_b16 v[42:43], v10 offset:12288
    v_mfma_f32_16x16x32_bf16 v[200:203], v[84:87], v[104:107], v[200:203]
    ds_read_b64_tr_b16 v[44:45], v11 offset:8192
    v_mfma_f32_16x16x32_bf16 v[204:207], v[84:87], v[108:111], v[204:207]
    ds_read_b64_tr_b16 v[46:47], v11 offset:12288
    v_mfma_f32_16x16x32_bf16 v[208:211], v[88:91], v[96:99], v[208:211]
    v_mfma_f32_16x16x32_bf16 v[212:215], v[88:91], v[100:103], v[212:215]
    v_mfma_f32_16x16x32_bf16 v[216:219], v[88:91], v[104:107], v[216:219]
    v_mfma_f32_16x16x32_bf16 v[220:223], v[88:91], v[108:111], v[220:223]
    v_mfma_f32_16x16x32_bf16 v[224:227], v[92:95], v[96:99], v[224:227]
    v_mfma_f32_16x16x32_bf16 v[228:231], v[92:95], v[100:103], v[228:231]
    v_mfma_f32_16x16x32_bf16 v[232:235], v[92:95], v[104:107], v[232:235]
    s_waitcnt lgkmcnt(0)
    s_nop 0
    v_mfma_f32_16x16x32_bf16 v[236:239], v[92:95], v[108:111], v[236:239]
    s_barrier
    s_nop 0
    v_mfma_f32_16x16x32_bf16 v[112:115], v[16:19], v[48:51], v[112:115]
    ds_read2_b32 v[248:249], v15 offset0:0 offset1:16
    ds_read_b64_tr_b16 v[64:65], v8 offset:24576
    v_mfma_f32_16x16x32_bf16 v[116:119], v[16:19], v[52:55], v[116:119]
    ds_read2_b32 v[250:251], v15 offset0:32 offset1:48
    ds_read_b64_tr_b16 v[66:67], v8 offset:28672
    v_mfma_f32_16x16x32_bf16 v[120:123], v[16:19], v[56:59], v[120:123]
    ds_read_b64 v[12:13], v14 offset:0
    ds_read_b64_tr_b16 v[96:97], v2 offset:24576
    v_mfma_f32_16x16x32_bf16 v[124:127], v[16:19], v[60:63], v[124:127]
    ds_read_b64 v[252:253], v14 offset:8
    ds_read_b64_tr_b16 v[98:99], v2 offset:28672
    v_mfma_f32_16x16x32_bf16 v[128:131], v[20:23], v[48:51], v[128:131]
    ds_read_b64_tr_b16 v[100:101], v3 offset:24576
    v_mfma_f32_16x16x32_bf16 v[132:135], v[20:23], v[52:55], v[132:135]
    ds_read_b64_tr_b16 v[102:103], v3 offset:28672
    v_mfma_f32_16x16x32_bf16 v[136:139], v[20:23], v[56:59], v[136:139]
    ds_read_b64_tr_b16 v[104:105], v4 offset:24576
    v_mfma_f32_16x16x32_bf16 v[140:143], v[20:23], v[60:63], v[140:143]
    ds_read_b64_tr_b16 v[106:107], v4 offset:28672
    v_mfma_f32_16x16x32_bf16 v[144:147], v[24:27], v[48:51], v[144:147]
    ds_read_b64_tr_b16 v[108:109], v5 offset:24576
    v_mfma_f32_16x16x32_bf16 v[148:151], v[24:27], v[52:55], v[148:151]
    ds_read_b64_tr_b16 v[110:111], v5 offset:28672
    v_mfma_f32_16x16x32_bf16 v[152:155], v[24:27], v[56:59], v[152:155]
    ds_read_b64_tr_b16 v[68:69], v9 offset:24576
    v_mfma_f32_16x16x32_bf16 v[156:159], v[24:27], v[60:63], v[156:159]
    ds_read_b64_tr_b16 v[70:71], v9 offset:28672
    v_mfma_f32_16x16x32_bf16 v[160:163], v[28:31], v[48:51], v[160:163]
    ds_read_b64_tr_b16 v[72:73], v8 offset:32768
    v_mfma_f32_16x16x32_bf16 v[164:167], v[28:31], v[52:55], v[164:167]
    ds_read_b64_tr_b16 v[74:75], v8 offset:36864
    v_mfma_f32_16x16x32_bf16 v[168:171], v[28:31], v[56:59], v[168:171]
    ds_read_b64_tr_b16 v[76:77], v9 offset:32768
    v_mfma_f32_16x16x32_bf16 v[172:175], v[28:31], v[60:63], v[172:175]
    ds_read_b64_tr_b16 v[78:79], v9 offset:36864
    v_mfma_f32_16x16x32_bf16 v[176:179], v[32:35], v[48:51], v[176:179]
    ds_read_b64_tr_b16 v[80:81], v10 offset:24576
    v_mfma_f32_16x16x32_bf16 v[180:183], v[32:35], v[52:55], v[180:183]
    ds_read_b64_tr_b16 v[82:83], v10 offset:28672
    v_mfma_f32_16x16x32_bf16 v[184:187], v[32:35], v[56:59], v[184:187]
    ds_read_b64_tr_b16 v[84:85], v11 offset:24576
    v_mfma_f32_16x16x32_bf16 v[188:191], v[32:35], v[60:63], v[188:191]
    ds_read_b64_tr_b16 v[86:87], v11 offset:28672
    v_mfma_f32_16x16x32_bf16 v[192:195], v[36:39], v[48:51], v[192:195]
    ds_read_b64_tr_b16 v[88:89], v10 offset:32768
    v_mfma_f32_16x16x32_bf16 v[196:199], v[36:39], v[52:55], v[196:199]
    ds_read_b64_tr_b16 v[90:91], v10 offset:36864
    v_mfma_f32_16x16x32_bf16 v[200:203], v[36:39], v[56:59], v[200:203]
    ds_read_b64_tr_b16 v[92:93], v11 offset:32768
    v_mfma_f32_16x16x32_bf16 v[204:207], v[36:39], v[60:63], v[204:207]
    ds_read_b64_tr_b16 v[94:95], v11 offset:36864
    s_waitcnt lgkmcnt(15)
    s_nop 0
    v_mfma_f32_16x16x32_bf16 v[208:211], v[40:43], v[48:51], v[208:211]
    v_fmac_f32 v112, v12, v248
    v_fmac_f32 v113, v13, v248
    v_mfma_f32_16x16x32_bf16 v[212:215], v[40:43], v[52:55], v[212:215]
    v_fmac_f32 v114, v252, v248
    v_fmac_f32 v115, v253, v248
    v_mfma_f32_16x16x32_bf16 v[216:219], v[40:43], v[56:59], v[216:219]
    v_fmac_f32 v116, v12, v249
    v_fmac_f32 v117, v13, v249
    v_mfma_f32_16x16x32_bf16 v[220:223], v[40:43], v[60:63], v[220:223]
    v_fmac_f32 v118, v252, v249
    v_fmac_f32 v119, v253, v249
    v_mfma_f32_16x16x32_bf16 v[224:227], v[44:47], v[48:51], v[224:227]
    v_fmac_f32 v120, v12, v250
    v_fmac_f32 v121, v13, v250
    v_mfma_f32_16x16x32_bf16 v[228:231], v[44:47], v[52:55], v[228:231]
    v_fmac_f32 v122, v252, v250
    v_fmac_f32 v123, v253, v250
    v_mfma_f32_16x16x32_bf16 v[232:235], v[44:47], v[56:59], v[232:235]
    v_fmac_f32 v124, v12, v251
    v_fmac_f32 v125, v13, v251
    s_waitcnt lgkmcnt(0)
    s_nop 0
    v_mfma_f32_16x16x32_bf16 v[236:239], v[44:47], v[60:63], v[236:239]
    v_fmac_f32 v126, v252, v251
    v_fmac_f32 v127, v253, v251
    s_barrier
    s_nop 0
    v_mfma_f32_16x16x32_bf16 v[112:115], v[64:67], v[96:99], v[112:115]
    ds_read_b128 v[32:35], v14 offset:64
    ds_read_b64_tr_b16 v[16:17], v8 offset:49152
    v_mfma_f32_16x16x32_bf16 v[116:119], v[64:67], v[100:103], v[116:119]
    ds_read_b128 v[36:39], v14 offset:512
    ds_read_b64_tr_b16 v[18:19], v8 offset:53248
    v_mfma_f32_16x16x32_bf16 v[120:123], v[64:67], v[104:107], v[120:123]
    ds_read_b128 v[40:43], v14 offset:576
    ds_read_b64_tr_b16 v[48:49], v2 offset:49152
    v_mfma_f32_16x16x32_bf16 v[124:127], v[64:67], v[108:111], v[124:127]
    ds_read_b64_tr_b16 v[50:51], v2 offset:53248
    v_mfma_f32_16x16x32_bf16 v[128:131], v[68:71], v[96:99], v[128:131]
    ds_read_b64_tr_b16 v[52:53], v3 offset:49152
    v_mfma_f32_16x16x32_bf16 v[132:135], v[68:71], v[100:103], v[132:135]
    ds_read_b64_tr_b16 v[54:55], v3 offset:53248
    v_mfma_f32_16x16x32_bf16 v[136:139], v[68:71], v[104:107], v[136:139]
    ds_read_b64_tr_b16 v[56:57], v4 offset:49152
    v_mfma_f32_16x16x32_bf16 v[140:143], v[68:71], v[108:111], v[140:143]
PADB5:
    s_cbranch_execz PADB6
    s_nop 0
    ds_read_b64_tr_b16 v[58:59], v4 offset:53248
    v_mfma_f32_16x16x32_bf16 v[144:147], v[72:75], v[96:99], v[144:147]
    ds_read_b64_tr_b16 v[60:61], v5 offset:49152
    v_mfma_f32_16x16x32_bf16 v[148:151], v[72:75], v[100:103], v[148:151]
    ds_read_b64_tr_b16 v[62:63], v5 offset:53248
    v_mfma_f32_16x16x32_bf16 v[152:155], v[72:75], v[104:107], v[152:155]
    ds_read_b64_tr_b16 v[20:21], v9 offset:49152
    v_mfma_f32_16x16x32_bf16 v[156:159], v[72:75], v[108:111], v[156:159]
    ds_read_b64_tr_b16 v[22:23], v9 offset:53248
    s_waitcnt lgkmcnt(10)
    s_nop 0
    v_mfma_f32_16x16x32_bf16 v[160:163], v[76:79], v[96:99], v[160:163]
    ds_read_b64_tr_b16 v[24:25], v8 offset:57344
    v_fma_f32 v128, v32, v248, v128
    v_mfma_f32_16x16x32_bf16 v[164:167], v[76:79], v[100:103], v[164:167]
    ds_read_b64_tr_b16 v[26:27], v8 offset:61440
    v_fma_f32 v129, v33, v248, v129
    v_mfma_f32_16x16x32_bf16 v[168:171], v[76:79], v[104:107], v[168:171]
    ds_read_b64_tr_b16 v[28:29], v9 offset:57344
    v_fma_f32 v130, v34, v248, v130
    v_mfma_f32_16x16x32_bf16 v[172:175], v[76:79], v[108:111], v[172:175]
    ds_read_b64_tr_b16 v[30:31], v9 offset:61440
    v_fma_f32 v131, v35, v248, v131
    v_mfma_f32_16x16x32_bf16 v[176:179], v[80:83], v[96:99], v[176:179]
    v_fmac_f32 v132, v32, v249
    v_fmac_f32 v133, v33, v249
    v_mfma_f32_16x16x32_bf16 v[180:183], v[80:83], v[100:103], v[180:183]
    v_fma_f32 v134, v34, v249, v134
    v_fmac_f32 v135, v35, v249
    v_fmac_f32 v136, v32, v250
    v_mfma_f32_16x16x32_bf16 v[184:187], v[80:83], v[104:107], v[184:187]
    v_fma_f32 v137, v33, v250, v137
    v_fmac_f32 v138, v34, v250
    v_fmac_f32 v139, v35, v250
    v_mfma_f32_16x16x32_bf16 v[188:191], v[80:83], v[108:111], v[188:191]
    v_fma_f32 v140, v32, v251, v140
    v_fmac_f32 v141, v33, v251
    v_fmac_f32 v142, v34, v251
    v_mfma_f32_16x16x32_bf16 v[192:195], v[84:87], v[96:99], v[192:195]
    v_fmac_f32 v143, v35, v251
    v_fmac_f32 v144, v36, v248
    v_mfma_f32_16x16x32_bf16 v[196:199], v[84:87], v[100:103], v[196:199]
    v_fma_f32 v145, v37, v248, v145
    v_fmac_f32 v146, v38, v248
    v_fmac_f32 v147, v39, v248
    v_mfma_f32_16x16x32_bf16 v[200:203], v[84:87], v[104:107], v[200:203]
    v_fma_f32 v148, v36, v249, v148
    v_fmac_f32 v149, v37, v249
    v_fmac_f32 v150, v38, v249
    v_mfma_f32_16x16x32_bf16 v[204:207], v[84:87], v[108:111], v[204:207]
    v_fma_f32 v151, v39, v249, v151
    v_fmac_f32 v152, v36, v250
    v_fmac_f32 v153, v37, v250
    v_mfma_f32_16x16x32_bf16 v[208:211], v[88:91], v[96:99], v[208:211]
    v_fmac_f32 v154, v38, v250
    v_fmac_f32 v155, v39, v250
    v_mfma_f32_16x16x32_bf16 v[212:215], v[88:91], v[100:103], v[212:215]
    v_fma_f32 v156, v36, v251, v156
    v_fmac_f32 v157, v37, v251
    v_fmac_f32 v158, v38, v251
    v_mfma_f32_16x16x32_bf16 v[216:219], v[88:91], v[104:107], v[216:219]
    v_fma_f32 v159, v39, v251, v159
    v_fmac_f32 v160, v40, v248
    v_fmac_f32 v161, v41, v248
    v_mfma_f32_16x16x32_bf16 v[220:223], v[88:91], v[108:111], v[220:223]
    v_fma_f32 v162, v42, v248, v162
    v_fmac_f32 v163, v43, v248
    v_fmac_f32 v164, v40, v249
    v_mfma_f32_16x16x32_bf16 v[224:227], v[92:95], v[96:99], v[224:227]
    v_fmac_f32 v165, v41, v249
    v_fmac_f32 v166, v42, v249
    v_mfma_f32_16x16x32_bf16 v[228:231], v[92:95], v[100:103], v[228:231]
    v_fma_f32 v167, v43, v249, v167
    v_fmac_f32 v168, v40, v250
    v_fmac_f32 v169, v41, v250
    v_mfma_f32_16x16x32_bf16 v[232:235], v[92:95], v[104:107], v[232:235]
    v_fma_f32 v170, v42, v250, v170
    v_fmac_f32 v171, v43, v250
    v_fmac_f32 v172, v40, v251
    s_waitcnt lgkmcnt(0)
    s_nop 0
    v_mfma_f32_16x16x32_bf16 v[236:239], v[92:95], v[108:111], v[236:239]
    v_fma_f32 v173, v41, v251, v173
    v_fmac_f32 v174, v42, v251
    v_fmac_f32 v175, v43, v251
    v_mfma_f32_16x16x32_bf16 v[112:115], v[16:19], v[48:51], v[112:115]
    ds_read_b128 v[80:83], v14 offset:128
    ds_read_b64_tr_b16 v[64:65], v244 offset:0
    v_mfma_f32_16x16x32_bf16 v[116:119], v[16:19], v[52:55], v[116:119]
    ds_read_b128 v[84:87], v14 offset:192
    ds_read_b64_tr_b16 v[66:67], v244 offset:4096
    v_mfma_f32_16x16x32_bf16 v[120:123], v[16:19], v[56:59], v[120:123]
    ds_read_b128 v[88:91], v14 offset:640
    ds_read_b64_tr_b16 v[96:97], v240 offset:0
    v_mfma_f32_16x16x32_bf16 v[124:127], v[16:19], v[60:63], v[124:127]
    ds_read_b128 v[92:95], v14 offset:704
    ds_read_b64_tr_b16 v[98:99], v240 offset:4096
    v_mfma_f32_16x16x32_bf16 v[128:131], v[20:23], v[48:51], v[128:131]
    ds_read_b64_tr_b16 v[100:101], v241 offset:0
    v_mfma_f32_16x16x32_bf16 v[132:135], v[20:23], v[52:55], v[132:135]
    ds_read_b64_tr_b16 v[102:103], v241 offset:4096
    v_mfma_f32_16x16x32_bf16 v[136:139], v[20:23], v[56:59], v[136:139]
    ds_read_b64_tr_b16 v[104:105], v242 offset:0
    v_mfma_f32_16x16x32_bf16 v[140:143], v[20:23], v[60:63], v[140:143]
    ds_read_b64_tr_b16 v[106:107], v242 offset:4096
    s_waitcnt lgkmcnt(5)
    s_nop 0
    v_mfma_f32_16x16x32_bf16 v[144:147], v[24:27], v[48:51], v[144:147]
    ds_read_b64_tr_b16 v[108:109], v243 offset:0
    v_fma_f32 v176, v80, v248, v176
    v_mfma_f32_16x16x32_bf16 v[148:151], v[24:27], v[52:55], v[148:151]
    ds_read_b64_tr_b16 v[110:111], v243 offset:4096
    v_fma_f32 v177, v81, v248, v177
    v_mfma_f32_16x16x32_bf16 v[152:155], v[24:27], v[56:59], v[152:155]
    ds_read_b64_tr_b16 v[68:69], v245 offset:0
    v_fma_f32 v178, v82, v248, v178
    v_mfma_f32_16x16x32_bf16 v[156:159], v[24:27], v[60:63], v[156:159]
    ds_read_b64_tr_b16 v[70:71], v245 offset:4096
    v_fma_f32 v179, v83, v248, v179
    v_mfma_f32_16x16x32_bf16 v[160:163], v[28:31], v[48:51], v[160:163]
    ds_read_b64_tr_b16 v[72:73], v244 offset:8192
    v_fma_f32 v180, v80, v249, v180
    v_mfma_f32_16x16x32_bf16 v[164:167], v[28:31], v[52:55], v[164:167]
    ds_read_b64_tr_b16 v[74:75], v244 offset:12288
    v_fma_f32 v181, v81, v249, v181
    v_mfma_f32_16x16x32_bf16 v[168:171], v[28:31], v[56:59], v[168:171]
    ds_read_b64_tr_b16 v[76:77], v245 offset:8192
    v_fma_f32 v182, v82, v249, v182
    v_mfma_f32_16x16x32_bf16 v[172:175], v[28:31], v[60:63], v[172:175]
    ds_read_b64_tr_b16 v[78:79], v245 offset:12288
    v_fmac_f32 v183, v83, v249
    s_waitcnt lgkmcnt(6)
    v_mfma_f32_16x16x32_bf16 v[112:115], v[64:67], v[96:99], v[112:115]
    ds_read_b64_tr_b16 v[16:17], v244 offset:24576
    v_fma_f32 v184, v80, v250, v184
    v_mfma_f32_16x16x32_bf16 v[116:119], v[64:67], v[100:103], v[116:119]
    ds_read_b64_tr_b16 v[18:19], v244 offset:28672
    v_fmac_f32 v185, v81, v250
    v_fmac_f32 v186, v82, v250
    v_mfma_f32_16x16x32_bf16 v[120:123], v[64:67], v[104:107], v[120:123]
    ds_read_b64_tr_b16 v[48:49], v240 offset:24576
    v_fma_f32 v187, v83, v250, v187
    v_mfma_f32_16x16x32_bf16 v[124:127], v[64:67], v[108:111], v[124:127]
    ds_read_b64_tr_b16 v[50:51], v240 offset:28672
    v_fmac_f32 v188, v80, v251
    s_waitcnt lgkmcnt(8)
    v_mfma_f32_16x16x32_bf16 v[128:131], v[68:71], v[96:99], v[128:131]
    ds_read_b64_tr_b16 v[52:53], v241 offset:24576
    v_fma_f32 v189, v81, v251, v189
    v_mfma_f32_16x16x32_bf16 v[132:135], v[68:71], v[100:103], v[132:135]
    ds_read_b64_tr_b16 v[54:55], v241 offset:28672
    v_fmac_f32 v190, v82, v251
    v_fmac_f32 v191, v83, v251
    v_mfma_f32_16x16x32_bf16 v[136:139], v[68:71], v[104:107], v[136:139]
    ds_read_b64_tr_b16 v[56:57], v242 offset:24576
    v_fma_f32 v192, v84, v248, v192
    v_mfma_f32_16x16x32_bf16 v[140:143], v[68:71], v[108:111], v[140:143]
    ds_read_b64_tr_b16 v[58:59], v242 offset:28672
    v_fmac_f32 v193, v85, v248
    s_waitcnt lgkmcnt(10)
    v_mfma_f32_16x16x32_bf16 v[144:147], v[72:75], v[96:99], v[144:147]
    ds_read_b64_tr_b16 v[60:61], v243 offset:24576
    v_fma_f32 v194, v86, v248, v194
    v_mfma_f32_16x16x32_bf16 v[148:151], v[72:75], v[100:103], v[148:151]
    ds_read_b64_tr_b16 v[62:63], v243 offset:28672
    v_fmac_f32 v195, v87, v248
    v_fmac_f32 v196, v84, v249
    v_mfma_f32_16x16x32_bf16 v[152:155], v[72:75], v[104:107], v[152:155]
    ds_read_b64_tr_b16 v[20:21], v245 offset:24576
    v_fma_f32 v197, v85, v249, v197
    v_mfma_f32_16x16x32_bf16 v[156:159], v[72:75], v[108:111], v[156:159]
    ds_read_b64_tr_b16 v[22:23], v245 offset:28672
    v_fmac_f32 v198, v86, v249
    s_waitcnt lgkmcnt(12)
    v_mfma_f32_16x16x32_bf16 v[160:163], v[76:79], v[96:99], v[160:163]
    ds_read_b64_tr_b16 v[24:25], v244 offset:32768
    v_fma_f32 v199, v87, v249, v199
    v_mfma_f32_16x16x32_bf16 v[164:167], v[76:79], v[100:103], v[164:167]
    ds_read_b64_tr_b16 v[26:27], v244 offset:36864
    v_fmac_f32 v200, v84, v250
    v_fmac_f32 v201, v85, v250
    v_mfma_f32_16x16x32_bf16 v[168:171], v[76:79], v[104:107], v[168:171]
    ds_read_b64_tr_b16 v[28:29], v245 offset:32768
    v_fma_f32 v202, v86, v250, v202
    v_mfma_f32_16x16x32_bf16 v[172:175], v[76:79], v[108:111], v[172:175]
    ds_read_b64_tr_b16 v[30:31], v245 offset:36864
    v_fmac_f32 v203, v87, v250
    s_waitcnt lgkmcnt(6)
    v_mfma_f32_16x16x32_bf16 v[112:115], v[16:19], v[48:51], v[112:115]
    ds_read_b64_tr_b16 v[64:65], v244 offset:49152
    v_fma_f32 v204, v84, v251, v204
    v_mfma_f32_16x16x32_bf16 v[116:119], v[16:19], v[52:55], v[116:119]
    ds_read_b64_tr_b16 v[66:67], v244 offset:53248
    v_fmac_f32 v205, v85, v251
    v_fmac_f32 v206, v86, v251
    v_mfma_f32_16x16x32_bf16 v[120:123], v[16:19], v[56:59], v[120:123]
    ds_read_b64_tr_b16 v[96:97], v240 offset:49152
    v_fma_f32 v207, v87, v251, v207
    v_mfma_f32_16x16x32_bf16 v[124:127], v[16:19], v[60:63], v[124:127]
    ds_read_b64_tr_b16 v[98:99], v240 offset:53248
    v_fmac_f32 v208, v88, v248
    s_waitcnt lgkmcnt(8)
    v_mfma_f32_16x16x32_bf16 v[128:131], v[20:23], v[48:51], v[128:131]
    ds_read_b64_tr_b16 v[100:101], v241 offset:49152
    v_fma_f32 v209, v89, v248, v209
    v_mfma_f32_16x16x32_bf16 v[132:135], v[20:23], v[52:55], v[132:135]
    ds_read_b64_tr_b16 v[102:103], v241 offset:53248
    v_fmac_f32 v210, v90, v248
    v_fmac_f32 v211, v91, v248
    v_mfma_f32_16x16x32_bf16 v[136:139], v[20:23], v[56:59], v[136:139]
    ds_read_b64_tr_b16 v[104:105], v242 offset:49152
    v_fma_f32 v212, v88, v249, v212
    v_mfma_f32_16x16x32_bf16 v[140:143], v[20:23], v[60:63], v[140:143]
    ds_read_b64_tr_b16 v[106:107], v242 offset:53248
    v_fmac_f32 v213, v89, v249
    s_waitcnt lgkmcnt(10)
    v_mfma_f32_16x16x32_bf16 v[144:147], v[24:27], v[48:51], v[144:147]
    ds_read_b64_tr_b16 v[108:109], v243 offset:49152
    v_fma_f32 v214, v90, v249, v214
    v_mfma_f32_16x16x32_bf16 v[148:151], v[24:27], v[52:55], v[148:151]
    ds_read_b64_tr_b16 v[110:111], v243 offset:53248
    v_fmac_f32 v215, v91, v249
    v_fmac_f32 v216, v88, v250
    v_mfma_f32_16x16x32_bf16 v[152:155], v[24:27], v[56:59], v[152:155]
    ds_read_b64_tr_b16 v[68:69], v245 offset:49152
    v_fma_f32 v217, v89, v250, v217
    v_mfma_f32_16x16x32_bf16 v[156:159], v[24:27], v[60:63], v[156:159]
    ds_read_b64_tr_b16 v[70:71], v245 offset:53248
    v_fmac_f32 v218, v90, v250
    s_waitcnt lgkmcnt(12)
    v_mfma_f32_16x16x32_bf16 v[160:163], v[28:31], v[48:51], v[160:163]
    ds_read_b64_tr_b16 v[72:73], v244 offset:57344
    v_fma_f32 v219, v91, v250, v219
    v_mfma_f32_16x16x32_bf16 v[164:167], v[28:31], v[52:55], v[164:167]
    ds_read_b64_tr_b16 v[74:75], v244 offset:61440
    v_fmac_f32 v220, v88, v251
    v_fmac_f32 v221, v89, v251
    v_mfma_f32_16x16x32_bf16 v[168:171], v[28:31], v[56:59], v[168:171]
    ds_read_b64_tr_b16 v[76:77], v245 offset:57344
    v_fma_f32 v222, v90, v251, v222
    v_mfma_f32_16x16x32_bf16 v[172:175], v[28:31], v[60:63], v[172:175]
    ds_read_b64_tr_b16 v[78:79], v245 offset:61440
    v_fmac_f32 v223, v91, v251
    s_waitcnt lgkmcnt(6)
    v_mfma_f32_16x16x32_bf16 v[112:115], v[64:67], v[96:99], v[112:115]
    ds_read_b64_tr_b16 v[16:17], v10 offset:49152
    v_fma_f32 v224, v92, v248, v224
    v_mfma_f32_16x16x32_bf16 v[116:119], v[64:67], v[100:103], v[116:119]
    ds_read_b64_tr_b16 v[18:19], v10 offset:53248
    v_fmac_f32 v225, v93, v248
    v_fmac_f32 v226, v94, v248
    v_mfma_f32_16x16x32_bf16 v[120:123], v[64:67], v[104:107], v[120:123]
    ds_read_b64_tr_b16 v[48:49], v2 offset:49152
    v_fma_f32 v227, v95, v248, v227
    v_mfma_f32_16x16x32_bf16 v[124:127], v[64:67], v[108:111], v[124:127]
    ds_read_b64_tr_b16 v[50:51], v2 offset:53248
    v_fmac_f32 v228, v92, v249
    s_waitcnt lgkmcnt(8)
    v_mfma_f32_16x16x32_bf16 v[128:131], v[68:71], v[96:99], v[128:131]
    ds_read_b64_tr_b16 v[52:53], v3 offset:49152
    v_fma_f32 v229, v93, v249, v229
    v_mfma_f32_16x16x32_bf16 v[132:135], v[68:71], v[100:103], v[132:135]
    ds_read_b64_tr_b16 v[54:55], v3 offset:53248
    v_fmac_f32 v230, v94, v249
    v_fmac_f32 v231, v95, v249
    v_mfma_f32_16x16x32_bf16 v[136:139], v[68:71], v[104:107], v[136:139]
    ds_read_b64_tr_b16 v[56:57], v4 offset:49152
    v_fma_f32 v232, v92, v250, v232
    v_mfma_f32_16x16x32_bf16 v[140:143], v[68:71], v[108:111], v[140:143]
    ds_read_b64_tr_b16 v[58:59], v4 offset:53248
    v_fmac_f32 v233, v93, v250
    s_waitcnt lgkmcnt(10)
    v_mfma_f32_16x16x32_bf16 v[144:147], v[72:75], v[96:99], v[144:147]
    ds_read_b64_tr_b16 v[60:61], v5 offset:49152
    v_fma_f32 v234, v94, v250, v234
    v_mfma_f32_16x16x32_bf16 v[148:151], v[72:75], v[100:103], v[148:151]
    ds_read_b64_tr_b16 v[62:63], v5 offset:53248
    v_fmac_f32 v235, v95, v250
    v_fmac_f32 v236, v92, v251
    v_mfma_f32_16x16x32_bf16 v[152:155], v[72:75], v[104:107], v[152:155]
    ds_read_b64_tr_b16 v[20:21], v11 offset:49152
    v_fma_f32 v237, v93, v251, v237
    v_mfma_f32_16x16x32_bf16 v[156:159], v[72:75], v[108:111], v[156:159]
    ds_read_b64_tr_b16 v[22:23], v11 offset:53248
    v_fmac_f32 v238, v94, v251
    s_waitcnt lgkmcnt(12)
    v_mfma_f32_16x16x32_bf16 v[160:163], v[76:79], v[96:99], v[160:163]
    ds_read_b64_tr_b16 v[24:25], v10 offset:57344
    v_fma_f32 v239, v95, v251, v239
    v_mfma_f32_16x16x32_bf16 v[164:167], v[76:79], v[100:103], v[164:167]
    ds_read_b64_tr_b16 v[26:27], v10 offset:61440
    v_mfma_f32_16x16x32_bf16 v[168:171], v[76:79], v[104:107], v[168:171]
    ds_read_b64_tr_b16 v[28:29], v11 offset:57344
    v_mfma_f32_16x16x32_bf16 v[172:175], v[76:79], v[108:111], v[172:175]
    ds_read_b64_tr_b16 v[30:31], v11 offset:61440
    s_waitcnt lgkmcnt(6)
    s_nop 0
    v_mfma_f32_16x16x32_bf16 v[176:179], v[16:19], v[48:51], v[176:179]
    ds_read_b64_tr_b16 v[64:65], v246 offset:0
    v_mfma_f32_16x16x32_bf16 v[180:183], v[16:19], v[52:55], v[180:183]
    ds_read_b64_tr_b16 v[66:67], v246 offset:4096
    v_mfma_f32_16x16x32_bf16 v[184:187], v[16:19], v[56:59], v[184:187]
    ds_read_b64_tr_b16 v[96:97], v240 offset:0
    v_mfma_f32_16x16x32_bf16 v[188:191], v[16:19], v[60:63], v[188:191]
    ds_read_b64_tr_b16 v[98:99], v240 offset:4096
    v_mul_f32 v112, v112, v144
    s_waitcnt lgkmcnt(8)
    v_mfma_f32_16x16x32_bf16 v[192:195], v[20:23], v[48:51], v[192:195]
    ds_read_b64_tr_b16 v[100:101], v241 offset:0
    v_mul_f32_e64 v113, v113, v145
    v_mfma_f32_16x16x32_bf16 v[196:199], v[20:23], v[52:55], v[196:199]
    ds_read_b64_tr_b16 v[102:103], v241 offset:4096
    v_mul_f32_e64 v114, v114, v146
    v_mfma_f32_16x16x32_bf16 v[200:203], v[20:23], v[56:59], v[200:203]
    ds_read_b64_tr_b16 v[104:105], v242 offset:0
    v_mul_f32_e64 v115, v115, v147
    v_mfma_f32_16x16x32_bf16 v[204:207], v[20:23], v[60:63], v[204:207]
    ds_read_b64_tr_b16 v[106:107], v242 offset:4096
    v_mul_f32 v128, v128, v160
    s_waitcnt lgkmcnt(10)
    v_mfma_f32_16x16x32_bf16 v[208:211], v[24:27], v[48:51], v[208:211]
    ds_read_b64_tr_b16 v[108:109], v243 offset:0
    v_mul_f32_e64 v129, v129, v161
    v_mfma_f32_16x16x32_bf16 v[212:215], v[24:27], v[52:55], v[212:215]
    ds_read_b64_tr_b16 v[110:111], v243 offset:4096
    v_mul_f32_e64 v130, v130, v162
    v_mfma_f32_16x16x32_bf16 v[216:219], v[24:27], v[56:59], v[216:219]
    ds_read_b64_tr_b16 v[68:69], v247 offset:0
    v_mul_f32_e64 v131, v131, v163
    v_mfma_f32_16x16x32_bf16 v[220:223], v[24:27], v[60:63], v[220:223]
    ds_read_b64_tr_b16 v[70:71], v247 offset:4096
    v_cvt_pk_bf16_f32 v144, v112, v113
    s_waitcnt lgkmcnt(12)
    s_nop 0
    v_mfma_f32_16x16x32_bf16 v[224:227], v[28:31], v[48:51], v[224:227]
    ds_read_b64_tr_b16 v[72:73], v246 offset:8192
    v_cvt_pk_bf16_f32 v145, v114, v115
    v_mfma_f32_16x16x32_bf16 v[228:231], v[28:31], v[52:55], v[228:231]
    ds_read_b64_tr_b16 v[74:75], v246 offset:12288
    v_cvt_pk_bf16_f32 v146, v128, v129
    v_mfma_f32_16x16x32_bf16 v[232:235], v[28:31], v[56:59], v[232:235]
    ds_read_b64_tr_b16 v[76:77], v247 offset:8192
    v_cvt_pk_bf16_f32 v147, v130, v131
    v_mfma_f32_16x16x32_bf16 v[236:239], v[28:31], v[60:63], v[236:239]
    ds_read_b64_tr_b16 v[78:79], v247 offset:12288
    buffer_store_dwordx4 v[144:147], v6, s[16:19], s26 offen offset:0 sc1
    s_waitcnt lgkmcnt(6)
    s_nop 0
    v_mfma_f32_16x16x32_bf16 v[176:179], v[64:67], v[96:99], v[176:179]
    ds_read_b64_tr_b16 v[16:17], v246 offset:24576
    v_mul_f32_e64 v116, v116, v148
    v_mfma_f32_16x16x32_bf16 v[180:183], v[64:67], v[100:103], v[180:183]
    ds_read_b64_tr_b16 v[18:19], v246 offset:28672
    v_mul_f32_e64 v117, v117, v149
    v_mfma_f32_16x16x32_bf16 v[184:187], v[64:67], v[104:107], v[184:187]
    ds_read_b64_tr_b16 v[48:49], v240 offset:24576
    v_mul_f32_e64 v118, v118, v150
    v_mfma_f32_16x16x32_bf16 v[188:191], v[64:67], v[108:111], v[188:191]
    ds_read_b64_tr_b16 v[50:51], v240 offset:28672
    v_mul_f32 v119, v119, v151
    s_waitcnt lgkmcnt(8)
    v_mfma_f32_16x16x32_bf16 v[192:195], v[68:71], v[96:99], v[192:195]
    ds_read_b64_tr_b16 v[52:53], v241 offset:24576
    v_mul_f32_e64 v132, v132, v164
    v_mfma_f32_16x16x32_bf16 v[196:199], v[68:71], v[100:103], v[196:199]
    ds_read_b64_tr_b16 v[54:55], v241 offset:28672
    v_mul_f32_e64 v133, v133, v165
    v_mfma_f32_16x16x32_bf16 v[200:203], v[68:71], v[104:107], v[200:203]
    ds_read_b64_tr_b16 v[56:57], v242 offset:24576
    v_mul_f32_e64 v134, v134, v166
    v_mfma_f32_16x16x32_bf16 v[204:207], v[68:71], v[108:111], v[204:207]
    ds_read_b64_tr_b16 v[58:59], v242 offset:28672
    v_mul_f32 v135, v135, v167
    s_waitcnt lgkmcnt(10)
    v_mfma_f32_16x16x32_bf16 v[208:211], v[72:75], v[96:99], v[208:211]
    ds_read_b64_tr_b16 v[60:61], v243 offset:24576
    v_cvt_pk_bf16_f32 v148, v116, v117
    v_mfma_f32_16x16x32_bf16 v[212:215], v[72:75], v[100:103], v[212:215]
    ds_read_b64_tr_b16 v[62:63], v243 offset:28672
    v_cvt_pk_bf16_f32 v149, v118, v119
    v_mfma_f32_16x16x32_bf16 v[216:219], v[72:75], v[104:107], v[216:219]
    ds_read_b64_tr_b16 v[20:21], v247 offset:24576
    v_cvt_pk_bf16_f32 v150, v132, v133
    v_mfma_f32_16x16x32_bf16 v[220:223], v[72:75], v[108:111], v[220:223]
    ds_read_b64_tr_b16 v[22:23], v247 offset:28672
    v_cvt_pk_bf16_f32 v151, v134, v135
    s_waitcnt lgkmcnt(12)
    s_nop 0
    v_mfma_f32_16x16x32_bf16 v[224:227], v[76:79], v[96:99], v[224:227]
    ds_read_b64_tr_b16 v[24:25], v246 offset:32768
    buffer_store_dwordx4 v[148:151], v6, s[16:19], s26 offen offset:1024 sc1
    v_mfma_f32_16x16x32_bf16 v[228:231], v[76:79], v[100:103], v[228:231]
    ds_read_b64_tr_b16 v[26:27], v246 offset:36864
    v_mul_f32_e64 v120, v120, v152
    v_mfma_f32_16x16x32_bf16 v[232:235], v[76:79], v[104:107], v[232:235]
    ds_read_b64_tr_b16 v[28:29], v247 offset:32768
    v_mul_f32_e64 v121, v121, v153
    v_mfma_f32_16x16x32_bf16 v[236:239], v[76:79], v[108:111], v[236:239]
    ds_read_b64_tr_b16 v[30:31], v247 offset:36864
    v_mul_f32 v122, v122, v154
    s_waitcnt lgkmcnt(6)
    v_mfma_f32_16x16x32_bf16 v[176:179], v[16:19], v[48:51], v[176:179]
    ds_read_b64_tr_b16 v[64:65], v246 offset:49152
    v_mul_f32_e64 v123, v123, v155
    v_mfma_f32_16x16x32_bf16 v[180:183], v[16:19], v[52:55], v[180:183]
    ds_read_b64_tr_b16 v[66:67], v246 offset:53248
    v_mul_f32_e64 v136, v136, v168
    v_mfma_f32_16x16x32_bf16 v[184:187], v[16:19], v[56:59], v[184:187]
    ds_read_b64_tr_b16 v[96:97], v240 offset:49152
    v_mul_f32_e64 v137, v137, v169
    v_mfma_f32_16x16x32_bf16 v[188:191], v[16:19], v[60:63], v[188:191]
    ds_read_b64_tr_b16 v[98:99], v240 offset:53248
    v_mul_f32 v138, v138, v170
    s_waitcnt lgkmcnt(8)
    v_mfma_f32_16x16x32_bf16 v[192:195], v[20:23], v[48:51], v[192:195]
    ds_read_b64_tr_b16 v[100:101], v241 offset:49152
    v_mul_f32_e64 v139, v139, v171
    v_mfma_f32_16x16x32_bf16 v[196:199], v[20:23], v[52:55], v[196:199]
    ds_read_b64_tr_b16 v[102:103], v241 offset:53248
    v_cvt_pk_bf16_f32 v152, v120, v121
    v_mfma_f32_16x16x32_bf16 v[200:203], v[20:23], v[56:59], v[200:203]
    ds_read_b64_tr_b16 v[104:105], v242 offset:49152
    v_cvt_pk_bf16_f32 v153, v122, v123
    v_mfma_f32_16x16x32_bf16 v[204:207], v[20:23], v[60:63], v[204:207]
    ds_read_b64_tr_b16 v[106:107], v242 offset:53248
    v_cvt_pk_bf16_f32 v154, v136, v137
    s_waitcnt lgkmcnt(10)
    s_nop 0
    v_mfma_f32_16x16x32_bf16 v[208:211], v[24:27], v[48:51], v[208:211]
    ds_read_b64_tr_b16 v[108:109], v243 offset:49152
    v_cvt_pk_bf16_f32 v155, v138, v139
    v_mfma_f32_16x16x32_bf16 v[212:215], v[24:27], v[52:55], v[212:215]
    ds_read_b64_tr_b16 v[110:111], v243 offset:53248
    buffer_store_dwordx4 v[152:155], v6, s[16:19], s26 offen offset:2048 sc1
    v_mfma_f32_16x16x32_bf16 v[216:219], v[24:27], v[56:59], v[216:219]
    ds_read_b64_tr_b16 v[68:69], v247 offset:49152
    v_mul_f32_e64 v124, v124, v156
    v_mfma_f32_16x16x32_bf16 v[220:223], v[24:27], v[60:63], v[220:223]
    ds_read_b64_tr_b16 v[70:71], v247 offset:53248
    v_mul_f32 v125, v125, v157
    s_waitcnt lgkmcnt(12)
    v_mfma_f32_16x16x32_bf16 v[224:227], v[28:31], v[48:51], v[224:227]
    ds_read_b64_tr_b16 v[72:73], v246 offset:57344
    v_mul_f32_e64 v126, v126, v158
    v_mfma_f32_16x16x32_bf16 v[228:231], v[28:31], v[52:55], v[228:231]
    ds_read_b64_tr_b16 v[74:75], v246 offset:61440
    v_mul_f32_e64 v127, v127, v159
    v_mfma_f32_16x16x32_bf16 v[232:235], v[28:31], v[56:59], v[232:235]
    ds_read_b64_tr_b16 v[76:77], v247 offset:57344
    v_mul_f32_e64 v140, v140, v172
    v_mfma_f32_16x16x32_bf16 v[236:239], v[28:31], v[60:63], v[236:239]
    ds_read_b64_tr_b16 v[78:79], v247 offset:61440
    v_mul_f32 v141, v141, v173
    s_waitcnt lgkmcnt(6)
    v_mfma_f32_16x16x32_bf16 v[176:179], v[64:67], v[96:99], v[176:179]
    v_mul_f32_e64 v142, v142, v174
    v_mfma_f32_16x16x32_bf16 v[180:183], v[64:67], v[100:103], v[180:183]
    v_mul_f32_e64 v143, v143, v175
    v_mfma_f32_16x16x32_bf16 v[184:187], v[64:67], v[104:107], v[184:187]
    v_cvt_pk_bf16_f32 v156, v124, v125
    v_mfma_f32_16x16x32_bf16 v[188:191], v[64:67], v[108:111], v[188:191]
    v_cvt_pk_bf16_f32 v157, v126, v127
    s_waitcnt lgkmcnt(4)
    s_nop 0
    v_mfma_f32_16x16x32_bf16 v[192:195], v[68:71], v[96:99], v[192:195]
    v_cvt_pk_bf16_f32 v158, v140, v141
    v_mfma_f32_16x16x32_bf16 v[196:199], v[68:71], v[100:103], v[196:199]
    v_cvt_pk_bf16_f32 v159, v142, v143
    v_mfma_f32_16x16x32_bf16 v[200:203], v[68:71], v[104:107], v[200:203]
    buffer_store_dwordx4 v[156:159], v6, s[16:19], s26 offen offset:3072 sc1
    v_mfma_f32_16x16x32_bf16 v[204:207], v[68:71], v[108:111], v[204:207]
    s_waitcnt lgkmcnt(2)
    s_nop 0
    v_mfma_f32_16x16x32_bf16 v[208:211], v[72:75], v[96:99], v[208:211]
    v_mfma_f32_16x16x32_bf16 v[212:215], v[72:75], v[100:103], v[212:215]
    v_mfma_f32_16x16x32_bf16 v[216:219], v[72:75], v[104:107], v[216:219]
    v_mfma_f32_16x16x32_bf16 v[220:223], v[72:75], v[108:111], v[220:223]
    s_waitcnt lgkmcnt(0)
    s_nop 0
    v_mfma_f32_16x16x32_bf16 v[224:227], v[76:79], v[96:99], v[224:227]
    v_mfma_f32_16x16x32_bf16 v[228:231], v[76:79], v[100:103], v[228:231]
    v_mfma_f32_16x16x32_bf16 v[232:235], v[76:79], v[104:107], v[232:235]
    v_mfma_f32_16x16x32_bf16 v[236:239], v[76:79], v[108:111], v[236:239]
    s_nop 4
    v_pk_mul_f32 v[176:177], v[176:177], v[208:209]
    v_pk_mul_f32 v[178:179], v[178:179], v[210:211]
    v_pk_mul_f32 v[192:193], v[192:193], v[224:225]
    v_pk_mul_f32 v[194:195], v[194:195], v[226:227]
    v_cvt_pk_bf16_f32 v208, v176, v177
    v_cvt_pk_bf16_f32 v209, v178, v179
    v_cvt_pk_bf16_f32 v210, v192, v193
    v_cvt_pk_bf16_f32 v211, v194, v195
    buffer_store_dwordx4 v[208:211], v6, s[16:19], s27 offen offset:0 sc1
    v_pk_mul_f32 v[180:181], v[180:181], v[212:213]
    v_pk_mul_f32 v[182:183], v[182:183], v[214:215]
    v_pk_mul_f32 v[196:197], v[196:197], v[228:229]
    v_pk_mul_f32 v[198:199], v[198:199], v[230:231]
    v_cvt_pk_bf16_f32 v212, v180, v181
    v_cvt_pk_bf16_f32 v213, v182, v183
    v_cvt_pk_bf16_f32 v214, v196, v197
    v_cvt_pk_bf16_f32 v215, v198, v199
    buffer_store_dwordx4 v[212:215], v6, s[16:19], s27 offen offset:1024 sc1
    v_pk_mul_f32 v[184:185], v[184:185], v[216:217]
    v_pk_mul_f32 v[186:187], v[186:187], v[218:219]
    v_pk_mul_f32 v[200:201], v[200:201], v[232:233]
    v_pk_mul_f32 v[202:203], v[202:203], v[234:235]
    v_cvt_pk_bf16_f32 v216, v184, v185
    v_cvt_pk_bf16_f32 v217, v186, v187
    v_cvt_pk_bf16_f32 v218, v200, v201
    v_cvt_pk_bf16_f32 v219, v202, v203
    buffer_store_dwordx4 v[216:219], v6, s[16:19], s27 offen offset:2048 sc1
    v_pk_mul_f32 v[188:189], v[188:189], v[220:221]
    v_pk_mul_f32 v[190:191], v[190:191], v[222:223]
    v_pk_mul_f32 v[204:205], v[204:205], v[236:237]
    v_pk_mul_f32 v[206:207], v[206:207], v[238:239]
    v_cvt_pk_bf16_f32 v220, v188, v189
    v_cvt_pk_bf16_f32 v221, v190, v191
    v_cvt_pk_bf16_f32 v222, v204, v205
    v_cvt_pk_bf16_f32 v223, v206, v207
    buffer_store_dwordx4 v[220:223], v6, s[16:19], s27 offen offset:3072 sc1
    s_waitcnt vmcnt(4)
    s_branch F_C_ARR
F_C_STAT:
    s_add_u32 s16, s4, 12582912
    s_addc_u32 s17, s5, 0
    s_and_b32 s17, s17, 0xffff
    s_mov_b32 s18, 2621440
    s_mov_b32 s19, 0x20000
    s_sub_u32 s22, s2, 224
    s_lshr_b32 s26, s22, 1
    s_mul_i32 s26, s26, 163840
    s_and_b32 s27, s22, 1
    s_lshl_b32 s27, s27, 7
    s_add_u32 s26, s26, s27
    s_mul_i32 s27, s25, 40960
    s_add_u32 s26, s26, s27
    v_lshrrev_b32 v10, 3, v1
    v_lshlrev_b32 v10, 8, v10
    v_and_b32 v11, 7, v1
    v_lshl_add_u32 v10, v11, 4, v10
    v_mov_b32 v16, 0
    v_mov_b32 v17, 0
    v_mov_b32 v18, 0
    v_mov_b32 v19, 0
    v_mov_b32 v20, 0
    v_mov_b32 v21, 0
    v_mov_b32 v22, 0
    v_mov_b32 v23, 0
    v_mov_b32 v24, 0
    v_mov_b32 v25, 0
    v_mov_b32 v26, 0
    v_mov_b32 v27, 0
    v_mov_b32 v28, 0
    v_mov_b32 v29, 0
    v_mov_b32 v30, 0
    v_mov_b32 v31, 0
    s_cmp_lg_u32 s24, 4
    s_cbranch_scc1 F_C_S2B_OK
    s_add_u32 s36, s4, 15335424
    s_addc_u32 s37, s5, 0
    s_and_b32 s37, s37, 0xffff
    s_mov_b32 s38, 13824
    s_mov_b32 s39, 0x20000
    s_lshl_b32 s30, s20, 9
    s_add_u32 s30, s30, 5120
    v_and_b32 v12, 3, v1
    v_lshlrev_b32 v12, 7, v12
    s_mov_b32 s48, 0
F_C_S2B:
    buffer_load_dword v13, v12, s[36:39], s30 offen sc1
    s_add_u32 s48, s48, 1
    s_waitcnt vmcnt(0)
    v_cmp_gt_u32 vcc, 1, v13
    s_cbranch_vccz F_C_S2B_OK
    s_sleep 1
    s_cmp_lt_u32 s48, 262144
    s_cbranch_scc1 F_C_S2B
F_C_S2B_OK:
    s_barrier
    buffer_load_dwordx4 v[112:115], v10, s[16:19], s26 offen offset:0 sc1
    buffer_load_dwordx4 v[116:119], v10, s[16:19], s26 offen offset:2048 sc1
    s_add_u32 s26, s26, 4096
    buffer_load_dwordx4 v[120:123], v10, s[16:19], s26 offen offset:0 sc1
    buffer_load_dwordx4 v[124:127], v10, s[16:19], s26 offen offset:2048 sc1
    s_add_u32 s26, s26, 4096
    buffer_load_dwordx4 v[128:131], v10, s[16:19], s26 offen offset:0 sc1
    buffer_load_dwordx4 v[132:135], v10, s[16:19], s26 offen offset:2048 sc1
    s_add_u32 s26, s26, 4096
    buffer_load_dwordx4 v[136:139], v10, s[16:19], s26 offen offset:0 sc1
    buffer_load_dwordx4 v[140:143], v10, s[16:19], s26 offen offset:2048 sc1
    s_add_u32 s26, s26, 4096
    buffer_load_dwordx4 v[144:147], v10, s[16:19], s26 offen offset:0 sc1
    buffer_load_dwordx4 v[148:151], v10, s[16:19], s26 offen offset:2048 sc1
PADB6:
    s_cbranch_execz PADB7
    s_nop 0
    s_add_u32 s26, s26, 4096
    buffer_load_dwordx4 v[152:155], v10, s[16:19], s26 offen offset:0 sc1
    buffer_load_dwordx4 v[156:159], v10, s[16:19], s26 offen offset:2048 sc1
    s_add_u32 s26, s26, 4096
    buffer_load_dwordx4 v[160:163], v10, s[16:19], s26 offen offset:0 sc1
    buffer_load_dwordx4 v[164:167], v10, s[16:19], s26 offen offset:2048 sc1
    s_add_u32 s26, s26, 4096
    buffer_load_dwordx4 v[168:171], v10, s[16:19], s26 offen offset:0 sc1
    buffer_load_dwordx4 v[172:175], v10, s[16:19], s26 offen offset:2048 sc1
    s_add_u32 s26, s26, 4096
    buffer_load_dwordx4 v[176:179], v10, s[16:19], s26 offen offset:0 sc1
    buffer_load_dwordx4 v[180:183], v10, s[16:19], s26 offen offset:2048 sc1
    s_add_u32 s26, s26, 4096
    buffer_load_dwordx4 v[184:187], v10, s[16:19], s26 offen offset:0 sc1
    buffer_load_dwordx4 v[188:191], v10, s[16:19], s26 offen offset:2048 sc1
    s_add_u32 s26, s26, 4096
    s_waitcnt vmcnt(19)
    v_lshlrev_b32 v32, 16, v112
    v_and_b32 v33, 0xffff0000, v112
    v_pk_add_f32 v[16:17], v[16:17], v[32:33]
    v_pk_fma_f32 v[24:25], v[32:33], v[32:33], v[24:25]
    v_lshlrev_b32 v32, 16, v113
    v_and_b32 v33, 0xffff0000, v113
    v_pk_add_f32 v[18:19], v[18:19], v[32:33]
    v_pk_fma_f32 v[26:27], v[32:33], v[32:33], v[26:27]
    v_lshlrev_b32 v32, 16, v114
    v_and_b32 v33, 0xffff0000, v114
    v_pk_add_f32 v[20:21], v[20:21], v[32:33]
    v_pk_fma_f32 v[28:29], v[32:33], v[32:33], v[28:29]
    v_lshlrev_b32 v32, 16, v115
    v_and_b32 v33, 0xffff0000, v115
    v_pk_add_f32 v[22:23], v[22:23], v[32:33]
    v_pk_fma_f32 v[30:31], v[32:33], v[32:33], v[30:31]
    s_waitcnt vmcnt(18)
    v_lshlrev_b32 v32, 16, v116
    v_and_b32 v33, 0xffff0000, v116
    v_pk_add_f32 v[16:17], v[16:17], v[32:33]
    v_pk_fma_f32 v[24:25], v[32:33], v[32:33], v[24:25]
    v_lshlrev_b32 v32, 16, v117
    v_and_b32 v33, 0xffff0000, v117
    v_pk_add_f32 v[18:19], v[18:19], v[32:33]
    v_pk_fma_f32 v[26:27], v[32:33], v[32:33], v[26:27]
    v_lshlrev_b32 v32, 16, v118
    v_and_b32 v33, 0xffff0000, v118
    v_pk_add_f32 v[20:21], v[20:21], v[32:33]
    v_pk_fma_f32 v[28:29], v[32:33], v[32:33], v[28:29]
    v_lshlrev_b32 v32, 16, v119
    v_and_b32 v33, 0xffff0000, v119
    v_pk_add_f32 v[22:23], v[22:23], v[32:33]
    v_pk_fma_f32 v[30:31], v[32:33], v[32:33], v[30:31]
    s_waitcnt vmcnt(17)
    v_lshlrev_b32 v32, 16, v120
    v_and_b32 v33, 0xffff0000, v120
    v_pk_add_f32 v[16:17], v[16:17], v[32:33]
    v_pk_fma_f32 v[24:25], v[32:33], v[32:33], v[24:25]
    v_lshlrev_b32 v32, 16, v121
    v_and_b32 v33, 0xffff0000, v121
    v_pk_add_f32 v[18:19], v[18:19], v[32:33]
    v_pk_fma_f32 v[26:27], v[32:33], v[32:33], v[26:27]
    v_lshlrev_b32 v32, 16, v122
    v_and_b32 v33, 0xffff0000, v122
    v_pk_add_f32 v[20:21], v[20:21], v[32:33]
    v_pk_fma_f32 v[28:29], v[32:33], v[32:33], v[28:29]
    v_lshlrev_b32 v32, 16, v123
    v_and_b32 v33, 0xffff0000, v123
    v_pk_add_f32 v[22:23], v[22:23], v[32:33]
    v_pk_fma_f32 v[30:31], v[32:33], v[32:33], v[30:31]
    s_waitcnt vmcnt(16)
    v_lshlrev_b32 v32, 16, v124
    v_and_b32 v33, 0xffff0000, v124
    v_pk_add_f32 v[16:17], v[16:17], v[32:33]
    v_pk_fma_f32 v[24:25], v[32:33], v[32:33], v[24:25]
    v_lshlrev_b32 v32, 16, v125
    v_and_b32 v33, 0xffff0000, v125
    v_pk_add_f32 v[18:19], v[18:19], v[32:33]
    v_pk_fma_f32 v[26:27], v[32:33], v[32:33], v[26:27]
    v_lshlrev_b32 v32, 16, v126
    v_and_b32 v33, 0xffff0000, v126
    v_pk_add_f32 v[20:21], v[20:21], v[32:33]
    v_pk_fma_f32 v[28:29], v[32:33], v[32:33], v[28:29]
    v_lshlrev_b32 v32, 16, v127
    v_and_b32 v33, 0xffff0000, v127
    v_pk_add_f32 v[22:23], v[22:23], v[32:33]
    v_pk_fma_f32 v[30:31], v[32:33], v[32:33], v[30:31]
    s_waitcnt vmcnt(15)
    v_lshlrev_b32 v32, 16, v128
    v_and_b32 v33, 0xffff0000, v128
    v_pk_add_f32 v[16:17], v[16:17], v[32:33]
    v_pk_fma_f32 v[24:25], v[32:33], v[32:33], v[24:25]
    v_lshlrev_b32 v32, 16, v129
    v_and_b32 v33, 0xffff0000, v129
    v_pk_add_f32 v[18:19], v[18:19], v[32:33]
    v_pk_fma_f32 v[26:27], v[32:33], v[32:33], v[26:27]
    v_lshlrev_b32 v32, 16, v130
    v_and_b32 v33, 0xffff0000, v130
    v_pk_add_f32 v[20:21], v[20:21], v[32:33]
    v_pk_fma_f32 v[28:29], v[32:33], v[32:33], v[28:29]
    v_lshlrev_b32 v32, 16, v131
    v_and_b32 v33, 0xffff0000, v131
    v_pk_add_f32 v[22:23], v[22:23], v[32:33]
    v_pk_fma_f32 v[30:31], v[32:33], v[32:33], v[30:31]
    s_waitcnt vmcnt(14)
    v_lshlrev_b32 v32, 16, v132
    v_and_b32 v33, 0xffff0000, v132
    v_pk_add_f32 v[16:17], v[16:17], v[32:33]
    v_pk_fma_f32 v[24:25], v[32:33], v[32:33], v[24:25]
    v_lshlrev_b32 v32, 16, v133
    v_and_b32 v33, 0xffff0000, v133
    v_pk_add_f32 v[18:19], v[18:19], v[32:33]
    v_pk_fma_f32 v[26:27], v[32:33], v[32:33], v[26:27]
    v_lshlrev_b32 v32, 16, v134
    v_and_b32 v33, 0xffff0000, v134
    v_pk_add_f32 v[20:21], v[20:21], v[32:33]
    v_pk_fma_f32 v[28:29], v[32:33], v[32:33], v[28:29]
    v_lshlrev_b32 v32, 16, v135
    v_and_b32 v33, 0xffff0000, v135
    v_pk_add_f32 v[22:23], v[22:23], v[32:33]
    v_pk_fma_f32 v[30:31], v[32:33], v[32:33], v[30:31]
    s_waitcnt vmcnt(13)
    v_lshlrev_b32 v32, 16, v136
    v_and_b32 v33, 0xffff0000, v136
    v_pk_add_f32 v[16:17], v[16:17], v[32:33]
    v_pk_fma_f32 v[24:25], v[32:33], v[32:33], v[24:25]
    v_lshlrev_b32 v32, 16, v137
    v_and_b32 v33, 0xffff0000, v137
    v_pk_add_f32 v[18:19], v[18:19], v[32:33]
    v_pk_fma_f32 v[26:27], v[32:33], v[32:33], v[26:27]
    v_lshlrev_b32 v32, 16, v138
    v_and_b32 v33, 0xffff0000, v138
    v_pk_add_f32 v[20:21], v[20:21], v[32:33]
    v_pk_fma_f32 v[28:29], v[32:33], v[32:33], v[28:29]
    v_lshlrev_b32 v32, 16, v139
    v_and_b32 v33, 0xffff0000, v139
    v_pk_add_f32 v[22:23], v[22:23], v[32:33]
    v_pk_fma_f32 v[30:31], v[32:33], v[32:33], v[30:31]
    s_waitcnt vmcnt(12)
    v_lshlrev_b32 v32, 16, v140
    v_and_b32 v33, 0xffff0000, v140
    v_pk_add_f32 v[16:17], v[16:17], v[32:33]
    v_pk_fma_f32 v[24:25], v[32:33], v[32:33], v[24:25]
    v_lshlrev_b32 v32, 16, v141
    v_and_b32 v33, 0xffff0000, v141
    v_pk_add_f32 v[18:19], v[18:19], v[32:33]
    v_pk_fma_f32 v[26:27], v[32:33], v[32:33], v[26:27]
    v_lshlrev_b32 v32, 16, v142
    v_and_b32 v33, 0xffff0000, v142
    v_pk_add_f32 v[20:21], v[20:21], v[32:33]
    v_pk_fma_f32 v[28:29], v[32:33], v[32:33], v[28:29]
    v_lshlrev_b32 v32, 16, v143
    v_and_b32 v33, 0xffff0000, v143
    v_pk_add_f32 v[22:23], v[22:23], v[32:33]
    v_pk_fma_f32 v[30:31], v[32:33], v[32:33], v[30:31]
    s_waitcnt vmcnt(11)
    v_lshlrev_b32 v32, 16, v144
    v_and_b32 v33, 0xffff0000, v144
    v_pk_add_f32 v[16:17], v[16:17], v[32:33]
    v_pk_fma_f32 v[24:25], v[32:33], v[32:33], v[24:25]
    v_lshlrev_b32 v32, 16, v145
    v_and_b32 v33, 0xffff0000, v145
    v_pk_add_f32 v[18:19], v[18:19], v[32:33]
    v_pk_fma_f32 v[26:27], v[32:33], v[32:33], v[26:27]
    v_lshlrev_b32 v32, 16, v146
    v_and_b32 v33, 0xffff0000, v146
    v_pk_add_f32 v[20:21], v[20:21], v[32:33]
    v_pk_fma_f32 v[28:29], v[32:33], v[32:33], v[28:29]
    v_lshlrev_b32 v32, 16, v147
    v_and_b32 v33, 0xffff0000, v147
    v_pk_add_f32 v[22:23], v[22:23], v[32:33]
    v_pk_fma_f32 v[30:31], v[32:33], v[32:33], v[30:31]
    s_waitcnt vmcnt(10)
    v_lshlrev_b32 v32, 16, v148
    v_and_b32 v33, 0xffff0000, v148
    v_pk_add_f32 v[16:17], v[16:17], v[32:33]
    v_pk_fma_f32 v[24:25], v[32:33], v[32:33], v[24:25]
    v_lshlrev_b32 v32, 16, v149
    v_and_b32 v33, 0xffff0000, v149
    v_pk_add_f32 v[18:19], v[18:19], v[32:33]
    v_pk_fma_f32 v[26:27], v[32:33], v[32:33], v[26:27]
    v_lshlrev_b32 v32, 16, v150
    v_and_b32 v33, 0xffff0000, v150
    v_pk_add_f32 v[20:21], v[20:21], v[32:33]
    v_pk_fma_f32 v[28:29], v[32:33], v[32:33], v[28:29]
    v_lshlrev_b32 v32, 16, v151
    v_and_b32 v33, 0xffff0000, v151
    v_pk_add_f32 v[22:23], v[22:23], v[32:33]
    v_pk_fma_f32 v[30:31], v[32:33], v[32:33], v[30:31]
    s_waitcnt vmcnt(9)
    v_lshlrev_b32 v32, 16, v152
    v_and_b32 v33, 0xffff0000, v152
    v_pk_add_f32 v[16:17], v[16:17], v[32:33]
    v_pk_fma_f32 v[24:25], v[32:33], v[32:33], v[24:25]
    v_lshlrev_b32 v32, 16, v153
    v_and_b32 v33, 0xffff0000, v153
    v_pk_add_f32 v[18:19], v[18:19], v[32:33]
    v_pk_fma_f32 v[26:27], v[32:33], v[32:33], v[26:27]
    v_lshlrev_b32 v32, 16, v154
    v_and_b32 v33, 0xffff0000, v154
    v_pk_add_f32 v[20:21], v[20:21], v[32:33]
    v_pk_fma_f32 v[28:29], v[32:33], v[32:33], v[28:29]
    v_lshlrev_b32 v32, 16, v155
    v_and_b32 v33, 0xffff0000, v155
    v_pk_add_f32 v[22:23], v[22:23], v[32:33]
    v_pk_fma_f32 v[30:31], v[32:33], v[32:33], v[30:31]
    s_waitcnt vmcnt(8)
    v_lshlrev_b32 v32, 16, v156
    v_and_b32 v33, 0xffff0000, v156
    v_pk_add_f32 v[16:17], v[16:17], v[32:33]
    v_pk_fma_f32 v[24:25], v[32:33], v[32:33], v[24:25]
    v_lshlrev_b32 v32, 16, v157
    v_and_b32 v33, 0xffff0000, v157
    v_pk_add_f32 v[18:19], v[18:19], v[32:33]
    v_pk_fma_f32 v[26:27], v[32:33], v[32:33], v[26:27]
    v_lshlrev_b32 v32, 16, v158
    v_and_b32 v33, 0xffff0000, v158
    v_pk_add_f32 v[20:21], v[20:21], v[32:33]
    v_pk_fma_f32 v[28:29], v[32:33], v[32:33], v[28:29]
    v_lshlrev_b32 v32, 16, v159
    v_and_b32 v33, 0xffff0000, v159
    v_pk_add_f32 v[22:23], v[22:23], v[32:33]
    v_pk_fma_f32 v[30:31], v[32:33], v[32:33], v[30:31]
    s_waitcnt vmcnt(7)
    v_lshlrev_b32 v32, 16, v160
    v_and_b32 v33, 0xffff0000, v160
    v_pk_add_f32 v[16:17], v[16:17], v[32:33]
    v_pk_fma_f32 v[24:25], v[32:33], v[32:33], v[24:25]
    v_lshlrev_b32 v32, 16, v161
    v_and_b32 v33, 0xffff0000, v161
    v_pk_add_f32 v[18:19], v[18:19], v[32:33]
    v_pk_fma_f32 v[26:27], v[32:33], v[32:33], v[26:27]
    v_lshlrev_b32 v32, 16, v162
    v_and_b32 v33, 0xffff0000, v162
    v_pk_add_f32 v[20:21], v[20:21], v[32:33]
    v_pk_fma_f32 v[28:29], v[32:33], v[32:33], v[28:29]
    v_lshlrev_b32 v32, 16, v163
    v_and_b32 v33, 0xffff0000, v163
    v_pk_add_f32 v[22:23], v[22:23], v[32:33]
    v_pk_fma_f32 v[30:31], v[32:33], v[32:33], v[30:31]
    s_waitcnt vmcnt(6)
    v_lshlrev_b32 v32, 16, v164
    v_and_b32 v33, 0xffff0000, v164
    v_pk_add_f32 v[16:17], v[16:17], v[32:33]
    v_pk_fma_f32 v[24:25], v[32:33], v[32:33], v[24:25]
    v_lshlrev_b32 v32, 16, v165
    v_and_b32 v33, 0xffff0000, v165
    v_pk_add_f32 v[18:19], v[18:19], v[32:33]
    v_pk_fma_f32 v[26:27], v[32:33], v[32:33], v[26:27]
    v_lshlrev_b32 v32, 16, v166
    v_and_b32 v33, 0xffff0000, v166
    v_pk_add_f32 v[20:21], v[20:21], v[32:33]
    v_pk_fma_f32 v[28:29], v[32:33], v[32:33], v[28:29]
    v_lshlrev_b32 v32, 16, v167
    v_and_b32 v33, 0xffff0000, v167
    v_pk_add_f32 v[22:23], v[22:23], v[32:33]
    v_pk_fma_f32 v[30:31], v[32:33], v[32:33], v[30:31]
    s_waitcnt vmcnt(5)
    v_lshlrev_b32 v32, 16, v168
    v_and_b32 v33, 0xffff0000, v168
    v_pk_add_f32 v[16:17], v[16:17], v[32:33]
    v_pk_fma_f32 v[24:25], v[32:33], v[32:33], v[24:25]
    v_lshlrev_b32 v32, 16, v169
    v_and_b32 v33, 0xffff0000, v169
    v_pk_add_f32 v[18:19], v[18:19], v[32:33]
    v_pk_fma_f32 v[26:27], v[32:33], v[32:33], v[26:27]
    v_lshlrev_b32 v32, 16, v170
    v_and_b32 v33, 0xffff0000, v170
    v_pk_add_f32 v[20:21], v[20:21], v[32:33]
    v_pk_fma_f32 v[28:29], v[32:33], v[32:33], v[28:29]
    v_lshlrev_b32 v32, 16, v171
    v_and_b32 v33, 0xffff0000, v171
    v_pk_add_f32 v[22:23], v[22:23], v[32:33]
    v_pk_fma_f32 v[30:31], v[32:33], v[32:33], v[30:31]
    s_waitcnt vmcnt(4)
    v_lshlrev_b32 v32, 16, v172
    v_and_b32 v33, 0xffff0000, v172
    v_pk_add_f32 v[16:17], v[16:17], v[32:33]
    v_pk_fma_f32 v[24:25], v[32:33], v[32:33], v[24:25]
    v_lshlrev_b32 v32, 16, v173
    v_and_b32 v33, 0xffff0000, v173
    v_pk_add_f32 v[18:19], v[18:19], v[32:33]
    v_pk_fma_f32 v[26:27], v[32:33], v[32:33], v[26:27]
    v_lshlrev_b32 v32, 16, v174
    v_and_b32 v33, 0xffff0000, v174
    v_pk_add_f32 v[20:21], v[20:21], v[32:33]
    v_pk_fma_f32 v[28:29], v[32:33], v[32:33], v[28:29]
    v_lshlrev_b32 v32, 16, v175
    v_and_b32 v33, 0xffff0000, v175
    v_pk_add_f32 v[22:23], v[22:23], v[32:33]
    v_pk_fma_f32 v[30:31], v[32:33], v[32:33], v[30:31]
    s_waitcnt vmcnt(3)
    v_lshlrev_b32 v32, 16, v176
    v_and_b32 v33, 0xffff0000, v176
    v_pk_add_f32 v[16:17], v[16:17], v[32:33]
    v_pk_fma_f32 v[24:25], v[32:33], v[32:33], v[24:25]
    v_lshlrev_b32 v32, 16, v177
    v_and_b32 v33, 0xffff0000, v177
    v_pk_add_f32 v[18:19], v[18:19], v[32:33]
    v_pk_fma_f32 v[26:27], v[32:33], v[32:33], v[26:27]
    v_lshlrev_b32 v32, 16, v178
    v_and_b32 v33, 0xffff0000, v178
    v_pk_add_f32 v[20:21], v[20:21], v[32:33]
    v_pk_fma_f32 v[28:29], v[32:33], v[32:33], v[28:29]
    v_lshlrev_b32 v32, 16, v179
    v_and_b32 v33, 0xffff0000, v179
    v_pk_add_f32 v[22:23], v[22:23], v[32:33]
    v_pk_fma_f32 v[30:31], v[32:33], v[32:33], v[30:31]
    s_waitcnt vmcnt(2)
    v_lshlrev_b32 v32, 16, v180
    v_and_b32 v33, 0xffff0000, v180
    v_pk_add_f32 v[16:17], v[16:17], v[32:33]
    v_pk_fma_f32 v[24:25], v[32:33], v[32:33], v[24:25]
    v_lshlrev_b32 v32, 16, v181
    v_and_b32 v33, 0xffff0000, v181
    v_pk_add_f32 v[18:19], v[18:19], v[32:33]
    v_pk_fma_f32 v[26:27], v[32:33], v[32:33], v[26:27]
    v_lshlrev_b32 v32, 16, v182
    v_and_b32 v33, 0xffff0000, v182
    v_pk_add_f32 v[20:21], v[20:21], v[32:33]
    v_pk_fma_f32 v[28:29], v[32:33], v[32:33], v[28:29]
    v_lshlrev_b32 v32, 16, v183
    v_and_b32 v33, 0xffff0000, v183
    v_pk_add_f32 v[22:23], v[22:23], v[32:33]
    v_pk_fma_f32 v[30:31], v[32:33], v[32:33], v[30:31]
    s_waitcnt vmcnt(1)
    v_lshlrev_b32 v32, 16, v184
    v_and_b32 v33, 0xffff0000, v184
    v_pk_add_f32 v[16:17], v[16:17], v[32:33]
    v_pk_fma_f32 v[24:25], v[32:33], v[32:33], v[24:25]
    v_lshlrev_b32 v32, 16, v185
    v_and_b32 v33, 0xffff0000, v185
    v_pk_add_f32 v[18:19], v[18:19], v[32:33]
    v_pk_fma_f32 v[26:27], v[32:33], v[32:33], v[26:27]
    v_lshlrev_b32 v32, 16, v186
    v_and_b32 v33, 0xffff0000, v186
    v_pk_add_f32 v[20:21], v[20:21], v[32:33]
    v_pk_fma_f32 v[28:29], v[32:33], v[32:33], v[28:29]
    v_lshlrev_b32 v32, 16, v187
    v_and_b32 v33, 0xffff0000, v187
    v_pk_add_f32 v[22:23], v[22:23], v[32:33]
    v_pk_fma_f32 v[30:31], v[32:33], v[32:33], v[30:31]
    s_waitcnt vmcnt(0)
    v_lshlrev_b32 v32, 16, v188
    v_and_b32 v33, 0xffff0000, v188
    v_pk_add_f32 v[16:17], v[16:17], v[32:33]
    v_pk_fma_f32 v[24:25], v[32:33], v[32:33], v[24:25]
    v_lshlrev_b32 v32, 16, v189
    v_and_b32 v33, 0xffff0000, v189
    v_pk_add_f32 v[18:19], v[18:19], v[32:33]
    v_pk_fma_f32 v[26:27], v[32:33], v[32:33], v[26:27]
    v_lshlrev_b32 v32, 16, v190
    v_and_b32 v33, 0xffff0000, v190
    v_pk_add_f32 v[20:21], v[20:21], v[32:33]
    v_pk_fma_f32 v[28:29], v[32:33], v[32:33], v[28:29]
    v_lshlrev_b32 v32, 16, v191
    v_and_b32 v33, 0xffff0000, v191
    v_pk_add_f32 v[22:23], v[22:23], v[32:33]
    v_pk_fma_f32 v[30:31], v[32:33], v[32:33], v[30:31]
    s_lshl_b32 s26, s25, 12
    s_add_u32 s26, s26, 16384
    v_lshlrev_b32 v10, 6, v1
    v_add_u32 v10, s26, v10
    ds_write_b128 v10, v[16:19] offset:0
    ds_write_b128 v10, v[20:23] offset:16
    ds_write_b128 v10, v[24:27] offset:32
    ds_write_b128 v10, v[28:31] offset:48
    s_waitcnt lgkmcnt(0)
    s_barrier
    s_cmp_lg_u32 s25, 0
    s_cbranch_scc1 F_C_PUB
    v_lshrrev_b32 v10, 3, v1
    v_lshlrev_b32 v10, 6, v10
    v_and_b32 v11, 7, v1
    v_lshl_add_u32 v10, v11, 2, v10
    v_add_u32 v10, 16384, v10
    v_mov_b32 v16, 0
    v_mov_b32 v17, 0
    ds_read2_b32 v[32:33], v10 offset0:0 offset1:8
    v_add_u32 v10, 512, v10
    ds_read2_b32 v[34:35], v10 offset0:0 offset1:8
    v_add_u32 v10, 512, v10
    ds_read2_b32 v[36:37], v10 offset0:0 offset1:8
    v_add_u32 v10, 512, v10
    ds_read2_b32 v[38:39], v10 offset0:0 offset1:8
    v_add_u32 v10, 512, v10
    ds_read2_b32 v[40:41], v10 offset0:0 offset1:8
    v_add_u32 v10, 512, v10
    ds_read2_b32 v[42:43], v10 offset0:0 offset1:8
    v_add_u32 v10, 512, v10
    ds_read2_b32 v[44:45], v10 offset0:0 offset1:8
    v_add_u32 v10, 512, v10
    ds_read2_b32 v[46:47], v10 offset0:0 offset1:8
    v_add_u32 v10, 512, v10
    s_waitcnt lgkmcnt(0)
    v_pk_add_f32 v[16:17], v[16:17], v[32:33]
    v_pk_add_f32 v[16:17], v[16:17], v[34:35]
    v_pk_add_f32 v[16:17], v[16:17], v[36:37]
    v_pk_add_f32 v[16:17], v[16:17], v[38:39]
    v_pk_add_f32 v[16:17], v[16:17], v[40:41]
    v_pk_add_f32 v[16:17], v[16:17], v[42:43]
    v_pk_add_f32 v[16:17], v[16:17], v[44:45]
    v_pk_add_f32 v[16:17], v[16:17], v[46:47]
    ds_read2_b32 v[32:33], v10 offset0:0 offset1:8
    v_add_u32 v10, 512, v10
    ds_read2_b32 v[34:35], v10 offset0:0 offset1:8
    v_add_u32 v10, 512, v10
    ds_read2_b32 v[36:37], v10 offset0:0 offset1:8
    v_add_u32 v10, 512, v10
    ds_read2_b32 v[38:39], v10 offset0:0 offset1:8
    v_add_u32 v10, 512, v10
    ds_read2_b32 v[40:41], v10 offset0:0 offset1:8
    v_add_u32 v10, 512, v10
    ds_read2_b32 v[42:43], v10 offset0:0 offset1:8
    v_add_u32 v10, 512, v10
    ds_read2_b32 v[44:45], v10 offset0:0 offset1:8
    v_add_u32 v10, 512, v10
    ds_read2_b32 v[46:47], v10 offset0:0 offset1:8
    v_add_u32 v10, 512, v10
    s_waitcnt lgkmcnt(0)
    v_pk_add_f32 v[16:17], v[16:17], v[32:33]
    v_pk_add_f32 v[16:17], v[16:17], v[34:35]
    v_pk_add_f32 v[16:17], v[16:17], v[36:37]
    v_pk_add_f32 v[16:17], v[16:17], v[38:39]
    v_pk_add_f32 v[16:17], v[16:17], v[40:41]
    v_pk_add_f32 v[16:17], v[16:17], v[42:43]
    v_pk_add_f32 v[16:17], v[16:17], v[44:45]
    v_pk_add_f32 v[16:17], v[16:17], v[46:47]
    ds_read2_b32 v[32:33], v10 offset0:0 offset1:8
    v_add_u32 v10, 512, v10
    ds_read2_b32 v[34:35], v10 offset0:0 offset1:8
    v_add_u32 v10, 512, v10
    ds_read2_b32 v[36:37], v10 offset0:0 offset1:8
    v_add_u32 v10, 512, v10
    ds_read2_b32 v[38:39], v10 offset0:0 offset1:8
    v_add_u32 v10, 512, v10
    ds_read2_b32 v[40:41], v10 offset0:0 offset1:8
    v_add_u32 v10, 512, v10
    ds_read2_b32 v[42:43], v10 offset0:0 offset1:8
    v_add_u32 v10, 512, v10
    ds_read2_b32 v[44:45], v10 offset0:0 offset1:8
    v_add_u32 v10, 512, v10
    ds_read2_b32 v[46:47], v10 offset0:0 offset1:8
    v_add_u32 v10, 512, v10
    s_waitcnt lgkmcnt(0)
    v_pk_add_f32 v[16:17], v[16:17], v[32:33]
    v_pk_add_f32 v[16:17], v[16:17], v[34:35]
    v_pk_add_f32 v[16:17], v[16:17], v[36:37]
    v_pk_add_f32 v[16:17], v[16:17], v[38:39]
    v_pk_add_f32 v[16:17], v[16:17], v[40:41]
    v_pk_add_f32 v[16:17], v[16:17], v[42:43]
    v_pk_add_f32 v[16:17], v[16:17], v[44:45]
    v_pk_add_f32 v[16:17], v[16:17], v[46:47]
    ds_read2_b32 v[32:33], v10 offset0:0 offset1:8
    v_add_u32 v10, 512, v10
    ds_read2_b32 v[34:35], v10 offset0:0 offset1:8
    v_add_u32 v10, 512, v10
    ds_read2_b32 v[36:37], v10 offset0:0 offset1:8
    v_add_u32 v10, 512, v10
    ds_read2_b32 v[38:39], v10 offset0:0 offset1:8
    v_add_u32 v10, 512, v10
    ds_read2_b32 v[40:41], v10 offset0:0 offset1:8
    v_add_u32 v10, 512, v10
    ds_read2_b32 v[42:43], v10 offset0:0 offset1:8
    v_add_u32 v10, 512, v10
    ds_read2_b32 v[44:45], v10 offset0:0 offset1:8
    v_add_u32 v10, 512, v10
    ds_read2_b32 v[46:47], v10 offset0:0 offset1:8
    v_add_u32 v10, 512, v10
    s_waitcnt lgkmcnt(0)
    v_pk_add_f32 v[16:17], v[16:17], v[32:33]
    v_pk_add_f32 v[16:17], v[16:17], v[34:35]
    v_pk_add_f32 v[16:17], v[16:17], v[36:37]
    v_pk_add_f32 v[16:17], v[16:17], v[38:39]
    v_pk_add_f32 v[16:17], v[16:17], v[40:41]
    v_pk_add_f32 v[16:17], v[16:17], v[42:43]
    v_pk_add_f32 v[16:17], v[16:17], v[44:45]
    v_pk_add_f32 v[16:17], v[16:17], v[46:47]
    v_mul_f32 v16, 0x3acccccd, v16
    v_mul_f32 v17, 0x3acccccd, v17
    v_fma_f32 v17, -v16, v16, v17
    v_max_f32 v17, 0, v17
    v_add_f32 v17, 0x3727c5ac, v17
    v_rcp_f32 v12, v17
    v_sub_f32 v13, 0, v16
    s_lshl_b32 s26, s22, 8
    v_lshlrev_b32 v10, 2, v1
    s_add_u32 s27, s26, 16384
    buffer_store_dword v13, v10, s[40:43], s27 offen sc1
    buffer_store_dword v12, v10, s[40:43], s26 offen sc1
    s_lshr_b32 s47, s22, 1
    s_lshl_b32 s47, s47, 8
    s_add_u32 s47, s47, 15345152
    s_mov_b32 s49, 1
    s_waitcnt vmcnt(0)
    s_atomic_add s49, s[4:5], s47
    s_sub_u32 s46, s47, 9728
    s_atomic_add s49, s[4:5], s46
    s_add_u32 s51, s46, 128
    s_atomic_add s49, s[4:5], s51
F_C_PUB:
    s_barrier
F_C_ARR:
PADB7:
    s_cbranch_execz PADB8
    s_nop 0
    s_barrier
    buffer_load_dwordx4 v[16:19], v6, s[52:55], s50 offen offset:0 sc1
    buffer_load_dwordx4 v[20:23], v6, s[52:55], s50 offen offset:1024 sc1
    s_add_u32 s50, s50, 40960
    buffer_load_dwordx4 v[24:27], v6, s[52:55], s50 offen offset:0 sc1
    buffer_load_dwordx4 v[28:31], v6, s[52:55], s50 offen offset:1024 sc1
    s_add_u32 s50, s50, 40960
    buffer_load_dwordx4 v[32:35], v6, s[52:55], s50 offen offset:0 sc1
    buffer_load_dwordx4 v[36:39], v6, s[52:55], s50 offen offset:1024 sc1
    s_add_u32 s50, s50, 40960
    buffer_load_dwordx4 v[40:43], v6, s[52:55], s50 offen offset:0 sc1
    buffer_load_dwordx4 v[44:47], v6, s[52:55], s50 offen offset:1024 sc1
    s_add_u32 s50, s50, 40960
    buffer_load_dwordx4 v[48:51], v6, s[52:55], s50 offen offset:0 sc1
    buffer_load_dwordx4 v[52:55], v6, s[52:55], s50 offen offset:1024 sc1
    s_add_u32 s50, s50, 40960
    buffer_load_dwordx4 v[56:59], v6, s[52:55], s50 offen offset:0 sc1
    buffer_load_dwordx4 v[60:63], v6, s[52:55], s50 offen offset:1024 sc1
    s_add_u32 s50, s50, 40960
    buffer_load_dwordx4 v[64:67], v6, s[52:55], s50 offen offset:0 sc1
    buffer_load_dwordx4 v[68:71], v6, s[52:55], s50 offen offset:1024 sc1
    s_sub_u32 s50, s50, 240640
    buffer_load_dwordx4 v[72:75], v6, s[52:55], s50 offen offset:0 sc1
    buffer_load_dwordx4 v[76:79], v6, s[52:55], s50 offen offset:1024 sc1
    s_add_u32 s50, s50, 40960
    buffer_load_dwordx4 v[80:83], v6, s[52:55], s50 offen offset:0 sc1
    buffer_load_dwordx4 v[84:87], v6, s[52:55], s50 offen offset:1024 sc1
    s_add_u32 s50, s50, 40960
    buffer_load_dwordx4 v[88:91], v6, s[52:55], s50 offen offset:0 sc1
    buffer_load_dwordx4 v[92:95], v6, s[52:55], s50 offen offset:1024 sc1
    s_add_u32 s50, s50, 40960
    buffer_load_dwordx4 v[96:99], v6, s[52:55], s50 offen offset:0 sc1
    buffer_load_dwordx4 v[100:103], v6, s[52:55], s50 offen offset:1024 sc1
    s_add_u32 s50, s50, 40960
    buffer_load_dwordx4 v[104:107], v6, s[52:55], s50 offen offset:0 sc1
    buffer_load_dwordx4 v[108:111], v6, s[52:55], s50 offen offset:1024 sc1
    s_add_u32 s50, s50, 40960
    buffer_load_dwordx4 v[112:115], v6, s[52:55], s50 offen offset:0 sc1
    buffer_load_dwordx4 v[116:119], v6, s[52:55], s50 offen offset:1024 sc1
    s_add_u32 s50, s50, 40960
    buffer_load_dwordx4 v[120:123], v6, s[52:55], s50 offen offset:0 sc1
    buffer_load_dwordx4 v[124:127], v6, s[52:55], s50 offen offset:1024 sc1
    s_add_u32 s50, s50, 40960
    s_mul_i32 s26, s44, 221184
    s_add_u32 s26, s26, 24114176
    s_add_u32 s8, s4, s26
    s_addc_u32 s9, s5, 0
    s_and_b32 s9, s9, 0xffff
    s_mov_b32 s10, 224256
    s_mov_b32 s11, 0x20000
    s_add_u32 s28, s25, 0
    s_and_b32 s28, s28, 3
    s_lshl_b32 s28, s28, 10
    s_add_u32 s28, s28, 3072
    v_add_u32 v192, s28, v6
    s_add_u32 s28, s25, 1
    s_and_b32 s28, s28, 3
    s_lshl_b32 s28, s28, 10
    s_add_u32 s28, s28, 2048
    v_add_u32 v193, s28, v6
    s_add_u32 s28, s25, 2
    s_and_b32 s28, s28, 3
    s_lshl_b32 s28, s28, 10
    s_add_u32 s28, s28, 1024
    v_add_u32 v194, s28, v6
    s_add_u32 s28, s25, 3
    s_and_b32 s28, s28, 3
    s_lshl_b32 s28, s28, 10
    s_add_u32 s28, s28, 0
    v_add_u32 v195, s28, v6
    s_lshl_b32 s29, s44, 8
    s_lshl_b32 s30, s25, 6
    s_add_u32 s29, s29, s30
    v_and_b32 v11, 15, v1
    v_lshlrev_b32 v12, 2, v11
    s_lshl_b32 s28, s25, 12
    s_add_u32 s28, s28, 16384
    v_add_u32 v2, s28, v6
    v_add_u32 v3, 0x10000, v2
    v_add_u32 v4, 0x20000, v2
    s_add_u32 s28, s25, 1
    s_and_b32 s28, s28, 3
    s_mul_i32 s28, s28, 15360
    s_add_u32 s28, s28, 98304
    v_add_u32 v7, s28, v6
    s_add_u32 s28, s25, 2
    s_and_b32 s28, s28, 3
    s_mul_i32 s28, s28, 15360
    s_add_u32 s28, s28, 103424
    v_add_u32 v8, s28, v6
    s_add_u32 s28, s25, 3
    s_and_b32 s28, s28, 3
    s_mul_i32 s28, s28, 15360
PADB8:
    s_cbranch_execz PAD_RET
    s_nop 0
    s_add_u32 s28, s28, 108544
    v_add_u32 v9, s28, v6
    s_mul_i32 s28, s25, 15360
    s_add_u32 s28, s28, 98304
    v_add_u32 v14, s28, v6
    v_lshrrev_b32 v5, 4, v1
    v_mul_u32_u24 v5, 20, v5
    v_lshrrev_b32 v10, 2, v1
    v_and_b32 v10, 3, v10
    v_add_u32 v5, v5, v10
    v_lshlrev_b32 v5, 7, v5
    v_and_b32 v10, 3, v1
    v_lshl_add_u32 v5, v10, 3, v5
    s_lshl_b32 s28, s25, 5
    s_add_u32 s28, s28, 0
    v_add_u32 v5, s28, v5
    s_lshl_b32 s28, s44, 6
    s_lshl_b32 s30, s25, 4
    s_add_u32 s28, s28, s30
    s_mul_i32 s28, s28, 1280
    s_mul_i32 s30, s45, 160
    s_add_u32 s28, s28, s30
    v_mul_u32_u24 v11, 1280, v11
    v_lshrrev_b32 v10, 4, v1
    v_mul_u32_u24 v10, 40, v10
    v_add_u32 v11, v11, v10
    s_mov_b32 s16, s78
    s_and_b32 s17, s79, 0xffff
    s_mov_b32 s18, 2621440
    s_mov_b32 s19, 0x20000
    s_lshl_b32 s34, s25, 12
    s_lshl_b32 s32, s25, 13
    s_setprio 3
    s_waitcnt vmcnt(28)
    s_barrier
    s_add_u32 m0, s34, 16384
    s_nop 0
    buffer_load_dwordx4 v192, s[8:11], s32 offen offset:0 sc1 lds
    buffer_load_dwordx4 v193, s[8:11], s32 offen offset:1024 sc1 lds
    buffer_load_dwordx4 v194, s[8:11], s32 offen offset:2048 sc1 lds
    buffer_load_dwordx4 v195, s[8:11], s32 offen offset:3072 sc1 lds
    s_add_u32 s32, s32, 32768
    s_add_u32 m0, s34, 32768
    s_nop 0
    buffer_load_dwordx4 v192, s[8:11], s32 offen offset:0 sc1 lds
    buffer_load_dwordx4 v193, s[8:11], s32 offen offset:1024 sc1 lds
    buffer_load_dwordx4 v194, s[8:11], s32 offen offset:2048 sc1 lds
    buffer_load_dwordx4 v195, s[8:11], s32 offen offset:3072 sc1 lds
    s_add_u32 s32, s32, 32768
    s_add_u32 m0, s34, 49152
    s_nop 0
    buffer_load_dwordx4 v192, s[8:11], s32 offen offset:0 sc1 lds
    buffer_load_dwordx4 v193, s[8:11], s32 offen offset:1024 sc1 lds
    buffer_load_dwordx4 v194, s[8:11], s32 offen offset:2048 sc1 lds
    buffer_load_dwordx4 v195, s[8:11], s32 offen offset:3072 sc1 lds
    s_add_u32 s32, s32, 32768
    s_add_u32 m0, s34, 65536
    s_nop 0
    buffer_load_dwordx4 v192, s[8:11], s32 offen offset:0 sc1 lds
    buffer_load_dwordx4 v193, s[8:11], s32 offen offset:1024 sc1 lds
    buffer_load_dwordx4 v194, s[8:11], s32 offen offset:2048 sc1 lds
    buffer_load_dwordx4 v195, s[8:11], s32 offen offset:3072 sc1 lds
    s_add_u32 s32, s32, 32768
    buffer_load_dword v13, v12, s[40:43], s29 offen sc1
    s_waitcnt vmcnt(13)
    s_barrier
    ds_read_b128 v[160:163], v2 offset:0
    ds_read_b128 v[164:167], v2 offset:1024
    ds_read_b128 v[168:171], v2 offset:2048
    ds_read_b128 v[172:175], v2 offset:3072
    s_waitcnt vmcnt(9) lgkmcnt(0)
    s_barrier
    v_mfma_f32_16x16x32_bf16 v[128:131], v[16:19], v[160:163], 0
    ds_read_b128 v[176:179], v2 offset:16384
    v_mfma_f32_16x16x32_bf16 v[132:135], v[20:23], v[160:163], 0
    s_add_u32 m0, s34, 81920
    s_nop 0
    s_nop 0
    buffer_load_dwordx4 v192, s[8:11], s32 offen offset:0 sc1 lds
    v_mfma_f32_16x16x32_bf16 v[136:139], v[16:19], v[164:167], 0
    ds_read_b128 v[180:183], v2 offset:17408
    v_mfma_f32_16x16x32_bf16 v[140:143], v[20:23], v[164:167], 0
    buffer_load_dwordx4 v193, s[8:11], s32 offen offset:1024 sc1 lds
    v_mfma_f32_16x16x32_bf16 v[144:147], v[16:19], v[168:171], 0
    ds_read_b128 v[184:187], v2 offset:18432
    v_mfma_f32_16x16x32_bf16 v[148:151], v[20:23], v[168:171], 0
    buffer_load_dwordx4 v194, s[8:11], s32 offen offset:2048 sc1 lds
    v_mfma_f32_16x16x32_bf16 v[152:155], v[16:19], v[172:175], 0
    ds_read_b128 v[188:191], v2 offset:19456
    v_mfma_f32_16x16x32_bf16 v[156:159], v[20:23], v[172:175], 0
    buffer_load_dwordx4 v195, s[8:11], s32 offen offset:3072 sc1 lds
    s_add_u32 s32, s32, 32768
    s_waitcnt vmcnt(9) lgkmcnt(0)
    s_barrier
    v_mfma_f32_16x16x32_bf16 v[128:131], v[24:27], v[176:179], v[128:131]
    ds_read_b128 v[160:163], v2 offset:32768
    v_mfma_f32_16x16x32_bf16 v[132:135], v[28:31], v[176:179], v[132:135]
    s_add_u32 m0, s34, 98304
    s_nop 0
    s_nop 0
    buffer_load_dwordx4 v192, s[8:11], s32 offen offset:0 sc1 lds
    v_mfma_f32_16x16x32_bf16 v[136:139], v[24:27], v[180:183], v[136:139]
    ds_read_b128 v[164:167], v2 offset:33792
    v_mfma_f32_16x16x32_bf16 v[140:143], v[28:31], v[180:183], v[140:143]
    buffer_load_dwordx4 v193, s[8:11], s32 offen offset:1024 sc1 lds
    v_mfma_f32_16x16x32_bf16 v[144:147], v[24:27], v[184:187], v[144:147]
    ds_read_b128 v[168:171], v2 offset:34816
    v_mfma_f32_16x16x32_bf16 v[148:151], v[28:31], v[184:187], v[148:151]
    buffer_load_dwordx4 v194, s[8:11], s32 offen offset:2048 sc1 lds
    v_mfma_f32_16x16x32_bf16 v[152:155], v[24:27], v[188:191], v[152:155]
    ds_read_b128 v[172:175], v2 offset:35840
    v_mfma_f32_16x16x32_bf16 v[156:159], v[28:31], v[188:191], v[156:159]
    buffer_load_dwordx4 v195, s[8:11], s32 offen offset:3072 sc1 lds
    s_add_u32 s32, s32, 32768
    s_waitcnt vmcnt(9) lgkmcnt(0)
    s_barrier
    v_mfma_f32_16x16x32_bf16 v[128:131], v[32:35], v[160:163], v[128:131]
    ds_read_b128 v[176:179], v2 offset:49152
    v_mfma_f32_16x16x32_bf16 v[132:135], v[36:39], v[160:163], v[132:135]
    s_add_u32 m0, s34, 114688
    s_nop 0
    s_nop 0
    buffer_load_dwordx4 v192, s[8:11], s32 offen offset:0 sc1 lds
    v_mfma_f32_16x16x32_bf16 v[136:139], v[32:35], v[164:167], v[136:139]
    ds_read_b128 v[180:183], v2 offset:50176
    v_mfma_f32_16x16x32_bf16 v[140:143], v[36:39], v[164:167], v[140:143]
    buffer_load_dwordx4 v193, s[8:11], s32 offen offset:1024 sc1 lds
    v_mfma_f32_16x16x32_bf16 v[144:147], v[32:35], v[168:171], v[144:147]
    ds_read_b128 v[184:187], v2 offset:51200
    v_mfma_f32_16x16x32_bf16 v[148:151], v[36:39], v[168:171], v[148:151]
    buffer_load_dwordx4 v194, s[8:11], s32 offen offset:2048 sc1 lds
    v_mfma_f32_16x16x32_bf16 v[152:155], v[32:35], v[172:175], v[152:155]
    ds_read_b128 v[188:191], v2 offset:52224
    v_mfma_f32_16x16x32_bf16 v[156:159], v[36:39], v[172:175], v[156:159]
    buffer_load_dwordx4 v195, s[8:11], s32 offen offset:3072 sc1 lds
    s_sub_u32 s32, s32, 192512
    s_waitcnt vmcnt(8) lgkmcnt(0)
    s_barrier
    v_mfma_f32_16x16x32_bf16 v[128:131], v[40:43], v[176:179], v[128:131]
    ds_read_b128 v[160:163], v3 offset:0
    v_mfma_f32_16x16x32_bf16 v[132:135], v[44:47], v[176:179], v[132:135]
    s_add_u32 m0, s34, 131072
    s_nop 0
    s_nop 0
    buffer_load_dwordx4 v192, s[8:11], s32 offen offset:0 sc1 lds
    v_mfma_f32_16x16x32_bf16 v[136:139], v[40:43], v[180:183], v[136:139]
    ds_read_b128 v[164:167], v3 offset:1024
    v_mfma_f32_16x16x32_bf16 v[140:143], v[44:47], v[180:183], v[140:143]
    buffer_load_dwordx4 v193, s[8:11], s32 offen offset:1024 sc1 lds
    v_mfma_f32_16x16x32_bf16 v[144:147], v[40:43], v[184:187], v[144:147]
    ds_read_b128 v[168:171], v3 offset:2048
    v_mfma_f32_16x16x32_bf16 v[148:151], v[44:47], v[184:187], v[148:151]
    buffer_load_dwordx4 v194, s[8:11], s32 offen offset:2048 sc1 lds
    v_mfma_f32_16x16x32_bf16 v[152:155], v[40:43], v[188:191], v[152:155]
    ds_read_b128 v[172:175], v3 offset:3072
    v_mfma_f32_16x16x32_bf16 v[156:159], v[44:47], v[188:191], v[156:159]
    buffer_load_dwordx4 v195, s[8:11], s32 offen offset:3072 sc1 lds
    s_add_u32 s32, s32, 32768
    s_waitcnt vmcnt(8) lgkmcnt(0)
    s_barrier
    v_mfma_f32_16x16x32_bf16 v[128:131], v[48:51], v[160:163], v[128:131]
    ds_read_b128 v[176:179], v3 offset:16384
    v_mfma_f32_16x16x32_bf16 v[132:135], v[52:55], v[160:163], v[132:135]
    s_add_u32 m0, s34, 147456
    s_nop 0
    s_nop 0
    buffer_load_dwordx4 v192, s[8:11], s32 offen offset:0 sc1 lds
    v_mfma_f32_16x16x32_bf16 v[136:139], v[48:51], v[164:167], v[136:139]
    ds_read_b128 v[180:183], v3 offset:17408
    v_mfma_f32_16x16x32_bf16 v[140:143], v[52:55], v[164:167], v[140:143]
    buffer_load_dwordx4 v193, s[8:11], s32 offen offset:1024 sc1 lds
    v_mfma_f32_16x16x32_bf16 v[144:147], v[48:51], v[168:171], v[144:147]
    ds_read_b128 v[184:187], v3 offset:18432
    v_mfma_f32_16x16x32_bf16 v[148:151], v[52:55], v[168:171], v[148:151]
    buffer_load_dwordx4 v194, s[8:11], s32 offen offset:2048 sc1 lds
    v_mfma_f32_16x16x32_bf16 v[152:155], v[48:51], v[172:175], v[152:155]
    ds_read_b128 v[188:191], v3 offset:19456
    v_mfma_f32_16x16x32_bf16 v[156:159], v[52:55], v[172:175], v[156:159]
    buffer_load_dwordx4 v195, s[8:11], s32 offen offset:3072 sc1 lds
    s_add_u32 s32, s32, 32768
    s_waitcnt vmcnt(8) lgkmcnt(0)
    s_barrier
    v_mfma_f32_16x16x32_bf16 v[128:131], v[56:59], v[176:179], v[128:131]
    ds_read_b128 v[160:163], v3 offset:32768
    v_mfma_f32_16x16x32_bf16 v[132:135], v[60:63], v[176:179], v[132:135]
    s_add_u32 m0, s34, 16384
    s_nop 0
    s_nop 0
    buffer_load_dwordx4 v192, s[8:11], s32 offen offset:0 sc1 lds
    v_mfma_f32_16x16x32_bf16 v[136:139], v[56:59], v[180:183], v[136:139]
    ds_read_b128 v[164:167], v3 offset:33792
    v_mfma_f32_16x16x32_bf16 v[140:143], v[60:63], v[180:183], v[140:143]
    buffer_load_dwordx4 v193, s[8:11], s32 offen offset:1024 sc1 lds
    v_mfma_f32_16x16x32_bf16 v[144:147], v[56:59], v[184:187], v[144:147]
    ds_read_b128 v[168:171], v3 offset:34816
    v_mfma_f32_16x16x32_bf16 v[148:151], v[60:63], v[184:187], v[148:151]
    buffer_load_dwordx4 v194, s[8:11], s32 offen offset:2048 sc1 lds
    v_mfma_f32_16x16x32_bf16 v[152:155], v[56:59], v[188:191], v[152:155]
    ds_read_b128 v[172:175], v3 offset:35840
    v_mfma_f32_16x16x32_bf16 v[156:159], v[60:63], v[188:191], v[156:159]
    buffer_load_dwordx4 v195, s[8:11], s32 offen offset:3072 sc1 lds
    s_add_u32 s32, s32, 32768
    s_waitcnt vmcnt(8) lgkmcnt(0)
    s_barrier
    v_mfma_f32_16x16x32_bf16 v[128:131], v[64:67], v[160:163], v[128:131]
    ds_read_b128 v[176:179], v3 offset:49152
    v_mfma_f32_16x16x32_bf16 v[132:135], v[68:71], v[160:163], v[132:135]
    s_add_u32 m0, s34, 32768
    s_nop 0
    s_nop 0
    buffer_load_dwordx4 v192, s[8:11], s32 offen offset:0 sc1 lds
    v_mfma_f32_16x16x32_bf16 v[136:139], v[64:67], v[164:167], v[136:139]
    ds_read_b128 v[180:183], v3 offset:50176
    v_mfma_f32_16x16x32_bf16 v[140:143], v[68:71], v[164:167], v[140:143]
    buffer_load_dwordx4 v193, s[8:11], s32 offen offset:1024 sc1 lds
    v_mfma_f32_16x16x32_bf16 v[144:147], v[64:67], v[168:171], v[144:147]
    ds_read_b128 v[184:187], v3 offset:51200
    v_mfma_f32_16x16x32_bf16 v[148:151], v[68:71], v[168:171], v[148:151]
    buffer_load_dwordx4 v194, s[8:11], s32 offen offset:2048 sc1 lds
    v_mfma_f32_16x16x32_bf16 v[152:155], v[64:67], v[172:175], v[152:155]
    ds_read_b128 v[188:191], v3 offset:52224
    v_mfma_f32_16x16x32_bf16 v[156:159], v[68:71], v[172:175], v[156:159]
    buffer_load_dwordx4 v195, s[8:11], s32 offen offset:3072 sc1 lds
    s_add_u32 s32, s32, 32768
    s_waitcnt vmcnt(8) lgkmcnt(0)
    s_barrier
    v_mfma_f32_16x16x32_bf16 v[128:131], v[72:75], v[176:179], v[128:131]
    ds_read_b128 v[160:163], v4 offset:0
    v_mfma_f32_16x16x32_bf16 v[132:135], v[76:79], v[176:179], v[132:135]
    s_add_u32 m0, s34, 49152
    s_nop 0
    s_nop 0
    buffer_load_dwordx4 v192, s[8:11], s32 offen offset:0 sc1 lds
    v_mfma_f32_16x16x32_bf16 v[136:139], v[72:75], v[180:183], v[136:139]
    ds_read_b128 v[164:167], v4 offset:1024
    v_mfma_f32_16x16x32_bf16 v[140:143], v[76:79], v[180:183], v[140:143]
    buffer_load_dwordx4 v193, s[8:11], s32 offen offset:1024 sc1 lds
    v_mfma_f32_16x16x32_bf16 v[144:147], v[72:75], v[184:187], v[144:147]
    ds_read_b128 v[168:171], v4 offset:2048
    v_mfma_f32_16x16x32_bf16 v[148:151], v[76:79], v[184:187], v[148:151]
    buffer_load_dwordx4 v194, s[8:11], s32 offen offset:2048 sc1 lds
    v_mfma_f32_16x16x32_bf16 v[152:155], v[72:75], v[188:191], v[152:155]
    ds_read_b128 v[172:175], v4 offset:3072
    v_mfma_f32_16x16x32_bf16 v[156:159], v[76:79], v[188:191], v[156:159]
    buffer_load_dwordx4 v195, s[8:11], s32 offen offset:3072 sc1 lds
    s_add_u32 s32, s32, 32768
    s_waitcnt vmcnt(8) lgkmcnt(0)
    s_barrier
    v_mfma_f32_16x16x32_bf16 v[128:131], v[80:83], v[160:163], v[128:131]
    ds_read_b128 v[176:179], v2 offset:0
    v_mfma_f32_16x16x32_bf16 v[132:135], v[84:87], v[160:163], v[132:135]
    s_add_u32 m0, s34, 65536
    s_nop 0
    s_nop 0
    buffer_load_dwordx4 v192, s[8:11], s32 offen offset:0 sc1 lds
    v_mfma_f32_16x16x32_bf16 v[136:139], v[80:83], v[164:167], v[136:139]
    ds_read_b128 v[180:183], v2 offset:1024
    v_mfma_f32_16x16x32_bf16 v[140:143], v[84:87], v[164:167], v[140:143]
    buffer_load_dwordx4 v193, s[8:11], s32 offen offset:1024 sc1 lds
    v_mfma_f32_16x16x32_bf16 v[144:147], v[80:83], v[168:171], v[144:147]
    ds_read_b128 v[184:187], v2 offset:2048
    v_mfma_f32_16x16x32_bf16 v[148:151], v[84:87], v[168:171], v[148:151]
    buffer_load_dwordx4 v194, s[8:11], s32 offen offset:2048 sc1 lds
    v_mfma_f32_16x16x32_bf16 v[152:155], v[80:83], v[172:175], v[152:155]
    ds_read_b128 v[188:191], v2 offset:3072
    v_mfma_f32_16x16x32_bf16 v[156:159], v[84:87], v[172:175], v[156:159]
    buffer_load_dwordx4 v195, s[8:11], s32 offen offset:3072 sc1 lds
    s_add_u32 s32, s32, 32768
    s_waitcnt vmcnt(8) lgkmcnt(0)
    s_barrier
    v_mfma_f32_16x16x32_bf16 v[128:131], v[88:91], v[176:179], v[128:131]
    ds_read_b128 v[160:163], v2 offset:16384
    v_mfma_f32_16x16x32_bf16 v[132:135], v[92:95], v[176:179], v[132:135]
    s_add_u32 m0, s34, 81920
    s_nop 0
    s_nop 0
    buffer_load_dwordx4 v192, s[8:11], s32 offen offset:0 sc1 lds
    v_mfma_f32_16x16x32_bf16 v[136:139], v[88:91], v[180:183], v[136:139]
    ds_read_b128 v[164:167], v2 offset:17408
    v_mfma_f32_16x16x32_bf16 v[140:143], v[92:95], v[180:183], v[140:143]
    buffer_load_dwordx4 v193, s[8:11], s32 offen offset:1024 sc1 lds
    v_mfma_f32_16x16x32_bf16 v[144:147], v[88:91], v[184:187], v[144:147]
    ds_read_b128 v[168:171], v2 offset:18432
    v_mfma_f32_16x16x32_bf16 v[148:151], v[92:95], v[184:187], v[148:151]
    buffer_load_dwordx4 v194, s[8:11], s32 offen offset:2048 sc1 lds
    v_mfma_f32_16x16x32_bf16 v[152:155], v[88:91], v[188:191], v[152:155]
    ds_read_b128 v[172:175], v2 offset:19456
    v_mfma_f32_16x16x32_bf16 v[156:159], v[92:95], v[188:191], v[156:159]
    buffer_load_dwordx4 v195, s[8:11], s32 offen offset:3072 sc1 lds
    s_add_u32 s32, s32, 32768
    s_waitcnt vmcnt(8) lgkmcnt(0)
    s_barrier
    v_mfma_f32_16x16x32_bf16 v[128:131], v[96:99], v[160:163], v[128:131]
    ds_read_b128 v[176:179], v2 offset:32768
    v_mfma_f32_16x16x32_bf16 v[132:135], v[100:103], v[160:163], v[132:135]
    ds_read_b128 v[180:183], v2 offset:33792
    v_mfma_f32_16x16x32_bf16 v[136:139], v[96:99], v[164:167], v[136:139]
    ds_read_b128 v[184:187], v2 offset:34816
    v_mfma_f32_16x16x32_bf16 v[140:143], v[100:103], v[164:167], v[140:143]
    ds_read_b128 v[188:191], v2 offset:35840
    v_mfma_f32_16x16x32_bf16 v[144:147], v[96:99], v[168:171], v[144:147]
    v_mfma_f32_16x16x32_bf16 v[148:151], v[100:103], v[168:171], v[148:151]
    v_mfma_f32_16x16x32_bf16 v[152:155], v[96:99], v[172:175], v[152:155]
    v_mfma_f32_16x16x32_bf16 v[156:159], v[100:103], v[172:175], v[156:159]
    s_waitcnt vmcnt(4) lgkmcnt(0)
    s_barrier
    v_mfma_f32_16x16x32_bf16 v[128:131], v[104:107], v[176:179], v[128:131]
    ds_read_b128 v[160:163], v2 offset:49152
    v_mfma_f32_16x16x32_bf16 v[132:135], v[108:111], v[176:179], v[132:135]
    ds_read_b128 v[164:167], v2 offset:50176
    v_mfma_f32_16x16x32_bf16 v[136:139], v[104:107], v[180:183], v[136:139]
    ds_read_b128 v[168:171], v2 offset:51200
    v_mfma_f32_16x16x32_bf16 v[140:143], v[108:111], v[180:183], v[140:143]
    ds_read_b128 v[172:175], v2 offset:52224
    v_mfma_f32_16x16x32_bf16 v[144:147], v[104:107], v[184:187], v[144:147]
    v_mfma_f32_16x16x32_bf16 v[148:151], v[108:111], v[184:187], v[148:151]
    v_mfma_f32_16x16x32_bf16 v[152:155], v[104:107], v[188:191], v[152:155]
    v_mfma_f32_16x16x32_bf16 v[156:159], v[108:111], v[188:191], v[156:159]
    s_waitcnt vmcnt(0) lgkmcnt(0)
    s_barrier
    v_mfma_f32_16x16x32_bf16 v[128:131], v[112:115], v[160:163], v[128:131]
    ds_read_b128 v[176:179], v3 offset:0
    v_mfma_f32_16x16x32_bf16 v[132:135], v[116:119], v[160:163], v[132:135]
    ds_read_b128 v[180:183], v3 offset:1024
    v_mfma_f32_16x16x32_bf16 v[136:139], v[112:115], v[164:167], v[136:139]
    ds_read_b128 v[184:187], v3 offset:2048
    v_mfma_f32_16x16x32_bf16 v[140:143], v[116:119], v[164:167], v[140:143]
    ds_read_b128 v[188:191], v3 offset:3072
    v_mfma_f32_16x16x32_bf16 v[144:147], v[112:115], v[168:171], v[144:147]
    v_mfma_f32_16x16x32_bf16 v[148:151], v[116:119], v[168:171], v[148:151]
    v_mfma_f32_16x16x32_bf16 v[152:155], v[112:115], v[172:175], v[152:155]
    v_mfma_f32_16x16x32_bf16 v[156:159], v[116:119], v[172:175], v[156:159]
    s_waitcnt lgkmcnt(0)
    v_mfma_f32_16x16x32_bf16 v[152:155], v[120:123], v[188:191], v[152:155]
    v_mfma_f32_16x16x32_bf16 v[156:159], v[124:127], v[188:191], v[156:159]
    v_mfma_f32_16x16x32_bf16 v[144:147], v[120:123], v[184:187], v[144:147]
    v_mfma_f32_16x16x32_bf16 v[148:151], v[124:127], v[184:187], v[148:151]
    v_mfma_f32_16x16x32_bf16 v[136:139], v[120:123], v[180:183], v[136:139]
    v_mfma_f32_16x16x32_bf16 v[140:143], v[124:127], v[180:183], v[140:143]
    v_mfma_f32_16x16x32_bf16 v[128:131], v[120:123], v[176:179], v[128:131]
    v_mfma_f32_16x16x32_bf16 v[132:135], v[124:127], v[176:179], v[132:135]
    s_nop 4
    ds_write_b128 v9, v[152:155] offset:3072
    ds_write_b128 v9, v[156:159] offset:4096
    ds_write_b128 v8, v[144:147] offset:3072
    ds_write_b128 v8, v[148:151] offset:4096
    ds_write_b128 v7, v[136:139] offset:3072
    ds_write_b128 v7, v[140:143] offset:4096
    ds_read_b64_tr_b16 v[16:17], v5 offset:1536
    ds_read_b64_tr_b16 v[18:19], v5 offset:2048
    s_waitcnt lgkmcnt(0)
    s_barrier
    ds_read_b128 v[24:27], v14 offset:3072
    ds_read_b128 v[28:31], v14 offset:4096
    ds_read_b128 v[32:35], v14 offset:8192
    ds_read_b128 v[36:39], v14 offset:9216
    ds_read_b128 v[40:43], v14 offset:13312
    ds_read_b128 v[44:47], v14 offset:14336
    v_lshlrev_b32 v64, 16, v16
    v_and_b32 v65, 0xffff0000, v16
    v_lshlrev_b32 v66, 16, v17
    v_and_b32 v67, 0xffff0000, v17
    v_lshlrev_b32 v68, 16, v18
    v_and_b32 v69, 0xffff0000, v18
    v_lshlrev_b32 v70, 16, v19
    v_and_b32 v71, 0xffff0000, v19
    s_waitcnt vmcnt(0)
    v_mov_b32 v12, v13
    s_waitcnt lgkmcnt(4)
    v_pk_add_f32 v[128:129], v[128:129], v[24:25]
    v_pk_add_f32 v[130:131], v[130:131], v[26:27]
    v_pk_add_f32 v[132:133], v[132:133], v[28:29]
    v_pk_add_f32 v[134:135], v[134:135], v[30:31]
    s_waitcnt lgkmcnt(2)
    v_pk_add_f32 v[128:129], v[128:129], v[32:33]
    v_pk_add_f32 v[130:131], v[130:131], v[34:35]
    v_pk_add_f32 v[132:133], v[132:133], v[36:37]
    v_pk_add_f32 v[134:135], v[134:135], v[38:39]
    s_waitcnt lgkmcnt(0)
    v_pk_add_f32 v[128:129], v[128:129], v[40:41]
    v_pk_add_f32 v[130:131], v[130:131], v[42:43]
    v_pk_add_f32 v[132:133], v[132:133], v[44:45]
    v_pk_add_f32 v[134:135], v[134:135], v[46:47]
    v_pk_fma_f32 v[128:129], v[128:129], v[12:13], v[64:65]
    v_cvt_pk_bf16_f32 v16, v128, v129
    v_pk_fma_f32 v[130:131], v[130:131], v[12:13], v[66:67]
    v_cvt_pk_bf16_f32 v17, v130, v131
    v_pk_fma_f32 v[132:133], v[132:133], v[12:13], v[68:69]
    v_cvt_pk_bf16_f32 v18, v132, v133
    v_pk_fma_f32 v[134:135], v[134:135], v[12:13], v[70:71]
    v_cvt_pk_bf16_f32 v19, v134, v135
    buffer_store_dwordx4 v[16:19], v11, s[16:19], s28 offen offset:24
    s_endpgm
M_END:
    s_endpgm
.section .rodata,"a"
.p2align 6
.amdhsa_kernel sequential_preLN__ssm_conv_s4__glu_gated_bilinear__prompt_kernel
  .amdhsa_next_free_vgpr 256
  .amdhsa_next_free_sgpr 100
  .amdhsa_accum_offset 256
  .amdhsa_group_segment_fixed_size 0
  .amdhsa_kernarg_size 128
  .amdhsa_user_sgpr_count 2
  .amdhsa_user_sgpr_kernarg_segment_ptr 1
  .amdhsa_system_sgpr_workgroup_id_x 1
  .amdhsa_float_denorm_mode_32 3
.end_amdhsa_kernel
```
